```python
import torch

def _softmax(x, axis=-1):
    return torch.softmax(x, dim=axis)

def _gelu(x):
    return torch.nn.functional.gelu(x, approximate='tanh')

def _silu(x):
    return torch.nn.functional.silu(x)

def _sigmoid(x):
    return torch.sigmoid(x)

def _layernorm(x, axis=-1, eps=1e-05):
    m = x.mean(dim=axis, keepdim=True)
    v = x.var(dim=axis, keepdim=True, unbiased=False)
    return (x - m) / torch.sqrt(v + eps)

def _scatter_add(tgt, idx, src, axis=0):
    return tgt.clone().index_add_(axis, idx, src)

def _segment_sum(src, seg, n):
    out = torch.zeros((n,) + src.shape[1:], dtype=src.dtype)
    return out.index_add_(0, seg, src)

def _pad(x, pw):
    flat = tuple((v for pair in reversed(pw) for v in pair))
    return torch.nn.functional.pad(x, flat)
kernel_name = 'adaLN_cond__sliding_block__glu_gated_bilinear__prompt'

def setup_inputs():

    _w = lambda a: (lambda t: t.to(torch.bfloat16) if t.is_floating_point() else t)(torch.as_tensor(a))

    def _A_setup():
        B, S, D = (1, 2048, 640)
        return {'x': _w((lambda *s: torch.randn(*s, dtype=torch.bfloat16) * 0.05)(B, S, D)), 'wqkv': _w((lambda *s: torch.randn(*s, dtype=torch.bfloat16) * 0.05)(D, 3 * D)), 'wo': _w((lambda *s: torch.randn(*s, dtype=torch.bfloat16) * 0.05)(D, D))}
    _A_in = _A_setup()

    def _B_setup():
        B, S, D, F = (1, 2048, 640, 1536)
        return {'x': _w((lambda *s: torch.randn(*s, dtype=torch.bfloat16) * 0.05)(B, S, D)), 'w_gate': _w((lambda *s: torch.randn(*s, dtype=torch.bfloat16) * 0.8)(D, F) * D ** (-0.5)), 'w_up': _w((lambda *s: torch.randn(*s, dtype=torch.bfloat16) * 0.8)(D, F) * D ** (-0.5)), 'w_down': _w((lambda *s: torch.randn(*s, dtype=torch.bfloat16) * 0.8)(F, D) * F ** (-0.5))}
    _B_in = _B_setup()
    return {'A_x': _A_in['x'], 'A_wqkv': _A_in['wqkv'], 'A_wo': _A_in['wo'], 'B_x': _B_in['x'], 'B_w_gate': _B_in['w_gate'], 'B_w_up': _B_in['w_up'], 'B_w_down': _B_in['w_down'], 'c': _w((lambda *s: torch.randn(*s, dtype=torch.bfloat16) * 0.1)(1, 640) * 8.0), 'w_mod': _w((lambda *s: torch.randn(*s, dtype=torch.bfloat16) * 0.1)(640, 6 * 640) * 640 ** (-0.5) * 8.0)}

def reference(A_x, A_wqkv, A_wo, B_x, B_w_gate, B_w_up, B_w_down, c, w_mod):

    def _A_ref(x, wqkv, wo):
        B, S, D = x.shape
        H = 32
        Dh = D // H
        W = 256
        qkv = (lambda x, *d: x.permute(*d))((x @ wqkv).reshape(B, S, 3, H, Dh), 2, 0, 3, 1, 4)
        q, k, v = (qkv[0], qkv[1], qkv[2])
        scores = torch.einsum('bhqd,bhkd->bhqk', q, k) * Dh ** (-0.5)
        idx = torch.arange(S)
        mask = (idx[:, None] - idx[None, :] >= 0) & (idx[:, None] - idx[None, :] < W)
        scores = torch.where(mask[None, None], scores, -1000000000.0)
        p = _softmax(scores, axis=-1)
        o = torch.einsum('bhqk,bhkd->bhqd', p, v)
        return (lambda x, *d: x.permute(*d))(o, 0, 2, 1, 3).reshape(B, S, D) @ wo

    def _B_ref(x, w_gate, w_up, w_down):
        g = torch.einsum('bsd,df->bsf', x, w_gate)
        u = torch.einsum('bsd,df->bsf', x, w_up)
        h = g * u
        return torch.einsum('bsf,fd->bsd', h, w_down)
    x = A_x
    mod = (_silu(c) @ w_mod).reshape(c.shape[0], 6, 1, -1)
    sa, ca, ga, sb, cb, gb = (mod[:, 0].clone(), mod[:, 1].clone(), mod[:, 2].clone(), mod[:, 3].clone(), mod[:, 4].clone(), mod[:, 5].clone())
    h = _layernorm(x, axis=-1) * (1 + ca) + sa
    x = x + ga * _A_ref(h, A_wqkv, A_wo)
    h = _layernorm(x, axis=-1) * (1 + cb) + sb
    x = x + gb * _B_ref(h, B_w_gate, B_w_up, B_w_down)
    return x
```

```asm
; @launch kernel=k0_kernel grid=(632,1,1) block=(256,1,1) lds=47104
; @launch kernel=p_kernel grid=(256,1,1) block=(512,1,1) lds=163840
.amdgcn_target "amdgcn-amd-amdhsa--gfx950"
.text
.globl k0_kernel
.p2align 8
.type k0_kernel,@function
k0_kernel:
  s_cmp_ge_u32 s2, 632
  s_cbranch_scc1 L_k0_end
  s_getpc_b64 s[6:7]
L_k0_pc:
  s_add_u32 s6, s6, (k0_tasks - L_k0_pc)
  s_addc_u32 s7, s7, 0
  s_lshl_b32 s8, s2, 2
  s_load_dword s30, s[6:7], s8
  s_load_dwordx2 s[4:5], s[0:1], 88
  s_load_dwordx16 s[64:79], s[0:1], 0
  s_load_dwordx2 s[80:81], s[0:1], 64
  v_lshrrev_b32 v1, 6, v0
  v_and_b32 v2, 63, v0
  v_lshlrev_b32 v3, 4, v2
  v_readfirstlane_b32 s3, v1
  s_waitcnt lgkmcnt(0)
  s_and_b32 s31, s30, 15
  s_bfe_u32 s32, s30, 0x60004
  s_bfe_u32 s33, s30, 0x4000a
  s_cmp_ge_u32 s2, 16
  s_cbranch_scc1 L_k0_nowarm
  s_getpc_b64 s[44:45]
L_k0_pc2:
  s_add_u32 s44, s44, (p_kernel - L_k0_pc2)
  s_addc_u32 s45, s45, 0
  s_mov_b32 s48, s44
  s_and_b32 s49, s45, 0xffff
  s_mov_b32 s50, (L_p_codeend - p_kernel)
  s_mov_b32 s51, 0x20000
  s_lshr_b32 s52, s2, 3
  s_lshl_b32 s52, s52, 2
  s_add_u32 s52, s52, s3
  s_lshl_b32 s52, s52, 10
  buffer_load_dwordx4 v[16:19], v3, s[48:51], s52 offen
  s_add_u32 s52, s52, 8192
  buffer_load_dwordx4 v[16:19], v3, s[48:51], s52 offen
  s_add_u32 s52, s52, 8192
  buffer_load_dwordx4 v[16:19], v3, s[48:51], s52 offen
  s_add_u32 s52, s52, 8192
  buffer_load_dwordx4 v[16:19], v3, s[48:51], s52 offen
  s_add_u32 s52, s52, 8192
  buffer_load_dwordx4 v[16:19], v3, s[48:51], s52 offen
  s_add_u32 s52, s52, 8192
  buffer_load_dwordx4 v[16:19], v3, s[48:51], s52 offen
  s_add_u32 s52, s52, 8192
  buffer_load_dwordx4 v[16:19], v3, s[48:51], s52 offen
  s_add_u32 s52, s52, 8192
  buffer_load_dwordx4 v[16:19], v3, s[48:51], s52 offen
  s_add_u32 s52, s52, 8192
L_k0_nowarm:
  s_add_u32 s12, s4, 0x2094000
  s_addc_u32 s13, s5, 0
  s_and_b32 s13, s13, 0xffff
  s_mov_b32 s14, 0x10000
  s_mov_b32 s15, 0x20000
  s_cmp_ge_u32 s2, 16
  s_cbranch_scc1 L_k0_noz
  v_lshlrev_b32 v8, 4, v0
  s_lshl_b32 s34, s2, 12
  v_mov_b32 v4, 0
  v_mov_b32 v5, 0
  v_mov_b32 v6, 0
  v_mov_b32 v7, 0
  buffer_store_dwordx4 v[4:7], v8, s[12:15], s34 offen
  s_nop 1
L_k0_noz:
  s_cmp_eq_u32 s31, 1
  s_cbranch_scc1 L_k0_w1
  s_cmp_eq_u32 s31, 2
  s_cbranch_scc1 L_k0_w2
  s_cmp_eq_u32 s31, 4
  s_cbranch_scc1 L_k0_xn
  s_cmp_ge_u32 s31, 5
  s_cbranch_scc1 L_k0_tb
  s_mov_b64 s[10:11], s[80:81]
  s_mov_b64 s[52:53], s[78:79]
  s_waitcnt lgkmcnt(0)
  s_mov_b32 s16, s10
  s_mov_b32 s17, s11
  s_and_b32 s17, s17, 0xffff
  s_mov_b32 s18, 0x4b0000
  s_mov_b32 s19, 0x20000
  s_mov_b32 s20, s52
  s_mov_b32 s21, s53
  s_and_b32 s21, s21, 0xffff
  s_mov_b32 s22, 0x500
  s_mov_b32 s23, 0x20000
  v_lshlrev_b32 v8, 4, v0
  s_mul_i32 s34, s33, 640
  buffer_load_dwordx4 v[16:19], v8, s[20:23], s34 offen
  v_lshrrev_b32 v9, 3, v2
  v_and_b32 v10, 7, v2
  v_lshrrev_b32 v11, 1, v9
  v_and_b32 v11, 1, v11
  s_and_b32 s36, s3, 1
  s_lshl_b32 s36, s36, 1
  v_or_b32 v11, s36, v11
  v_lshrrev_b32 v12, 1, v10
  v_xor_b32 v12, v12, v11
  v_and_b32 v13, 1, v10
  v_lshl_or_b32 v12, v12, 1, v13
  v_lshlrev_b32 v13, 4, v12
  v_mul_u32_u24 v14, 7680, v9
  v_add_u32 v13, v13, v14
  s_lshl_b32 s36, s32, 7
  s_mul_i32 s37, s33, 320*7680
  s_add_u32 s37, s37, s36
  s_mul_i32 s36, s3, 8*7680
  s_add_u32 s37, s37, s36
  s_lshl_b32 s38, s3, 10
  s_add_u32 s38, s38, 2048
  s_mov_b32 m0, s38
  s_add_u32 s38, s38, 4096
  buffer_load_dwordx4 v13, s[16:19], s37 offen nt lds
  s_add_u32 s37, s37, 245760
  s_mov_b32 m0, s38
  s_add_u32 s38, s38, 4096
  buffer_load_dwordx4 v13, s[16:19], s37 offen nt lds
  s_add_u32 s37, s37, 245760
  s_mov_b32 m0, s38
  s_add_u32 s38, s38, 4096
  buffer_load_dwordx4 v13, s[16:19], s37 offen nt lds
  s_add_u32 s37, s37, 245760
  s_mov_b32 m0, s38
  s_add_u32 s38, s38, 4096
  buffer_load_dwordx4 v13, s[16:19], s37 offen nt lds
  s_add_u32 s37, s37, 245760
  s_mov_b32 m0, s38
  s_add_u32 s38, s38, 4096
  buffer_load_dwordx4 v13, s[16:19], s37 offen nt lds
  s_add_u32 s37, s37, 245760
  s_mov_b32 m0, s38
  s_add_u32 s38, s38, 4096
  buffer_load_dwordx4 v13, s[16:19], s37 offen nt lds
  s_add_u32 s37, s37, 245760
  s_mov_b32 m0, s38
  s_add_u32 s38, s38, 4096
  buffer_load_dwordx4 v13, s[16:19], s37 offen nt lds
  s_add_u32 s37, s37, 245760
  s_mov_b32 m0, s38
  s_add_u32 s38, s38, 4096
  buffer_load_dwordx4 v13, s[16:19], s37 offen nt lds
  s_add_u32 s37, s37, 245760
  s_mov_b32 m0, s38
  s_add_u32 s38, s38, 4096
  buffer_load_dwordx4 v13, s[16:19], s37 offen nt lds
  s_add_u32 s37, s37, 245760
  s_mov_b32 m0, s38
  s_add_u32 s38, s38, 4096
  buffer_load_dwordx4 v13, s[16:19], s37 offen nt lds
  s_add_u32 s37, s37, 245760
  v_cmp_gt_u32 vcc, 40, v0
  s_and_saveexec_b64 s[48:49], vcc
  s_cbranch_execz L_k0_nosil
  s_waitcnt vmcnt(10)
  s_mov_b32 s36, 0xbfb8aa3b
  v_lshlrev_b32 v20, 16, v16
  v_and_b32 v21, 0xffff0000, v16
  v_lshlrev_b32 v22, 16, v17
  v_and_b32 v23, 0xffff0000, v17
  v_lshlrev_b32 v24, 16, v18
  v_and_b32 v25, 0xffff0000, v18
  v_lshlrev_b32 v26, 16, v19
  v_and_b32 v27, 0xffff0000, v19
  v_mul_f32 v30, s36, v20
  v_mul_f32 v31, s36, v21
  v_mul_f32 v32, s36, v22
  v_mul_f32 v33, s36, v23
  v_mul_f32 v34, s36, v24
  v_mul_f32 v35, s36, v25
  v_mul_f32 v36, s36, v26
  v_mul_f32 v37, s36, v27
  v_exp_f32 v30, v30
  v_exp_f32 v31, v31
  v_exp_f32 v32, v32
  v_exp_f32 v33, v33
  v_exp_f32 v34, v34
  v_exp_f32 v35, v35
  v_exp_f32 v36, v36
  v_exp_f32 v37, v37
  s_nop 0
  v_add_f32 v30, 1.0, v30
  v_add_f32 v31, 1.0, v31
  v_add_f32 v32, 1.0, v32
  v_add_f32 v33, 1.0, v33
  v_add_f32 v34, 1.0, v34
  v_add_f32 v35, 1.0, v35
  v_add_f32 v36, 1.0, v36
  v_add_f32 v37, 1.0, v37
  v_rcp_f32 v30, v30
  v_rcp_f32 v31, v31
  v_rcp_f32 v32, v32
  v_rcp_f32 v33, v33
  v_rcp_f32 v34, v34
  v_rcp_f32 v35, v35
  v_rcp_f32 v36, v36
  v_rcp_f32 v37, v37
  s_nop 0
  v_mul_f32 v20, v20, v30
  v_mul_f32 v21, v21, v31
  v_mul_f32 v22, v22, v32
  v_mul_f32 v23, v23, v33
  v_mul_f32 v24, v24, v34
  v_mul_f32 v25, v25, v35
  v_mul_f32 v26, v26, v36
  v_mul_f32 v27, v27, v37
  v_cvt_pk_bf16_f32 v16, v20, v21
  v_cvt_pk_bf16_f32 v17, v22, v23
  v_cvt_pk_bf16_f32 v18, v24, v25
  v_cvt_pk_bf16_f32 v19, v26, v27
  v_lshlrev_b32 v8, 4, v0
  ds_write_b128 v8, v[16:19] offset:0
L_k0_nosil:
  s_mov_b64 exec, s[48:49]
  s_waitcnt vmcnt(0) lgkmcnt(0)
  s_barrier
  v_lshrrev_b32 v8, 4, v2
  v_and_b32 v9, 15, v2
  v_lshrrev_b32 v10, 2, v9
  v_lshl_add_u32 v11, v8, 3, v10
  v_lshrrev_b32 v12, 1, v10
  v_and_b32 v12, 1, v12
  v_and_b32 v13, 1, v8
  v_lshl_or_b32 v12, v13, 1, v12
  v_xor_b32 v12, s3, v12
  v_lshlrev_b32 v12, 5, v12
  v_lshl_add_u32 v12, v11, 7, v12
  v_and_b32 v13, 3, v9
  v_lshl_add_u32 v12, v13, 3, v12
  v_add_u32 v12, 2048, v12
  v_lshlrev_b32 v13, 4, v8
  ds_read_b128 v[16:19], v13 offset:0
  ds_read_b64_tr_b16 v[20:21], v12 offset:0
  ds_read_b64_tr_b16 v[22:23], v12 offset:512
  s_waitcnt lgkmcnt(0)
  v_mfma_f32_16x16x32_bf16 v[40:43], v[16:19], v[20:23], 0
  ds_read_b128 v[24:27], v13 offset:64
  ds_read_b64_tr_b16 v[28:29], v12 offset:4096
  ds_read_b64_tr_b16 v[30:31], v12 offset:4608
  s_waitcnt lgkmcnt(0)
  v_mfma_f32_16x16x32_bf16 v[40:43], v[24:27], v[28:31], v[40:43]
  ds_read_b128 v[16:19], v13 offset:128
  ds_read_b64_tr_b16 v[20:21], v12 offset:8192
  ds_read_b64_tr_b16 v[22:23], v12 offset:8704
  s_waitcnt lgkmcnt(0)
  v_mfma_f32_16x16x32_bf16 v[40:43], v[16:19], v[20:23], v[40:43]
  ds_read_b128 v[24:27], v13 offset:192
  ds_read_b64_tr_b16 v[28:29], v12 offset:12288
  ds_read_b64_tr_b16 v[30:31], v12 offset:12800
  s_waitcnt lgkmcnt(0)
  v_mfma_f32_16x16x32_bf16 v[40:43], v[24:27], v[28:31], v[40:43]
  ds_read_b128 v[16:19], v13 offset:256
  ds_read_b64_tr_b16 v[20:21], v12 offset:16384
  ds_read_b64_tr_b16 v[22:23], v12 offset:16896
  s_waitcnt lgkmcnt(0)
  v_mfma_f32_16x16x32_bf16 v[40:43], v[16:19], v[20:23], v[40:43]
  ds_read_b128 v[24:27], v13 offset:320
  ds_read_b64_tr_b16 v[28:29], v12 offset:20480
  ds_read_b64_tr_b16 v[30:31], v12 offset:20992
  s_waitcnt lgkmcnt(0)
  v_mfma_f32_16x16x32_bf16 v[40:43], v[24:27], v[28:31], v[40:43]
  ds_read_b128 v[16:19], v13 offset:384
  ds_read_b64_tr_b16 v[20:21], v12 offset:24576
  ds_read_b64_tr_b16 v[22:23], v12 offset:25088
  s_waitcnt lgkmcnt(0)
  v_mfma_f32_16x16x32_bf16 v[40:43], v[16:19], v[20:23], v[40:43]
  ds_read_b128 v[24:27], v13 offset:448
  ds_read_b64_tr_b16 v[28:29], v12 offset:28672
  ds_read_b64_tr_b16 v[30:31], v12 offset:29184
  s_waitcnt lgkmcnt(0)
  v_mfma_f32_16x16x32_bf16 v[40:43], v[24:27], v[28:31], v[40:43]
  ds_read_b128 v[16:19], v13 offset:512
  ds_read_b64_tr_b16 v[20:21], v12 offset:32768
  ds_read_b64_tr_b16 v[22:23], v12 offset:33280
  s_waitcnt lgkmcnt(0)
  v_mfma_f32_16x16x32_bf16 v[40:43], v[16:19], v[20:23], v[40:43]
  ds_read_b128 v[24:27], v13 offset:576
  ds_read_b64_tr_b16 v[28:29], v12 offset:36864
  ds_read_b64_tr_b16 v[30:31], v12 offset:37376
  s_waitcnt lgkmcnt(0)
  v_mfma_f32_16x16x32_bf16 v[40:43], v[24:27], v[28:31], v[40:43]
  s_add_u32 s12, s4, 0x236c000
  s_addc_u32 s13, s5, 0
  s_and_b32 s13, s13, 0xffff
  s_mov_b32 s14, 0x7800
  s_mov_b32 s15, 0x20000
  s_nop 4
  s_mul_i32 s36, s33, 3840*4
  s_lshl_b32 s37, s32, 8
  s_add_u32 s36, s36, s37
  s_lshl_b32 s37, s3, 6
  s_add_u32 s36, s36, s37
  v_lshlrev_b32 v8, 2, v2
  s_mov_b64 exec, 0xffff
  buffer_store_dword v40, v8, s[12:15], s36 offen sc1
  s_mov_b64 exec, -1
  s_branch L_k0_fin
L_k0_w1:
  s_mov_b64 s[40:41], s[66:67]
  s_waitcnt lgkmcnt(0)
  s_mov_b32 s24, s40
  s_mov_b32 s25, s41
  s_and_b32 s25, s25, 0xffff
  s_mov_b32 s26, 0x258000
  s_mov_b32 s27, 0x20000
  s_add_u32 s12, s4, 0x284000
  s_addc_u32 s13, s5, 0
  s_and_b32 s13, s13, 0xffff
  s_mov_b32 s14, 0x280000
  s_mov_b32 s15, 0x20000
  s_mul_i32 s36, s32, 16*3840
  s_mul_i32 s37, s33, 320
  s_add_u32 s36, s36, s37
  s_mov_b32 s39, 0
L_k0_w1_loop:
  s_lshl_b32 s37, s39, 2
  s_add_u32 s37, s37, s3
  s_cmp_ge_u32 s37, 17
  s_cbranch_scc1 L_k0_w1_done
  s_lshl_b32 s38, s37, 6
  v_add_u32 v8, s38, v2
  s_mov_b32 s41, 61681
  v_mul_lo_u32 v9, v8, s41
  v_lshrrev_b32 v9, 22, v9
  v_mul_u32_u24 v10, 68, v9
  v_sub_u32 v10, v8, v10
  v_mul_u32_u24 v11, 3277, v10
  v_lshrrev_b32 v11, 16, v11
  v_mul_u32_u24 v12, 20, v11
  v_sub_u32 v12, v10, v12
  v_mul_u32_u24 v11, 1280, v11
  v_lshl_add_u32 v11, v12, 4, v11
  v_mul_u32_u24 v12, 3840, v9
  v_add_u32 v11, v11, v12
  s_movk_i32 s42, 60
  v_cmp_le_u32 vcc, s42, v10
  s_movk_i32 s42, 16
  v_cmp_le_u32 s[48:49], s42, v9
  s_or_b64 s[48:49], vcc, s[48:49]
  v_mov_b32 v12, 0x40000000
  s_lshl_b32 s38, s37, 10
  v_cndmask_b32 v11, v11, v12, s[48:49]
  s_add_u32 m0, s38, 0
  s_nop 0
  buffer_load_dwordx4 v11, s[24:27], s36 offen nt lds
  s_add_u32 s39, s39, 1
  s_branch L_k0_w1_loop
L_k0_w1_done:
  v_lshrrev_b32 v8, 5, v2
  v_lshrrev_b32 v11, 4, v2
  v_and_b32 v12, 15, v2
  v_lshrrev_b32 v13, 2, v12
  v_lshl_add_u32 v13, v8, 3, v13
  v_and_b32 v14, 3, v12
  v_and_b32 v15, 1, v11
  v_mul_u32_u24 v13, 1088, v13
  s_lshl_b32 s36, s33, 2
  s_add_u32 s36, s36, s3
  s_waitcnt vmcnt(0)
  s_barrier
  v_lshl_add_u32 v40, v15, 2, v14
  v_add_u32 v40, 0, v40
  s_lshl_b32 s37, s3, 1
  s_add_u32 s37, s37, 0
  s_mul_i32 s37, s37, 40
  v_lshlrev_b32 v41, 3, v40
  v_add_u32 v42, 272, v41
  v_add_u32 v43, 552, v41
  v_cmp_gt_u32 vcc, 11, v40
  s_nop 1
  v_cndmask_b32 v43, v43, v42, vcc
  v_cmp_gt_u32 vcc, 5, v40
  s_nop 1
  v_cndmask_b32 v43, v43, v41, vcc
  v_add_u32 v43, s37, v43
  v_cmp_eq_u32 vcc, 5, v40
  v_mov_b32 v41, 960
  s_nop 0
  v_cndmask_b32 v43, v43, v41, vcc
  v_add_u32 v43, v13, v43
  s_mul_i32 s50, s36, 160*1024
  s_lshl_b32 s39, s32, 12
  s_add_u32 s50, s50, s39
  s_add_u32 s50, s50, 0
  ds_read_b64_tr_b16 v[64:65], v43 offset:0
  ds_read_b64_tr_b16 v[66:67], v43 offset:4352
  v_lshl_add_u32 v40, v15, 2, v14
  v_add_u32 v40, 8, v40
  s_lshl_b32 s37, s3, 1
  s_add_u32 s37, s37, 0
  s_mul_i32 s37, s37, 40
  v_lshlrev_b32 v41, 3, v40
  v_add_u32 v42, 272, v41
  v_add_u32 v43, 552, v41
  v_cmp_gt_u32 vcc, 11, v40
  s_nop 1
  v_cndmask_b32 v43, v43, v42, vcc
  v_cmp_gt_u32 vcc, 5, v40
  s_nop 1
  v_cndmask_b32 v43, v43, v41, vcc
  v_add_u32 v43, s37, v43
  v_cmp_eq_u32 vcc, 5, v40
  v_mov_b32 v41, 960
  s_nop 0
  v_cndmask_b32 v43, v43, v41, vcc
  v_add_u32 v43, v13, v43
  s_mul_i32 s52, s36, 160*1024
  s_lshl_b32 s39, s32, 12
  s_add_u32 s52, s52, s39
  s_add_u32 s52, s52, 1024
  ds_read_b64_tr_b16 v[72:73], v43 offset:0
  ds_read_b64_tr_b16 v[74:75], v43 offset:4352
  v_lshl_add_u32 v40, v15, 2, v14
  v_add_u32 v40, 0, v40
  s_lshl_b32 s37, s3, 1
  s_add_u32 s37, s37, 1
  s_mul_i32 s37, s37, 40
  v_lshlrev_b32 v41, 3, v40
  v_add_u32 v42, 272, v41
  v_add_u32 v43, 552, v41
  v_cmp_gt_u32 vcc, 11, v40
  s_nop 1
  v_cndmask_b32 v43, v43, v42, vcc
  v_cmp_gt_u32 vcc, 5, v40
  s_nop 1
  v_cndmask_b32 v43, v43, v41, vcc
  v_add_u32 v43, s37, v43
  v_cmp_eq_u32 vcc, 5, v40
  v_mov_b32 v41, 960
  s_nop 0
  v_cndmask_b32 v43, v43, v41, vcc
  v_add_u32 v43, v13, v43
  s_mul_i32 s54, s36, 160*1024
  s_lshl_b32 s39, s32, 12
  s_add_u32 s54, s54, s39
  s_add_u32 s54, s54, 2048
  ds_read_b64_tr_b16 v[80:81], v43 offset:0
  ds_read_b64_tr_b16 v[82:83], v43 offset:4352
  v_lshl_add_u32 v40, v15, 2, v14
  v_add_u32 v40, 8, v40
  s_lshl_b32 s37, s3, 1
  s_add_u32 s37, s37, 1
  s_mul_i32 s37, s37, 40
  v_lshlrev_b32 v41, 3, v40
  v_add_u32 v42, 272, v41
  v_add_u32 v43, 552, v41
  v_cmp_gt_u32 vcc, 11, v40
  s_nop 1
  v_cndmask_b32 v43, v43, v42, vcc
  v_cmp_gt_u32 vcc, 5, v40
  s_nop 1
  v_cndmask_b32 v43, v43, v41, vcc
  v_add_u32 v43, s37, v43
  v_cmp_eq_u32 vcc, 5, v40
  v_mov_b32 v41, 960
  s_nop 0
  v_cndmask_b32 v43, v43, v41, vcc
  v_add_u32 v43, v13, v43
  s_mul_i32 s56, s36, 160*1024
  s_lshl_b32 s39, s32, 12
  s_add_u32 s56, s56, s39
  s_add_u32 s56, s56, 3072
  ds_read_b64_tr_b16 v[88:89], v43 offset:0
  ds_read_b64_tr_b16 v[90:91], v43 offset:4352
  s_waitcnt lgkmcnt(0)
  buffer_store_dwordx4 v[64:67], v3, s[12:15], s50 offen sc1
  buffer_store_dwordx4 v[72:75], v3, s[12:15], s52 offen sc1
  buffer_store_dwordx4 v[80:83], v3, s[12:15], s54 offen sc1
  buffer_store_dwordx4 v[88:91], v3, s[12:15], s56 offen sc1
  s_branch L_k0_fin
L_k0_w2:
  s_mov_b64 s[40:41], s[72:73]
  s_mov_b64 s[42:43], s[74:75]
  s_waitcnt lgkmcnt(0)
  s_mov_b32 s24, s40
  s_mov_b32 s25, s41
  s_and_b32 s25, s25, 0xffff
  s_mov_b32 s26, 0x1e0000
  s_mov_b32 s27, 0x20000
  s_mov_b32 s44, s42
  s_mov_b32 s45, s43
  s_and_b32 s45, s45, 0xffff
  s_mov_b32 s46, 0x1e0000
  s_mov_b32 s47, 0x20000
  s_add_u32 s12, s4, 0x504000
  s_addc_u32 s13, s5, 0
  s_and_b32 s13, s13, 0xffff
  s_mov_b32 s14, 0x3c0000
  s_mov_b32 s15, 0x20000
  s_mul_i32 s36, s32, 16*3072
  s_mul_i32 s37, s33, 768
  s_add_u32 s36, s36, s37
  s_mov_b32 s39, 0
L_k0_w2_loop:
  s_lshl_b32 s37, s39, 2
  s_add_u32 s37, s37, s3
  s_cmp_ge_u32 s37, 25
  s_cbranch_scc1 L_k0_w2_done
  s_lshl_b32 s38, s37, 6
  v_add_u32 v8, s38, v2
  s_mov_b32 s41, 41944
  v_mul_lo_u32 v9, v8, s41
  v_lshrrev_b32 v9, 22, v9
  v_mul_u32_u24 v10, 100, v9
  v_sub_u32 v10, v8, v10
  v_cmp_le_u32 s[50:51], 48, v10
  v_subrev_u32 v12, 48, v10
  s_nop 0
  v_cndmask_b32 v11, v10, v12, s[50:51]
  v_mul_u32_u24 v12, 3072, v9
  v_lshl_add_u32 v11, v11, 4, v12
  s_movk_i32 s42, 96
  v_cmp_le_u32 vcc, s42, v10
  s_movk_i32 s42, 16
  v_cmp_le_u32 s[48:49], s42, v9
  s_or_b64 s[48:49], vcc, s[48:49]
  v_mov_b32 v12, 0x40000000
  s_lshl_b32 s38, s37, 10
  v_cndmask_b32 v11, v11, v12, s[48:49]
  s_add_u32 m0, s38, 0
  s_nop 0
  s_andn2_b64 exec, exec, s[50:51]
  buffer_load_dwordx4 v11, s[24:27], s36 offen nt lds
  s_mov_b64 exec, s[50:51]
  buffer_load_dwordx4 v11, s[44:47], s36 offen nt lds
  s_mov_b64 exec, -1
  s_add_u32 s39, s39, 1
  s_branch L_k0_w2_loop
L_k0_w2_done:
  v_lshrrev_b32 v8, 5, v2
  v_lshrrev_b32 v11, 4, v2
  v_and_b32 v12, 15, v2
  v_lshrrev_b32 v13, 2, v12
  v_lshl_add_u32 v13, v8, 3, v13
  v_and_b32 v14, 3, v12
  v_and_b32 v15, 1, v11
  v_mul_u32_u24 v13, 1600, v13
  v_lshrrev_b32 v40, 1, v14
  v_mul_u32_u24 v40, 768, v40
  v_and_b32 v41, 1, v14
  v_lshlrev_b32 v41, 3, v41
  v_lshl_add_u32 v41, v15, 4, v41
  v_add3_u32 v13, v13, v40, v41
  s_mul_i32 s36, s3, 192
  v_add_u32 v13, s36, v13
  s_lshl_b32 s40, s33, 2
  s_add_u32 s40, s40, s3
  s_mul_i32 s38, s40, 240*1024
  s_mul_i32 s39, s32, 6144
  s_add_u32 s38, s38, s39
  s_waitcnt vmcnt(0)
  s_barrier
  v_add_u32 v43, 0, v13
  s_add_u32 s50, s38, 0
  s_add_u32 s51, s50, 6144
  ds_read_b64_tr_b16 v[64:65], v43 offset:0
  ds_read_b64_tr_b16 v[66:67], v43 offset:6400
  v_add_u32 v43, 32, v13
  s_add_u32 s52, s38, 1024
  s_add_u32 s53, s52, 6144
  ds_read_b64_tr_b16 v[72:73], v43 offset:0
  ds_read_b64_tr_b16 v[74:75], v43 offset:6400
  v_add_u32 v43, 64, v13
  s_add_u32 s54, s38, 2048
  s_add_u32 s55, s54, 6144
  ds_read_b64_tr_b16 v[80:81], v43 offset:0
  ds_read_b64_tr_b16 v[82:83], v43 offset:6400
  v_add_u32 v43, 96, v13
  s_add_u32 s56, s38, 3072
  s_add_u32 s57, s56, 6144
  ds_read_b64_tr_b16 v[88:89], v43 offset:0
  ds_read_b64_tr_b16 v[90:91], v43 offset:6400
  v_add_u32 v43, 128, v13
  s_add_u32 s58, s38, 4096
  s_add_u32 s59, s58, 6144
  ds_read_b64_tr_b16 v[96:97], v43 offset:0
  ds_read_b64_tr_b16 v[98:99], v43 offset:6400
  v_add_u32 v43, 160, v13
  s_add_u32 s60, s38, 5120
  s_add_u32 s61, s60, 6144
  ds_read_b64_tr_b16 v[104:105], v43 offset:0
  ds_read_b64_tr_b16 v[106:107], v43 offset:6400
  s_waitcnt lgkmcnt(0)
  buffer_store_dwordx4 v[64:67], v3, s[12:15], s50 offen sc1
  buffer_store_dwordx4 v[72:75], v3, s[12:15], s52 offen sc1
  buffer_store_dwordx4 v[80:83], v3, s[12:15], s54 offen sc1
  buffer_store_dwordx4 v[88:91], v3, s[12:15], s56 offen sc1
  buffer_store_dwordx4 v[96:99], v3, s[12:15], s58 offen sc1
  buffer_store_dwordx4 v[104:107], v3, s[12:15], s60 offen sc1
  s_branch L_k0_fin
L_k0_xn:
  s_mov_b64 s[40:41], s[64:65]
  s_waitcnt lgkmcnt(0)
  s_mov_b32 s16, s40
  s_mov_b32 s17, s41
  s_and_b32 s17, s17, 0xffff
  s_mov_b32 s18, 0x280000
  s_mov_b32 s19, 0x20000
  s_add_u32 s12, s4, 0x4000
  s_addc_u32 s13, s5, 0
  s_and_b32 s13, s13, 0xffff
  s_mov_b32 s14, 0x280000
  s_mov_b32 s15, 0x20000
  s_mul_i32 s36, s32, 32*1280
  s_mov_b32 s39, 0
L_k0_xn_loop:
  s_lshl_b32 s37, s39, 2
  s_add_u32 s37, s37, s3
  s_cmp_ge_u32 s37, 41
  s_cbranch_scc1 L_k0_xn_done
  s_lshl_b32 s38, s37, 6
  v_add_u32 v8, s38, v2
  s_mov_b32 s41, 51782
  v_mul_lo_u32 v9, v8, s41
  v_lshrrev_b32 v9, 22, v9
  v_mul_u32_u24 v10, 81, v9
  v_sub_u32 v10, v8, v10
  v_mul_u32_u24 v11, 1280, v9
  v_lshl_add_u32 v11, v10, 4, v11
  s_movk_i32 s42, 80
  v_cmp_le_u32 vcc, s42, v10
  s_movk_i32 s42, 32
  v_cmp_le_u32 s[48:49], s42, v9
  s_or_b64 s[48:49], vcc, s[48:49]
  v_mov_b32 v12, 0x40000000
  s_lshl_b32 s38, s37, 10
  v_cndmask_b32 v11, v11, v12, s[48:49]
  s_add_u32 m0, s38, 0
  s_nop 0
  buffer_load_dwordx4 v11, s[16:19], s36 offen nt lds
  s_add_u32 s39, s39, 1
  s_branch L_k0_xn_loop
L_k0_xn_done:
  v_and_b32 v8, 31, v2
  v_lshrrev_b32 v9, 5, v2
  v_mul_u32_u24 v10, 1296, v8
  v_lshl_add_u32 v10, v9, 4, v10
  s_mul_i32 s37, s3, 320
  v_add_u32 v10, s37, v10
  s_waitcnt vmcnt(0)
  s_barrier
  ds_read_b128 v[16:19], v10 offset:0
  ds_read_b128 v[20:23], v10 offset:32
  ds_read_b128 v[24:27], v10 offset:64
  ds_read_b128 v[28:31], v10 offset:96
  ds_read_b128 v[32:35], v10 offset:128
  ds_read_b128 v[36:39], v10 offset:160
  ds_read_b128 v[40:43], v10 offset:192
  ds_read_b128 v[44:47], v10 offset:224
  ds_read_b128 v[48:51], v10 offset:256
  ds_read_b128 v[52:55], v10 offset:288
  v_mov_b32 v14, 0
  v_mov_b32 v15, 0
  v_mov_b32 v12, 0
  v_mov_b32 v9, 0
  v_mov_b32 v13, 0x3f803f80
  s_waitcnt lgkmcnt(9)
  v_dot2c_f32_bf16 v14, v16, v13
  v_dot2c_f32_bf16 v15, v16, v16
  v_dot2c_f32_bf16 v12, v17, v13
  v_dot2c_f32_bf16 v9, v17, v17
  v_dot2c_f32_bf16 v14, v18, v13
  v_dot2c_f32_bf16 v15, v18, v18
  v_dot2c_f32_bf16 v12, v19, v13
  v_dot2c_f32_bf16 v9, v19, v19
  s_waitcnt lgkmcnt(8)
  v_dot2c_f32_bf16 v14, v20, v13
  v_dot2c_f32_bf16 v15, v20, v20
  v_dot2c_f32_bf16 v12, v21, v13
  v_dot2c_f32_bf16 v9, v21, v21
  v_dot2c_f32_bf16 v14, v22, v13
  v_dot2c_f32_bf16 v15, v22, v22
  v_dot2c_f32_bf16 v12, v23, v13
  v_dot2c_f32_bf16 v9, v23, v23
  s_waitcnt lgkmcnt(7)
  v_dot2c_f32_bf16 v14, v24, v13
  v_dot2c_f32_bf16 v15, v24, v24
  v_dot2c_f32_bf16 v12, v25, v13
  v_dot2c_f32_bf16 v9, v25, v25
  v_dot2c_f32_bf16 v14, v26, v13
  v_dot2c_f32_bf16 v15, v26, v26
  v_dot2c_f32_bf16 v12, v27, v13
  v_dot2c_f32_bf16 v9, v27, v27
  s_waitcnt lgkmcnt(6)
  v_dot2c_f32_bf16 v14, v28, v13
  v_dot2c_f32_bf16 v15, v28, v28
  v_dot2c_f32_bf16 v12, v29, v13
  v_dot2c_f32_bf16 v9, v29, v29
  v_dot2c_f32_bf16 v14, v30, v13
  v_dot2c_f32_bf16 v15, v30, v30
  v_dot2c_f32_bf16 v12, v31, v13
  v_dot2c_f32_bf16 v9, v31, v31
  s_waitcnt lgkmcnt(5)
  v_dot2c_f32_bf16 v14, v32, v13
  v_dot2c_f32_bf16 v15, v32, v32
  v_dot2c_f32_bf16 v12, v33, v13
  v_dot2c_f32_bf16 v9, v33, v33
  v_dot2c_f32_bf16 v14, v34, v13
  v_dot2c_f32_bf16 v15, v34, v34
  v_dot2c_f32_bf16 v12, v35, v13
  v_dot2c_f32_bf16 v9, v35, v35
  s_waitcnt lgkmcnt(4)
  v_dot2c_f32_bf16 v14, v36, v13
  v_dot2c_f32_bf16 v15, v36, v36
  v_dot2c_f32_bf16 v12, v37, v13
  v_dot2c_f32_bf16 v9, v37, v37
  v_dot2c_f32_bf16 v14, v38, v13
  v_dot2c_f32_bf16 v15, v38, v38
  v_dot2c_f32_bf16 v12, v39, v13
  v_dot2c_f32_bf16 v9, v39, v39
  s_waitcnt lgkmcnt(3)
  v_dot2c_f32_bf16 v14, v40, v13
  v_dot2c_f32_bf16 v15, v40, v40
  v_dot2c_f32_bf16 v12, v41, v13
  v_dot2c_f32_bf16 v9, v41, v41
  v_dot2c_f32_bf16 v14, v42, v13
  v_dot2c_f32_bf16 v15, v42, v42
  v_dot2c_f32_bf16 v12, v43, v13
  v_dot2c_f32_bf16 v9, v43, v43
  s_waitcnt lgkmcnt(2)
  v_dot2c_f32_bf16 v14, v44, v13
  v_dot2c_f32_bf16 v15, v44, v44
  v_dot2c_f32_bf16 v12, v45, v13
  v_dot2c_f32_bf16 v9, v45, v45
  v_dot2c_f32_bf16 v14, v46, v13
  v_dot2c_f32_bf16 v15, v46, v46
  v_dot2c_f32_bf16 v12, v47, v13
  v_dot2c_f32_bf16 v9, v47, v47
  s_waitcnt lgkmcnt(1)
  v_dot2c_f32_bf16 v14, v48, v13
  v_dot2c_f32_bf16 v15, v48, v48
  v_dot2c_f32_bf16 v12, v49, v13
  v_dot2c_f32_bf16 v9, v49, v49
  v_dot2c_f32_bf16 v14, v50, v13
  v_dot2c_f32_bf16 v15, v50, v50
  v_dot2c_f32_bf16 v12, v51, v13
  v_dot2c_f32_bf16 v9, v51, v51
  s_waitcnt lgkmcnt(0)
  v_dot2c_f32_bf16 v14, v52, v13
  v_dot2c_f32_bf16 v15, v52, v52
  v_dot2c_f32_bf16 v12, v53, v13
  v_dot2c_f32_bf16 v9, v53, v53
  v_dot2c_f32_bf16 v14, v54, v13
  v_dot2c_f32_bf16 v15, v54, v54
  v_dot2c_f32_bf16 v12, v55, v13
  v_dot2c_f32_bf16 v9, v55, v55
  s_nop 2
  v_add_f32 v14, v14, v12
  v_add_f32 v15, v15, v9
  v_mov_b32 v12, v14
  v_mov_b32 v9, v15
  s_nop 1
  v_permlane32_swap_b32 v14, v12
  v_permlane32_swap_b32 v15, v9
  s_nop 1
  v_add_f32 v14, v14, v12
  v_add_f32 v15, v15, v9
  v_lshlrev_b32 v11, 3, v8
  s_lshl_b32 s37, s3, 8
  v_add_u32 v12, s37, v11
  ds_write_b64 v12, v[14:15] offset:45056
  s_waitcnt lgkmcnt(0)
  s_barrier
  ds_read_b64 v[56:57], v11 offset:45056
  ds_read_b64 v[58:59], v11 offset:45312
  ds_read_b64 v[60:61], v11 offset:45568
  ds_read_b64 v[62:63], v11 offset:45824
  s_waitcnt lgkmcnt(0)
  v_pk_add_f32 v[56:57], v[56:57], v[58:59]
  v_pk_add_f32 v[60:61], v[60:61], v[62:63]
  v_pk_add_f32 v[56:57], v[56:57], v[60:61]
  v_mul_f32 v14, 0x3acccccd, v56
  v_mul_f32 v15, 0x3acccccd, v57
  v_fma_f32 v15, -v14, v14, v15
  v_max_f32 v15, 0, v15
  v_add_f32 v15, 0x3727c5ac, v15
  v_rsq_f32 v6, v15
  s_nop 0
  v_mov_b32 v7, v6
  v_mul_f32 v4, v14, v6
  v_sub_f32 v4, 0, v4
  v_mov_b32 v5, v4
  v_lshlrev_b32 v64, 16, v16
  v_and_b32 v65, 0xffff0000, v16
  v_lshlrev_b32 v66, 16, v17
  v_and_b32 v67, 0xffff0000, v17
  v_lshlrev_b32 v68, 16, v18
  v_and_b32 v69, 0xffff0000, v18
  v_lshlrev_b32 v70, 16, v19
  v_and_b32 v71, 0xffff0000, v19
  v_pk_fma_f32 v[64:65], v[64:65], v[6:7], v[4:5]
  v_pk_fma_f32 v[66:67], v[66:67], v[6:7], v[4:5]
  v_pk_fma_f32 v[68:69], v[68:69], v[6:7], v[4:5]
  v_pk_fma_f32 v[70:71], v[70:71], v[6:7], v[4:5]
  v_cvt_pk_bf16_f32 v16, v64, v65
  v_cvt_pk_bf16_f32 v17, v66, v67
  v_cvt_pk_bf16_f32 v18, v68, v69
  v_cvt_pk_bf16_f32 v19, v70, v71
  s_mul_i32 s37, s32, 40
  s_mul_i32 s38, s3, 10
  s_add_u32 s37, s37, s38
  s_add_u32 s37, s37, 0
  s_lshl_b32 s37, s37, 10
  buffer_store_dwordx4 v[16:19], v3, s[12:15], s37 offen sc1
  v_lshlrev_b32 v64, 16, v20
  v_and_b32 v65, 0xffff0000, v20
  v_lshlrev_b32 v66, 16, v21
  v_and_b32 v67, 0xffff0000, v21
  v_lshlrev_b32 v68, 16, v22
  v_and_b32 v69, 0xffff0000, v22
  v_lshlrev_b32 v70, 16, v23
  v_and_b32 v71, 0xffff0000, v23
  v_pk_fma_f32 v[64:65], v[64:65], v[6:7], v[4:5]
  v_pk_fma_f32 v[66:67], v[66:67], v[6:7], v[4:5]
  v_pk_fma_f32 v[68:69], v[68:69], v[6:7], v[4:5]
  v_pk_fma_f32 v[70:71], v[70:71], v[6:7], v[4:5]
  v_cvt_pk_bf16_f32 v20, v64, v65
  v_cvt_pk_bf16_f32 v21, v66, v67
  v_cvt_pk_bf16_f32 v22, v68, v69
  v_cvt_pk_bf16_f32 v23, v70, v71
  s_mul_i32 s37, s32, 40
  s_mul_i32 s38, s3, 10
  s_add_u32 s37, s37, s38
  s_add_u32 s37, s37, 1
  s_lshl_b32 s37, s37, 10
  buffer_store_dwordx4 v[20:23], v3, s[12:15], s37 offen sc1
  v_lshlrev_b32 v64, 16, v24
  v_and_b32 v65, 0xffff0000, v24
  v_lshlrev_b32 v66, 16, v25
  v_and_b32 v67, 0xffff0000, v25
  v_lshlrev_b32 v68, 16, v26
  v_and_b32 v69, 0xffff0000, v26
  v_lshlrev_b32 v70, 16, v27
  v_and_b32 v71, 0xffff0000, v27
  v_pk_fma_f32 v[64:65], v[64:65], v[6:7], v[4:5]
  v_pk_fma_f32 v[66:67], v[66:67], v[6:7], v[4:5]
  v_pk_fma_f32 v[68:69], v[68:69], v[6:7], v[4:5]
  v_pk_fma_f32 v[70:71], v[70:71], v[6:7], v[4:5]
  v_cvt_pk_bf16_f32 v24, v64, v65
  v_cvt_pk_bf16_f32 v25, v66, v67
  v_cvt_pk_bf16_f32 v26, v68, v69
  v_cvt_pk_bf16_f32 v27, v70, v71
  s_mul_i32 s37, s32, 40
  s_mul_i32 s38, s3, 10
  s_add_u32 s37, s37, s38
  s_add_u32 s37, s37, 2
  s_lshl_b32 s37, s37, 10
  buffer_store_dwordx4 v[24:27], v3, s[12:15], s37 offen sc1
  v_lshlrev_b32 v64, 16, v28
  v_and_b32 v65, 0xffff0000, v28
  v_lshlrev_b32 v66, 16, v29
  v_and_b32 v67, 0xffff0000, v29
  v_lshlrev_b32 v68, 16, v30
  v_and_b32 v69, 0xffff0000, v30
  v_lshlrev_b32 v70, 16, v31
  v_and_b32 v71, 0xffff0000, v31
  v_pk_fma_f32 v[64:65], v[64:65], v[6:7], v[4:5]
  v_pk_fma_f32 v[66:67], v[66:67], v[6:7], v[4:5]
  v_pk_fma_f32 v[68:69], v[68:69], v[6:7], v[4:5]
  v_pk_fma_f32 v[70:71], v[70:71], v[6:7], v[4:5]
  v_cvt_pk_bf16_f32 v28, v64, v65
  v_cvt_pk_bf16_f32 v29, v66, v67
  v_cvt_pk_bf16_f32 v30, v68, v69
  v_cvt_pk_bf16_f32 v31, v70, v71
  s_mul_i32 s37, s32, 40
  s_mul_i32 s38, s3, 10
  s_add_u32 s37, s37, s38
  s_add_u32 s37, s37, 3
  s_lshl_b32 s37, s37, 10
  buffer_store_dwordx4 v[28:31], v3, s[12:15], s37 offen sc1
  v_lshlrev_b32 v64, 16, v32
  v_and_b32 v65, 0xffff0000, v32
  v_lshlrev_b32 v66, 16, v33
  v_and_b32 v67, 0xffff0000, v33
  v_lshlrev_b32 v68, 16, v34
  v_and_b32 v69, 0xffff0000, v34
  v_lshlrev_b32 v70, 16, v35
  v_and_b32 v71, 0xffff0000, v35
  v_pk_fma_f32 v[64:65], v[64:65], v[6:7], v[4:5]
  v_pk_fma_f32 v[66:67], v[66:67], v[6:7], v[4:5]
  v_pk_fma_f32 v[68:69], v[68:69], v[6:7], v[4:5]
  v_pk_fma_f32 v[70:71], v[70:71], v[6:7], v[4:5]
  v_cvt_pk_bf16_f32 v32, v64, v65
  v_cvt_pk_bf16_f32 v33, v66, v67
  v_cvt_pk_bf16_f32 v34, v68, v69
  v_cvt_pk_bf16_f32 v35, v70, v71
  s_mul_i32 s37, s32, 40
  s_mul_i32 s38, s3, 10
  s_add_u32 s37, s37, s38
  s_add_u32 s37, s37, 4
  s_lshl_b32 s37, s37, 10
  buffer_store_dwordx4 v[32:35], v3, s[12:15], s37 offen sc1
  v_lshlrev_b32 v64, 16, v36
  v_and_b32 v65, 0xffff0000, v36
  v_lshlrev_b32 v66, 16, v37
  v_and_b32 v67, 0xffff0000, v37
  v_lshlrev_b32 v68, 16, v38
  v_and_b32 v69, 0xffff0000, v38
  v_lshlrev_b32 v70, 16, v39
  v_and_b32 v71, 0xffff0000, v39
  v_pk_fma_f32 v[64:65], v[64:65], v[6:7], v[4:5]
  v_pk_fma_f32 v[66:67], v[66:67], v[6:7], v[4:5]
  v_pk_fma_f32 v[68:69], v[68:69], v[6:7], v[4:5]
  v_pk_fma_f32 v[70:71], v[70:71], v[6:7], v[4:5]
  v_cvt_pk_bf16_f32 v36, v64, v65
  v_cvt_pk_bf16_f32 v37, v66, v67
  v_cvt_pk_bf16_f32 v38, v68, v69
  v_cvt_pk_bf16_f32 v39, v70, v71
  s_mul_i32 s37, s32, 40
  s_mul_i32 s38, s3, 10
  s_add_u32 s37, s37, s38
  s_add_u32 s37, s37, 5
  s_lshl_b32 s37, s37, 10
  buffer_store_dwordx4 v[36:39], v3, s[12:15], s37 offen sc1
  v_lshlrev_b32 v64, 16, v40
  v_and_b32 v65, 0xffff0000, v40
  v_lshlrev_b32 v66, 16, v41
  v_and_b32 v67, 0xffff0000, v41
  v_lshlrev_b32 v68, 16, v42
  v_and_b32 v69, 0xffff0000, v42
  v_lshlrev_b32 v70, 16, v43
  v_and_b32 v71, 0xffff0000, v43
  v_pk_fma_f32 v[64:65], v[64:65], v[6:7], v[4:5]
  v_pk_fma_f32 v[66:67], v[66:67], v[6:7], v[4:5]
  v_pk_fma_f32 v[68:69], v[68:69], v[6:7], v[4:5]
  v_pk_fma_f32 v[70:71], v[70:71], v[6:7], v[4:5]
  v_cvt_pk_bf16_f32 v40, v64, v65
  v_cvt_pk_bf16_f32 v41, v66, v67
  v_cvt_pk_bf16_f32 v42, v68, v69
  v_cvt_pk_bf16_f32 v43, v70, v71
  s_mul_i32 s37, s32, 40
  s_mul_i32 s38, s3, 10
  s_add_u32 s37, s37, s38
  s_add_u32 s37, s37, 6
  s_lshl_b32 s37, s37, 10
  buffer_store_dwordx4 v[40:43], v3, s[12:15], s37 offen sc1
  v_lshlrev_b32 v64, 16, v44
  v_and_b32 v65, 0xffff0000, v44
  v_lshlrev_b32 v66, 16, v45
  v_and_b32 v67, 0xffff0000, v45
  v_lshlrev_b32 v68, 16, v46
  v_and_b32 v69, 0xffff0000, v46
  v_lshlrev_b32 v70, 16, v47
  v_and_b32 v71, 0xffff0000, v47
  v_pk_fma_f32 v[64:65], v[64:65], v[6:7], v[4:5]
  v_pk_fma_f32 v[66:67], v[66:67], v[6:7], v[4:5]
  v_pk_fma_f32 v[68:69], v[68:69], v[6:7], v[4:5]
  v_pk_fma_f32 v[70:71], v[70:71], v[6:7], v[4:5]
  v_cvt_pk_bf16_f32 v44, v64, v65
  v_cvt_pk_bf16_f32 v45, v66, v67
  v_cvt_pk_bf16_f32 v46, v68, v69
  v_cvt_pk_bf16_f32 v47, v70, v71
  s_mul_i32 s37, s32, 40
  s_mul_i32 s38, s3, 10
  s_add_u32 s37, s37, s38
  s_add_u32 s37, s37, 7
  s_lshl_b32 s37, s37, 10
  buffer_store_dwordx4 v[44:47], v3, s[12:15], s37 offen sc1
  v_lshlrev_b32 v64, 16, v48
  v_and_b32 v65, 0xffff0000, v48
  v_lshlrev_b32 v66, 16, v49
  v_and_b32 v67, 0xffff0000, v49
  v_lshlrev_b32 v68, 16, v50
  v_and_b32 v69, 0xffff0000, v50
  v_lshlrev_b32 v70, 16, v51
  v_and_b32 v71, 0xffff0000, v51
  v_pk_fma_f32 v[64:65], v[64:65], v[6:7], v[4:5]
  v_pk_fma_f32 v[66:67], v[66:67], v[6:7], v[4:5]
  v_pk_fma_f32 v[68:69], v[68:69], v[6:7], v[4:5]
  v_pk_fma_f32 v[70:71], v[70:71], v[6:7], v[4:5]
  v_cvt_pk_bf16_f32 v48, v64, v65
  v_cvt_pk_bf16_f32 v49, v66, v67
  v_cvt_pk_bf16_f32 v50, v68, v69
  v_cvt_pk_bf16_f32 v51, v70, v71
  s_mul_i32 s37, s32, 40
  s_mul_i32 s38, s3, 10
  s_add_u32 s37, s37, s38
  s_add_u32 s37, s37, 8
  s_lshl_b32 s37, s37, 10
  buffer_store_dwordx4 v[48:51], v3, s[12:15], s37 offen sc1
  v_lshlrev_b32 v64, 16, v52
  v_and_b32 v65, 0xffff0000, v52
  v_lshlrev_b32 v66, 16, v53
  v_and_b32 v67, 0xffff0000, v53
  v_lshlrev_b32 v68, 16, v54
  v_and_b32 v69, 0xffff0000, v54
  v_lshlrev_b32 v70, 16, v55
  v_and_b32 v71, 0xffff0000, v55
  v_pk_fma_f32 v[64:65], v[64:65], v[6:7], v[4:5]
  v_pk_fma_f32 v[66:67], v[66:67], v[6:7], v[4:5]
  v_pk_fma_f32 v[68:69], v[68:69], v[6:7], v[4:5]
  v_pk_fma_f32 v[70:71], v[70:71], v[6:7], v[4:5]
  v_cvt_pk_bf16_f32 v52, v64, v65
  v_cvt_pk_bf16_f32 v53, v66, v67
  v_cvt_pk_bf16_f32 v54, v68, v69
  v_cvt_pk_bf16_f32 v55, v70, v71
  s_mul_i32 s37, s32, 40
  s_mul_i32 s38, s3, 10
  s_add_u32 s37, s37, s38
  s_add_u32 s37, s37, 9
  s_lshl_b32 s37, s37, 10
  buffer_store_dwordx4 v[52:55], v3, s[12:15], s37 offen sc1
  s_branch L_k0_fin
L_k0_tb:
  s_mov_b64 s[40:41], s[76:77]
  s_mov_b64 s[42:43], s[68:69]
  s_waitcnt lgkmcnt(0)
  s_cmp_eq_u32 s31, 5
  s_cselect_b32 s40, s40, s42
  s_cselect_b32 s41, s41, s43
  s_cselect_b32 s34, 32, 40
  s_mov_b32 s35, 819200
  s_cselect_b32 s35, 1966080, s35
  s_mov_b32 s16, s40
  s_and_b32 s17, s41, 0xffff
  s_mov_b32 s18, s35
  s_mov_b32 s19, 0x20000
  s_mul_i32 s36, s32, s34
  s_mul_i32 s36, s36, 1280
  s_mul_i32 s37, s33, 640
  s_add_u32 s36, s36, s37
  s_mov_b32 s39, 0
L_k0_tb_loop:
  s_lshl_b32 s37, s39, 2
  s_add_u32 s37, s37, s3
  s_cmp_ge_u32 s37, 32
  s_cbranch_scc1 L_k0_tb_done
  s_lshl_b32 s38, s37, 6
  v_add_u32 v8, s38, v2
  s_mov_b32 s41, 83887
  v_mul_lo_u32 v9, v8, s41
  v_lshrrev_b32 v9, 22, v9
  v_mul_u32_u24 v10, 50, v9
  v_sub_u32 v10, v8, v10
  v_mul_u32_u24 v11, 1280, v9
  v_lshl_add_u32 v11, v10, 4, v11
  v_cmp_le_u32 s[50:51], s34, v9
  v_mov_b32 v12, 0x40000000
  s_nop 0
  v_cndmask_b32 v11, v11, v12, s[50:51]
  s_movk_i32 s42, 40
  v_cmp_le_u32 vcc, s42, v10
  s_movk_i32 s42, 40
  v_cmp_le_u32 s[48:49], s42, v9
  s_or_b64 s[48:49], vcc, s[48:49]
  v_mov_b32 v12, 0x40000000
  s_lshl_b32 s38, s37, 10
  v_cndmask_b32 v11, v11, v12, s[48:49]
  s_add_u32 m0, s38, 0
  s_nop 0
  buffer_load_dwordx4 v11, s[16:19], s36 offen nt lds
  s_add_u32 s39, s39, 1
  s_branch L_k0_tb_loop
L_k0_tb_done:
  v_lshrrev_b32 v8, 4, v2
  v_and_b32 v9, 15, v2
  v_lshrrev_b32 v10, 2, v9
  v_and_b32 v11, 3, v9
  v_lshlrev_b32 v11, 3, v11
  s_mul_i32 s37, s3, 160
  v_add_u32 v11, s37, v11
  s_lshl_b32 s35, s33, 2
  s_add_u32 s35, s35, s3
  v_lshlrev_b32 v12, 4, v9
  s_waitcnt vmcnt(0)
  s_barrier
  s_cmp_eq_u32 s31, 6
  s_cbranch_scc1 L_k0_wo
  s_add_u32 s12, s4, 0x994000
  s_addc_u32 s13, s5, 0
  s_and_b32 s13, s13, 0xffff
  s_mov_b32 s14, 0x1e0000
  s_mov_b32 s15, 0x20000
  v_lshrrev_b32 v13, 1, v8
  v_lshlrev_b32 v13, 4, v13
  v_and_b32 v14, 1, v8
  v_lshl_add_u32 v13, v14, 2, v13
  v_add_u32 v13, v13, v10
  v_mul_u32_u24 v13, 800, v13
  v_add_u32 v13, v13, v11
  s_mov_b32 s40, s32
  s_cmp_ge_u32 s40, 24
  s_cselect_b32 s56, 24, 0
  s_cselect_b32 s57, 2, 0
  s_sub_u32 s40, s40, s56
  s_lshr_b32 s56, s40, 1
  s_lshl_b32 s56, s56, 2
  s_and_b32 s40, s40, 1
  s_add_u32 s40, s40, s56
  s_add_u32 s40, s40, s57
  s_mul_i32 s40, s40, 5120
  s_mul_i32 s41, s35, 240*1024
  s_add_u32 s40, s40, s41
  ds_read_b64_tr_b16 v[16:17], v13 offset:0
  ds_read_b64_tr_b16 v[18:19], v13 offset:6400
  ds_read_b64_tr_b16 v[20:21], v13 offset:32
  ds_read_b64_tr_b16 v[22:23], v13 offset:6432
  ds_read_b64_tr_b16 v[24:25], v13 offset:64
  ds_read_b64_tr_b16 v[26:27], v13 offset:6464
  ds_read_b64_tr_b16 v[28:29], v13 offset:96
  ds_read_b64_tr_b16 v[30:31], v13 offset:6496
  ds_read_b64_tr_b16 v[32:33], v13 offset:128
  ds_read_b64_tr_b16 v[34:35], v13 offset:6528
  s_waitcnt lgkmcnt(0)
  s_add_u32 s41, s40, 0
  s_add_u32 s42, s41, 4096
  buffer_store_dwordx4 v[16:19], v3, s[12:15], s41 offen offset:0 sc1
  buffer_store_dwordx4 v[20:23], v3, s[12:15], s41 offen offset:1024 sc1
  buffer_store_dwordx4 v[24:27], v3, s[12:15], s41 offen offset:2048 sc1
  buffer_store_dwordx4 v[28:31], v3, s[12:15], s41 offen offset:3072 sc1
  buffer_store_dwordx4 v[32:35], v3, s[12:15], s42 offen offset:0 sc1
  s_branch L_k0_fin
L_k0_wo:
  s_add_u32 s12, s4, 0x8cc000
  s_addc_u32 s13, s5, 0
  s_and_b32 s13, s13, 0xffff
  s_mov_b32 s14, 0xc8000
  s_mov_b32 s15, 0x20000
  v_add_u32 v15, 0, v8
  v_cmp_gt_u32 s[48:49], 5, v15
  v_and_b32 v16, 1, v15
  v_lshlrev_b32 v16, 2, v16
  v_lshrrev_b32 v17, 1, v15
  v_mul_u32_u24 v17, 20, v17
  v_add_u32 v16, v16, v17
  v_add_u32 v17, 8, v16
  v_cmp_eq_u32 vcc, 4, v15
  v_mov_b32 v18, 16
  v_mov_b32 v19, 36
  v_cndmask_b32 v16, v16, v18, vcc
  v_cndmask_b32 v17, v17, v19, vcc
  v_add_u32 v16, v16, v10
  v_add_u32 v17, v17, v10
  v_mul_u32_u24 v16, 800, v16
  v_mul_u32_u24 v17, 800, v17
  v_add_u32 v16, v16, v11
  v_add_u32 v17, v17, v11
  v_cndmask_b32 v16, v11, v16, s[48:49]
  v_cndmask_b32 v17, v11, v17, s[48:49]
  s_mul_i32 s40, s32, 5
  v_add_u32 v18, s40, v15
  v_lshrrev_b32 v19, 2, v18
  v_and_b32 v18, 3, v18
  v_cmp_le_u32 vcc, 10, v19
  v_subrev_u32 v20, 10, v19
  s_nop 0
  v_cndmask_b32 v20, v19, v20, vcc
  v_cndmask_b32 v21, 0, 2, vcc
  v_lshrrev_b32 v22, 1, v20
  v_lshl_add_u32 v21, v22, 2, v21
  v_and_b32 v20, 1, v20
  v_add_u32 v21, v21, v20
  v_mul_u32_u24 v21, 5120, v21
  v_lshl_add_u32 v21, v18, 8, v21
  v_add_u32 v21, v21, v12
  ds_read_b64_tr_b16 v[24:25], v16 offset:0
  ds_read_b64_tr_b16 v[26:27], v17 offset:0
  ds_read_b64_tr_b16 v[28:29], v16 offset:32
  ds_read_b64_tr_b16 v[30:31], v17 offset:32
  ds_read_b64_tr_b16 v[32:33], v16 offset:64
  ds_read_b64_tr_b16 v[34:35], v17 offset:64
  ds_read_b64_tr_b16 v[36:37], v16 offset:96
  ds_read_b64_tr_b16 v[38:39], v17 offset:96
  ds_read_b64_tr_b16 v[40:41], v16 offset:128
  ds_read_b64_tr_b16 v[42:43], v17 offset:128
  s_waitcnt lgkmcnt(0)
  s_mov_b64 exec, s[48:49]
  s_mul_i32 s41, s35, 100*1024
  s_add_u32 s42, s41, 4096
  buffer_store_dwordx4 v[24:27], v21, s[12:15], s41 offen offset:0 sc1
  buffer_store_dwordx4 v[28:31], v21, s[12:15], s41 offen offset:1024 sc1
  buffer_store_dwordx4 v[32:35], v21, s[12:15], s41 offen offset:2048 sc1
  buffer_store_dwordx4 v[36:39], v21, s[12:15], s41 offen offset:3072 sc1
  buffer_store_dwordx4 v[40:43], v21, s[12:15], s42 offen offset:0 sc1
  s_mov_b64 exec, -1
  s_nop 1
  v_add_u32 v15, 4, v8
  v_cmp_gt_u32 s[48:49], 5, v15
  v_and_b32 v16, 1, v15
  v_lshlrev_b32 v16, 2, v16
  v_lshrrev_b32 v17, 1, v15
  v_mul_u32_u24 v17, 20, v17
  v_add_u32 v16, v16, v17
  v_add_u32 v17, 8, v16
  v_cmp_eq_u32 vcc, 4, v15
  v_mov_b32 v18, 16
  v_mov_b32 v19, 36
  v_cndmask_b32 v16, v16, v18, vcc
  v_cndmask_b32 v17, v17, v19, vcc
  v_add_u32 v16, v16, v10
  v_add_u32 v17, v17, v10
  v_mul_u32_u24 v16, 800, v16
  v_mul_u32_u24 v17, 800, v17
  v_add_u32 v16, v16, v11
  v_add_u32 v17, v17, v11
  v_cndmask_b32 v16, v11, v16, s[48:49]
  v_cndmask_b32 v17, v11, v17, s[48:49]
  s_mul_i32 s40, s32, 5
  v_add_u32 v18, s40, v15
  v_lshrrev_b32 v19, 2, v18
  v_and_b32 v18, 3, v18
  v_cmp_le_u32 vcc, 10, v19
  v_subrev_u32 v20, 10, v19
  s_nop 0
  v_cndmask_b32 v20, v19, v20, vcc
  v_cndmask_b32 v21, 0, 2, vcc
  v_lshrrev_b32 v22, 1, v20
  v_lshl_add_u32 v21, v22, 2, v21
  v_and_b32 v20, 1, v20
  v_add_u32 v21, v21, v20
  v_mul_u32_u24 v21, 5120, v21
  v_lshl_add_u32 v21, v18, 8, v21
  v_add_u32 v21, v21, v12
  ds_read_b64_tr_b16 v[24:25], v16 offset:0
  ds_read_b64_tr_b16 v[26:27], v17 offset:0
  ds_read_b64_tr_b16 v[28:29], v16 offset:32
  ds_read_b64_tr_b16 v[30:31], v17 offset:32
  ds_read_b64_tr_b16 v[32:33], v16 offset:64
  ds_read_b64_tr_b16 v[34:35], v17 offset:64
  ds_read_b64_tr_b16 v[36:37], v16 offset:96
  ds_read_b64_tr_b16 v[38:39], v17 offset:96
  ds_read_b64_tr_b16 v[40:41], v16 offset:128
  ds_read_b64_tr_b16 v[42:43], v17 offset:128
  s_waitcnt lgkmcnt(0)
  s_mov_b64 exec, s[48:49]
  s_mul_i32 s41, s35, 100*1024
  s_add_u32 s42, s41, 4096
  buffer_store_dwordx4 v[24:27], v21, s[12:15], s41 offen offset:0 sc1
  buffer_store_dwordx4 v[28:31], v21, s[12:15], s41 offen offset:1024 sc1
  buffer_store_dwordx4 v[32:35], v21, s[12:15], s41 offen offset:2048 sc1
  buffer_store_dwordx4 v[36:39], v21, s[12:15], s41 offen offset:3072 sc1
  buffer_store_dwordx4 v[40:43], v21, s[12:15], s42 offen offset:0 sc1
  s_mov_b64 exec, -1
  s_nop 1
L_k0_fin:
L_k0_end:
  s_endpgm
k0_tasks:
  .long 772, 788, 804, 820, 836, 852, 868, 884
  .long 1347, 1363, 1379, 1395, 1411, 1427, 1443, 1459
  .long 1475, 1491, 1507, 1523, 1539, 1555, 1571, 1587
  .long 1603, 1619, 1635, 1651, 1667, 1683, 1699, 1715
  .long 1731, 1747, 1763, 1779, 1795, 1811, 1827, 1843
  .long 1859, 1875, 1891, 1907, 1923, 1939, 1955, 1971
  .long 6, 1030, 22, 1046, 38, 1062, 54, 1078
  .long 70, 1094, 86, 1110, 102, 1126, 118, 1142
  .long 134, 1158, 150, 1174, 166, 1190, 182, 1206
  .long 198, 1222, 214, 1238, 230, 1254, 246, 1270
  .long 2, 1026, 2050, 3074, 18, 1042, 2066, 3090
  .long 34, 1058, 2082, 3106, 50, 1074, 2098, 3122
  .long 66, 1090, 2114, 3138, 82, 1106, 2130, 3154
  .long 98, 1122, 2146, 3170, 114, 1138, 2162, 3186
  .long 130, 1154, 2178, 3202, 146, 1170, 2194, 3218
  .long 4, 20, 36, 52, 68, 84, 100, 116
  .long 132, 148, 164, 180, 196, 212, 228, 244
  .long 260, 276, 292, 308, 324, 340, 356, 372
  .long 388, 404, 420, 436, 452, 468, 484, 500
  .long 516, 532, 548, 564, 580, 596, 612, 628
  .long 644, 660, 676, 692, 708, 724, 740, 756
  .long 900, 916, 932, 948, 964, 980, 996, 1012
  .long 3, 19, 35, 51, 67, 83, 99, 115
  .long 131, 147, 163, 179, 195, 211, 227, 243
  .long 259, 275, 291, 307, 323, 339, 355, 371
  .long 387, 403, 419, 435, 451, 467, 483, 499
  .long 515, 531, 547, 563, 579, 595, 611, 627
  .long 643, 659, 675, 691, 707, 723, 739, 755
  .long 771, 787, 803, 819, 835, 851, 867, 883
  .long 899, 915, 931, 947, 1027, 1043, 1059, 1075
  .long 1091, 1107, 1123, 1139, 1155, 1171, 1187, 1203
  .long 1219, 1235, 1251, 1267, 1283, 1299, 1315, 1331
  .long 5, 1029, 21, 1045, 37, 1061, 53, 1077
  .long 1, 1025, 2049, 3073, 17, 1041, 2065, 3089
  .long 33, 1057, 2081, 3105, 49, 1073, 2097, 3121
  .long 65, 1089, 2113, 3137, 81, 1105, 2129, 3153
  .long 97, 1121, 2145, 3169, 113, 1137, 2161, 3185
  .long 129, 1153, 2177, 3201, 145, 1169, 2193, 3217
  .long 322, 1346, 2370, 3394, 338, 1362, 2386, 3410
  .long 354, 1378, 2402, 3426, 370, 1394, 2418, 3442
  .long 386, 1410, 2434, 3458, 402, 1426, 2450, 3474
  .long 418, 1442, 2466, 3490, 434, 1458, 2482, 3506
  .long 162, 1186, 2210, 3234, 178, 1202, 2226, 3250
  .long 194, 1218, 2242, 3266, 210, 1234, 2258, 3282
  .long 226, 1250, 2274, 3298, 242, 1266, 2290, 3314
  .long 258, 1282, 2306, 3330, 274, 1298, 2322, 3346
  .long 290, 1314, 2338, 3362, 306, 1330, 2354, 3378
  .long 450, 1474, 2498, 3522, 466, 1490, 2514, 3538
  .long 482, 1506, 2530, 3554, 498, 1522, 2546, 3570
  .long 514, 1538, 2562, 3586, 530, 1554, 2578, 3602
  .long 546, 1570, 2594, 3618, 562, 1586, 2610, 3634
  .long 578, 1602, 2626, 3650, 594, 1618, 2642, 3666
  .long 610, 1634, 2658, 3682, 626, 1650, 2674, 3698
  .long 69, 1093, 85, 1109, 101, 1125, 117, 1141
  .long 133, 1157, 149, 1173, 165, 1189, 181, 1205
  .long 197, 1221, 213, 1237, 229, 1253, 245, 1269
  .long 261, 1285, 277, 1301, 293, 1317, 309, 1333
  .long 325, 1349, 341, 1365, 357, 1381, 373, 1397
  .long 389, 1413, 405, 1429, 421, 1445, 437, 1461
  .long 453, 1477, 469, 1493, 485, 1509, 501, 1525
  .long 517, 1541, 533, 1557, 549, 1573, 565, 1589
  .long 581, 1605, 597, 1621, 613, 1637, 629, 1653
  .long 645, 1669, 661, 1685, 677, 1701, 693, 1717
  .long 709, 1733, 725, 1749, 741, 1765, 757, 1781
  .long 609, 1633, 2657, 3681, 625, 1649, 2673, 3697
  .long 449, 1473, 2497, 3521, 465, 1489, 2513, 3537
  .long 481, 1505, 2529, 3553, 497, 1521, 2545, 3569
  .long 513, 1537, 2561, 3585, 529, 1553, 2577, 3601
  .long 545, 1569, 2593, 3617, 561, 1585, 2609, 3633
  .long 577, 1601, 2625, 3649, 593, 1617, 2641, 3665
  .long 321, 1345, 2369, 3393, 337, 1361, 2385, 3409
  .long 353, 1377, 2401, 3425, 369, 1393, 2417, 3441
  .long 385, 1409, 2433, 3457, 401, 1425, 2449, 3473
  .long 417, 1441, 2465, 3489, 433, 1457, 2481, 3505
  .long 161, 1185, 2209, 3233, 177, 1201, 2225, 3249
  .long 193, 1217, 2241, 3265, 209, 1233, 2257, 3281
  .long 225, 1249, 2273, 3297, 241, 1265, 2289, 3313
  .long 257, 1281, 2305, 3329, 273, 1297, 2321, 3345
  .long 289, 1313, 2337, 3361, 305, 1329, 2353, 3377
.globl p_kernel
.p2align 8
.type p_kernel,@function
p_kernel:
  s_cmp_ge_u32 s2, 256
  s_cbranch_scc1 L_p_end
  s_load_dwordx2 s[4:5], s[0:1], 88
  s_load_dwordx2 s[96:97], s[0:1], 72
  v_lshrrev_b32 v1, 6, v0
  v_and_b32 v2, 63, v0
  v_lshlrev_b32 v3, 4, v2
  v_readfirstlane_b32 s3, v1
  s_nop 3
  s_and_b32 s29, s3, 3
  s_load_dwordx2 s[6:7], s[0:1], 0
  v_add_u32 v4, 0x10000, v3
  v_add_u32 v5, 0x20000, v3
  v_mov_b32 v59, 0x40000000
  v_mov_b32 v60, 0x40000000
  v_mov_b32 v61, 0x40000000
  s_and_b32 s50, s2, 7
  s_lshr_b32 s51, s2, 3
  s_lshr_b32 s30, s50, 1
  s_lshl_b32 s30, s30, 2
  s_and_b32 s52, s51, 3
  s_add_u32 s30, s30, s52
  s_and_b32 s31, s50, 1
  s_lshl_b32 s31, s31, 3
  s_lshr_b32 s52, s51, 2
  s_add_u32 s31, s31, s52
  s_lshl_b32 s32, s30, 2
  s_add_u32 s32, s32, s29
  s_lshr_b32 s37, s31, 3
  s_lshl_b32 s38, s30, 1
  s_add_u32 s37, s37, s38
  s_and_b32 s38, s31, 7
  s_waitcnt lgkmcnt(0)
  s_add_u32 s16, s4, 0x2094000
  s_addc_u32 s17, s5, 0
  s_and_b32 s17, s17, 0xffff
  s_mov_b32 s18, 0x10000
  s_mov_b32 s19, 0x20000
  s_add_u32 s8, s4, 0x4000
  s_addc_u32 s9, s5, 0
  s_and_b32 s9, s9, 0xffff
  s_mov_b32 s10, 0x280000
  s_mov_b32 s11, 0x20000
  s_add_u32 s12, s4, 0x284000
  s_addc_u32 s13, s5, 0
  s_and_b32 s13, s13, 0xffff
  s_mov_b32 s14, 0x280000
  s_mov_b32 s15, 0x20000
  s_mul_i32 s33, s32, 40*1024
  s_mul_i32 s34, s31, 160*1024
  s_cmp_ge_u32 s3, 4
  s_cbranch_scc1 L_H_qkv
  v_lshrrev_b32 v15, 5, v2
  v_lshlrev_b32 v15, 6, v15
  v_add_u32 v15, 147456, v15
  s_mov_b32 s39, s33
  s_mov_b32 s35, s39
  s_add_u32 s39, s39, 4096
  buffer_load_dwordx4 v[128:131], v3, s[8:11], s35 offen offset:0
  buffer_load_dwordx4 v[132:135], v3, s[8:11], s35 offen offset:1024
  buffer_load_dwordx4 v[136:139], v3, s[8:11], s35 offen offset:2048
  buffer_load_dwordx4 v[140:143], v3, s[8:11], s35 offen offset:3072
  s_mov_b32 s36, s39
  s_add_u32 s39, s39, 4096
  buffer_load_dwordx4 v[144:147], v3, s[8:11], s36 offen offset:0
  buffer_load_dwordx4 v[148:151], v3, s[8:11], s36 offen offset:1024
  buffer_load_dwordx4 v[152:155], v3, s[8:11], s36 offen offset:2048
  buffer_load_dwordx4 v[156:159], v3, s[8:11], s36 offen offset:3072
  s_barrier
  s_mov_b32 s99, 0xffff0000
  ds_read_b128 v[192:195], v15 offset:0
  ds_read_b128 v[196:199], v15 offset:16
  ds_read_b128 v[200:203], v15 offset:32
  ds_read_b128 v[204:207], v15 offset:48
  ds_read_b128 v[208:211], v15 offset:128
  ds_read_b128 v[212:215], v15 offset:144
  ds_read_b128 v[216:219], v15 offset:160
  ds_read_b128 v[220:223], v15 offset:176
  ds_read_b128 v[224:227], v15 offset:256
  ds_read_b128 v[228:231], v15 offset:272
  ds_read_b128 v[232:235], v15 offset:288
  ds_read_b128 v[236:239], v15 offset:304
  s_waitcnt vmcnt(7)
  s_waitcnt lgkmcnt(8)
  v_lshlrev_b32 v48, 16, v128
  v_and_b32 v49, s99, v128
  v_lshlrev_b32 v50, 16, v129
  v_and_b32 v51, s99, v129
  v_lshlrev_b32 v52, 16, v130
  v_and_b32 v53, s99, v130
  v_lshlrev_b32 v54, 16, v131
  v_and_b32 v55, s99, v131
  v_fma_f32 v48, v48, v192, v200
  v_fma_f32 v49, v49, v193, v201
  v_fma_f32 v50, v50, v194, v202
  v_fma_f32 v51, v51, v195, v203
  v_fma_f32 v52, v52, v196, v204
  v_fma_f32 v53, v53, v197, v205
  v_fma_f32 v54, v54, v198, v206
  v_fma_f32 v55, v55, v199, v207
  v_cvt_pk_bf16_f32 v128, v48, v49
  v_cvt_pk_bf16_f32 v129, v50, v51
  v_cvt_pk_bf16_f32 v130, v52, v53
  v_cvt_pk_bf16_f32 v131, v54, v55
  s_barrier
  ds_read_b128 v[16:19], v3 offset:0
  ds_read_b128 v[20:23], v3 offset:1024
  ds_read_b128 v[24:27], v3 offset:2048
  ds_read_b128 v[28:31], v3 offset:3072
  s_waitcnt lgkmcnt(0)
  s_waitcnt vmcnt(6)
  v_mfma_f32_32x32x16_bf16 v[64:79], v[16:19], v[128:131], 0
  ds_read_b128 v[32:35], v3 offset:4096
  ds_read_b128 v[36:39], v3 offset:5120
  v_lshlrev_b32 v48, 16, v132
  v_and_b32 v49, s99, v132
  v_lshlrev_b32 v50, 16, v133
  v_and_b32 v51, s99, v133
  v_lshlrev_b32 v52, 16, v134
  v_mfma_f32_32x32x16_bf16 v[80:95], v[20:23], v[128:131], 0
  ds_read_b128 v[40:43], v3 offset:6144
  ds_read_b128 v[44:47], v3 offset:7168
  v_and_b32 v53, s99, v134
  v_lshlrev_b32 v54, 16, v135
  v_and_b32 v55, s99, v135
  v_fma_f32 v48, v48, v208, v216
  v_fma_f32 v49, v49, v209, v217
  v_mfma_f32_32x32x16_bf16 v[96:111], v[24:27], v[128:131], 0
  ds_read_b128 v[192:195], v15 offset:384
  ds_read_b128 v[196:199], v15 offset:400
  v_fma_f32 v50, v50, v210, v218
  v_fma_f32 v51, v51, v211, v219
  v_fma_f32 v52, v52, v212, v220
  v_fma_f32 v53, v53, v213, v221
  v_fma_f32 v54, v54, v214, v222
  s_mov_b32 s35, s39
  s_add_u32 s39, s39, 4096
  buffer_load_dwordx4 v[160:163], v3, s[8:11], s35 offen offset:0
  v_mfma_f32_32x32x16_bf16 v[112:127], v[28:31], v[128:131], 0
  v_fma_f32 v55, v55, v215, v223
  v_cvt_pk_bf16_f32 v132, v48, v49
  v_cvt_pk_bf16_f32 v133, v50, v51
  v_cvt_pk_bf16_f32 v134, v52, v53
  v_cvt_pk_bf16_f32 v135, v54, v55
  ds_read_b128 v[200:203], v15 offset:416
  ds_read_b128 v[204:207], v15 offset:432
  s_waitcnt lgkmcnt(4)
  s_waitcnt vmcnt(6)
  v_mfma_f32_32x32x16_bf16 v[64:79], v[32:35], v[132:135], v[64:79]
  ds_read_b128 v[16:19], v3 offset:8192
  ds_read_b128 v[20:23], v3 offset:9216
  v_lshlrev_b32 v48, 16, v136
  v_and_b32 v49, s99, v136
  v_lshlrev_b32 v50, 16, v137
  v_and_b32 v51, s99, v137
  v_lshlrev_b32 v52, 16, v138
  v_mfma_f32_32x32x16_bf16 v[80:95], v[36:39], v[132:135], v[80:95]
  ds_read_b128 v[24:27], v3 offset:10240
  ds_read_b128 v[28:31], v3 offset:11264
  v_and_b32 v53, s99, v138
  v_lshlrev_b32 v54, 16, v139
  v_and_b32 v55, s99, v139
  v_fma_f32 v48, v48, v224, v232
  v_fma_f32 v49, v49, v225, v233
  v_mfma_f32_32x32x16_bf16 v[96:111], v[40:43], v[132:135], v[96:111]
  ds_read_b128 v[208:211], v15 offset:512
  ds_read_b128 v[212:215], v15 offset:528
  v_fma_f32 v50, v50, v226, v234
  v_fma_f32 v51, v51, v227, v235
  v_fma_f32 v52, v52, v228, v236
  v_fma_f32 v53, v53, v229, v237
  v_fma_f32 v54, v54, v230, v238
  buffer_load_dwordx4 v[164:167], v3, s[8:11], s35 offen offset:1024
  v_mfma_f32_32x32x16_bf16 v[112:127], v[44:47], v[132:135], v[112:127]
  v_fma_f32 v55, v55, v231, v239
  v_cvt_pk_bf16_f32 v136, v48, v49
  v_cvt_pk_bf16_f32 v137, v50, v51
  v_cvt_pk_bf16_f32 v138, v52, v53
  v_cvt_pk_bf16_f32 v139, v54, v55
  ds_read_b128 v[216:219], v15 offset:544
  ds_read_b128 v[220:223], v15 offset:560
  s_waitcnt lgkmcnt(4)
  s_waitcnt vmcnt(6)
  v_mfma_f32_32x32x16_bf16 v[64:79], v[16:19], v[136:139], v[64:79]
  ds_read_b128 v[32:35], v3 offset:12288
  ds_read_b128 v[36:39], v3 offset:13312
  v_lshlrev_b32 v48, 16, v140
  v_and_b32 v49, s99, v140
  v_lshlrev_b32 v50, 16, v141
  v_and_b32 v51, s99, v141
  v_lshlrev_b32 v52, 16, v142
  v_mfma_f32_32x32x16_bf16 v[80:95], v[20:23], v[136:139], v[80:95]
  ds_read_b128 v[40:43], v3 offset:14336
  ds_read_b128 v[44:47], v3 offset:15360
  v_and_b32 v53, s99, v142
  v_lshlrev_b32 v54, 16, v143
  v_and_b32 v55, s99, v143
  v_fma_f32 v48, v48, v192, v200
  v_fma_f32 v49, v49, v193, v201
  v_mfma_f32_32x32x16_bf16 v[96:111], v[24:27], v[136:139], v[96:111]
  ds_read_b128 v[224:227], v15 offset:640
  ds_read_b128 v[228:231], v15 offset:656
  v_fma_f32 v50, v50, v194, v202
  v_fma_f32 v51, v51, v195, v203
  v_fma_f32 v52, v52, v196, v204
  v_fma_f32 v53, v53, v197, v205
  v_fma_f32 v54, v54, v198, v206
  buffer_load_dwordx4 v[168:171], v3, s[8:11], s35 offen offset:2048
  v_mfma_f32_32x32x16_bf16 v[112:127], v[28:31], v[136:139], v[112:127]
  v_fma_f32 v55, v55, v199, v207
  v_cvt_pk_bf16_f32 v140, v48, v49
  v_cvt_pk_bf16_f32 v141, v50, v51
  v_cvt_pk_bf16_f32 v142, v52, v53
  v_cvt_pk_bf16_f32 v143, v54, v55
  ds_read_b128 v[232:235], v15 offset:672
  ds_read_b128 v[236:239], v15 offset:688
  s_waitcnt lgkmcnt(4)
  s_waitcnt vmcnt(6)
  v_mfma_f32_32x32x16_bf16 v[64:79], v[32:35], v[140:143], v[64:79]
  ds_read_b128 v[16:19], v3 offset:16384
  ds_read_b128 v[20:23], v3 offset:17408
  v_lshlrev_b32 v48, 16, v144
  v_and_b32 v49, s99, v144
  v_lshlrev_b32 v50, 16, v145
  v_and_b32 v51, s99, v145
  v_lshlrev_b32 v52, 16, v146
  v_mfma_f32_32x32x16_bf16 v[80:95], v[36:39], v[140:143], v[80:95]
  ds_read_b128 v[24:27], v3 offset:18432
  ds_read_b128 v[28:31], v3 offset:19456
  v_and_b32 v53, s99, v146
  v_lshlrev_b32 v54, 16, v147
  v_and_b32 v55, s99, v147
  v_fma_f32 v48, v48, v208, v216
  v_fma_f32 v49, v49, v209, v217
  v_mfma_f32_32x32x16_bf16 v[96:111], v[40:43], v[140:143], v[96:111]
  ds_read_b128 v[192:195], v15 offset:768
  ds_read_b128 v[196:199], v15 offset:784
  v_fma_f32 v50, v50, v210, v218
  v_fma_f32 v51, v51, v211, v219
  v_fma_f32 v52, v52, v212, v220
  v_fma_f32 v53, v53, v213, v221
  v_fma_f32 v54, v54, v214, v222
  buffer_load_dwordx4 v[172:175], v3, s[8:11], s35 offen offset:3072
  v_mfma_f32_32x32x16_bf16 v[112:127], v[44:47], v[140:143], v[112:127]
  v_fma_f32 v55, v55, v215, v223
  v_cvt_pk_bf16_f32 v144, v48, v49
  v_cvt_pk_bf16_f32 v145, v50, v51
  v_cvt_pk_bf16_f32 v146, v52, v53
  v_cvt_pk_bf16_f32 v147, v54, v55
  ds_read_b128 v[200:203], v15 offset:800
  ds_read_b128 v[204:207], v15 offset:816
  s_waitcnt lgkmcnt(4)
  s_waitcnt vmcnt(6)
  v_mfma_f32_32x32x16_bf16 v[64:79], v[16:19], v[144:147], v[64:79]
  ds_read_b128 v[32:35], v3 offset:20480
  ds_read_b128 v[36:39], v3 offset:21504
  v_lshlrev_b32 v48, 16, v148
  v_and_b32 v49, s99, v148
  v_lshlrev_b32 v50, 16, v149
  v_and_b32 v51, s99, v149
  v_lshlrev_b32 v52, 16, v150
  v_mfma_f32_32x32x16_bf16 v[80:95], v[20:23], v[144:147], v[80:95]
  ds_read_b128 v[40:43], v3 offset:22528
  ds_read_b128 v[44:47], v3 offset:23552
  v_and_b32 v53, s99, v150
  v_lshlrev_b32 v54, 16, v151
  v_and_b32 v55, s99, v151
  v_fma_f32 v48, v48, v224, v232
  v_fma_f32 v49, v49, v225, v233
  v_mfma_f32_32x32x16_bf16 v[96:111], v[24:27], v[144:147], v[96:111]
  ds_read_b128 v[208:211], v15 offset:896
  ds_read_b128 v[212:215], v15 offset:912
  v_fma_f32 v50, v50, v226, v234
  v_fma_f32 v51, v51, v227, v235
  v_fma_f32 v52, v52, v228, v236
  v_fma_f32 v53, v53, v229, v237
  v_fma_f32 v54, v54, v230, v238
  s_mov_b32 s36, s39
  s_add_u32 s39, s39, 4096
  buffer_load_dwordx4 v[176:179], v3, s[8:11], s36 offen offset:0
  v_mfma_f32_32x32x16_bf16 v[112:127], v[28:31], v[144:147], v[112:127]
  v_fma_f32 v55, v55, v231, v239
  v_cvt_pk_bf16_f32 v148, v48, v49
  v_cvt_pk_bf16_f32 v149, v50, v51
  v_cvt_pk_bf16_f32 v150, v52, v53
  v_cvt_pk_bf16_f32 v151, v54, v55
  ds_read_b128 v[216:219], v15 offset:928
  ds_read_b128 v[220:223], v15 offset:944
  s_waitcnt lgkmcnt(4)
  s_waitcnt vmcnt(6)
  v_mfma_f32_32x32x16_bf16 v[64:79], v[32:35], v[148:151], v[64:79]
  ds_read_b128 v[16:19], v3 offset:24576
  ds_read_b128 v[20:23], v3 offset:25600
  v_lshlrev_b32 v48, 16, v152
  v_and_b32 v49, s99, v152
  v_lshlrev_b32 v50, 16, v153
  v_and_b32 v51, s99, v153
  v_lshlrev_b32 v52, 16, v154
  v_mfma_f32_32x32x16_bf16 v[80:95], v[36:39], v[148:151], v[80:95]
  ds_read_b128 v[24:27], v3 offset:26624
  ds_read_b128 v[28:31], v3 offset:27648
  v_and_b32 v53, s99, v154
  v_lshlrev_b32 v54, 16, v155
  v_and_b32 v55, s99, v155
  v_fma_f32 v48, v48, v192, v200
  v_fma_f32 v49, v49, v193, v201
  v_mfma_f32_32x32x16_bf16 v[96:111], v[40:43], v[148:151], v[96:111]
  ds_read_b128 v[224:227], v15 offset:1024
  ds_read_b128 v[228:231], v15 offset:1040
  v_fma_f32 v50, v50, v194, v202
  v_fma_f32 v51, v51, v195, v203
  v_fma_f32 v52, v52, v196, v204
  v_fma_f32 v53, v53, v197, v205
  v_fma_f32 v54, v54, v198, v206
  buffer_load_dwordx4 v[180:183], v3, s[8:11], s36 offen offset:1024
  v_mfma_f32_32x32x16_bf16 v[112:127], v[44:47], v[148:151], v[112:127]
  v_fma_f32 v55, v55, v199, v207
  v_cvt_pk_bf16_f32 v152, v48, v49
  v_cvt_pk_bf16_f32 v153, v50, v51
  v_cvt_pk_bf16_f32 v154, v52, v53
  v_cvt_pk_bf16_f32 v155, v54, v55
  ds_read_b128 v[232:235], v15 offset:1056
  ds_read_b128 v[236:239], v15 offset:1072
  s_waitcnt lgkmcnt(4)
  s_waitcnt vmcnt(6)
  v_mfma_f32_32x32x16_bf16 v[64:79], v[16:19], v[152:155], v[64:79]
  ds_read_b128 v[32:35], v3 offset:28672
  ds_read_b128 v[36:39], v3 offset:29696
  v_lshlrev_b32 v48, 16, v156
  v_and_b32 v49, s99, v156
  v_lshlrev_b32 v50, 16, v157
  v_and_b32 v51, s99, v157
  v_lshlrev_b32 v52, 16, v158
  v_mfma_f32_32x32x16_bf16 v[80:95], v[20:23], v[152:155], v[80:95]
  ds_read_b128 v[40:43], v3 offset:30720
  ds_read_b128 v[44:47], v3 offset:31744
  v_and_b32 v53, s99, v158
  v_lshlrev_b32 v54, 16, v159
  v_and_b32 v55, s99, v159
  v_fma_f32 v48, v48, v208, v216
  v_fma_f32 v49, v49, v209, v217
  v_mfma_f32_32x32x16_bf16 v[96:111], v[24:27], v[152:155], v[96:111]
  ds_read_b128 v[192:195], v15 offset:1152
  ds_read_b128 v[196:199], v15 offset:1168
  v_fma_f32 v50, v50, v210, v218
  v_fma_f32 v51, v51, v211, v219
  v_fma_f32 v52, v52, v212, v220
  v_fma_f32 v53, v53, v213, v221
  v_fma_f32 v54, v54, v214, v222
  buffer_load_dwordx4 v[184:187], v3, s[8:11], s36 offen offset:2048
  v_mfma_f32_32x32x16_bf16 v[112:127], v[28:31], v[152:155], v[112:127]
  v_fma_f32 v55, v55, v215, v223
  v_cvt_pk_bf16_f32 v156, v48, v49
  v_cvt_pk_bf16_f32 v157, v50, v51
  v_cvt_pk_bf16_f32 v158, v52, v53
  v_cvt_pk_bf16_f32 v159, v54, v55
  ds_read_b128 v[200:203], v15 offset:1184
  ds_read_b128 v[204:207], v15 offset:1200
  s_waitcnt lgkmcnt(4)
  s_barrier
  s_waitcnt vmcnt(6)
  v_mfma_f32_32x32x16_bf16 v[64:79], v[32:35], v[156:159], v[64:79]
  ds_read_b128 v[16:19], v3 offset:32768
  ds_read_b128 v[20:23], v3 offset:33792
  v_lshlrev_b32 v48, 16, v160
  v_and_b32 v49, s99, v160
  v_lshlrev_b32 v50, 16, v161
  v_and_b32 v51, s99, v161
  v_lshlrev_b32 v52, 16, v162
  v_mfma_f32_32x32x16_bf16 v[80:95], v[36:39], v[156:159], v[80:95]
  ds_read_b128 v[24:27], v3 offset:34816
  ds_read_b128 v[28:31], v3 offset:35840
  v_and_b32 v53, s99, v162
  v_lshlrev_b32 v54, 16, v163
  v_and_b32 v55, s99, v163
  v_fma_f32 v48, v48, v224, v232
  v_fma_f32 v49, v49, v225, v233
  v_mfma_f32_32x32x16_bf16 v[96:111], v[40:43], v[156:159], v[96:111]
  ds_read_b128 v[208:211], v15 offset:1280
  ds_read_b128 v[212:215], v15 offset:1296
  v_fma_f32 v50, v50, v226, v234
  v_fma_f32 v51, v51, v227, v235
  v_fma_f32 v52, v52, v228, v236
  v_fma_f32 v53, v53, v229, v237
  v_fma_f32 v54, v54, v230, v238
  buffer_load_dwordx4 v[188:191], v3, s[8:11], s36 offen offset:3072
  v_mfma_f32_32x32x16_bf16 v[112:127], v[44:47], v[156:159], v[112:127]
  v_fma_f32 v55, v55, v231, v239
  v_cvt_pk_bf16_f32 v160, v48, v49
  v_cvt_pk_bf16_f32 v161, v50, v51
  v_cvt_pk_bf16_f32 v162, v52, v53
  v_cvt_pk_bf16_f32 v163, v54, v55
  ds_read_b128 v[216:219], v15 offset:1312
  ds_read_b128 v[220:223], v15 offset:1328
  s_waitcnt lgkmcnt(4)
  s_waitcnt vmcnt(6)
  v_mfma_f32_32x32x16_bf16 v[64:79], v[16:19], v[160:163], v[64:79]
  ds_read_b128 v[32:35], v3 offset:36864
  ds_read_b128 v[36:39], v3 offset:37888
  v_lshlrev_b32 v48, 16, v164
  v_and_b32 v49, s99, v164
  v_lshlrev_b32 v50, 16, v165
  v_and_b32 v51, s99, v165
  v_lshlrev_b32 v52, 16, v166
  v_mfma_f32_32x32x16_bf16 v[80:95], v[20:23], v[160:163], v[80:95]
  ds_read_b128 v[40:43], v3 offset:38912
  ds_read_b128 v[44:47], v3 offset:39936
  v_and_b32 v53, s99, v166
  v_lshlrev_b32 v54, 16, v167
  v_and_b32 v55, s99, v167
  v_fma_f32 v48, v48, v192, v200
  v_fma_f32 v49, v49, v193, v201
  v_mfma_f32_32x32x16_bf16 v[96:111], v[24:27], v[160:163], v[96:111]
  ds_read_b128 v[224:227], v15 offset:1408
  ds_read_b128 v[228:231], v15 offset:1424
  v_fma_f32 v50, v50, v194, v202
  v_fma_f32 v51, v51, v195, v203
  v_fma_f32 v52, v52, v196, v204
  v_fma_f32 v53, v53, v197, v205
  v_fma_f32 v54, v54, v198, v206
  s_mov_b32 s35, s39
  s_add_u32 s39, s39, 4096
  buffer_load_dwordx4 v[128:131], v3, s[8:11], s35 offen offset:0
  v_mfma_f32_32x32x16_bf16 v[112:127], v[28:31], v[160:163], v[112:127]
  v_fma_f32 v55, v55, v199, v207
  v_cvt_pk_bf16_f32 v164, v48, v49
  v_cvt_pk_bf16_f32 v165, v50, v51
  v_cvt_pk_bf16_f32 v166, v52, v53
  v_cvt_pk_bf16_f32 v167, v54, v55
  ds_read_b128 v[232:235], v15 offset:1440
  ds_read_b128 v[236:239], v15 offset:1456
  s_waitcnt lgkmcnt(4)
  s_waitcnt vmcnt(6)
  v_mfma_f32_32x32x16_bf16 v[64:79], v[32:35], v[164:167], v[64:79]
  ds_read_b128 v[16:19], v3 offset:40960
  ds_read_b128 v[20:23], v3 offset:41984
  v_lshlrev_b32 v48, 16, v168
  v_and_b32 v49, s99, v168
  v_lshlrev_b32 v50, 16, v169
  v_and_b32 v51, s99, v169
  v_lshlrev_b32 v52, 16, v170
  v_mfma_f32_32x32x16_bf16 v[80:95], v[36:39], v[164:167], v[80:95]
  ds_read_b128 v[24:27], v3 offset:43008
  ds_read_b128 v[28:31], v3 offset:44032
  v_and_b32 v53, s99, v170
  v_lshlrev_b32 v54, 16, v171
  v_and_b32 v55, s99, v171
  v_fma_f32 v48, v48, v208, v216
  v_fma_f32 v49, v49, v209, v217
  v_mfma_f32_32x32x16_bf16 v[96:111], v[40:43], v[164:167], v[96:111]
  ds_read_b128 v[192:195], v15 offset:1536
  ds_read_b128 v[196:199], v15 offset:1552
  v_fma_f32 v50, v50, v210, v218
  v_fma_f32 v51, v51, v211, v219
  v_fma_f32 v52, v52, v212, v220
  v_fma_f32 v53, v53, v213, v221
  v_fma_f32 v54, v54, v214, v222
  buffer_load_dwordx4 v[132:135], v3, s[8:11], s35 offen offset:1024
  v_mfma_f32_32x32x16_bf16 v[112:127], v[44:47], v[164:167], v[112:127]
  v_fma_f32 v55, v55, v215, v223
  v_cvt_pk_bf16_f32 v168, v48, v49
  v_cvt_pk_bf16_f32 v169, v50, v51
  v_cvt_pk_bf16_f32 v170, v52, v53
  v_cvt_pk_bf16_f32 v171, v54, v55
  ds_read_b128 v[200:203], v15 offset:1568
  ds_read_b128 v[204:207], v15 offset:1584
  s_waitcnt lgkmcnt(4)
  s_waitcnt vmcnt(6)
  v_mfma_f32_32x32x16_bf16 v[64:79], v[16:19], v[168:171], v[64:79]
  ds_read_b128 v[32:35], v3 offset:45056
  ds_read_b128 v[36:39], v3 offset:46080
  v_lshlrev_b32 v48, 16, v172
  v_and_b32 v49, s99, v172
  v_lshlrev_b32 v50, 16, v173
  v_and_b32 v51, s99, v173
  v_lshlrev_b32 v52, 16, v174
  v_mfma_f32_32x32x16_bf16 v[80:95], v[20:23], v[168:171], v[80:95]
  ds_read_b128 v[40:43], v3 offset:47104
  ds_read_b128 v[44:47], v3 offset:48128
  v_and_b32 v53, s99, v174
  v_lshlrev_b32 v54, 16, v175
  v_and_b32 v55, s99, v175
  v_fma_f32 v48, v48, v224, v232
  v_fma_f32 v49, v49, v225, v233
  v_mfma_f32_32x32x16_bf16 v[96:111], v[24:27], v[168:171], v[96:111]
  ds_read_b128 v[208:211], v15 offset:1664
  ds_read_b128 v[212:215], v15 offset:1680
  v_fma_f32 v50, v50, v226, v234
  v_fma_f32 v51, v51, v227, v235
  v_fma_f32 v52, v52, v228, v236
  v_fma_f32 v53, v53, v229, v237
  v_fma_f32 v54, v54, v230, v238
  buffer_load_dwordx4 v[136:139], v3, s[8:11], s35 offen offset:2048
  v_mfma_f32_32x32x16_bf16 v[112:127], v[28:31], v[168:171], v[112:127]
  v_fma_f32 v55, v55, v231, v239
  v_cvt_pk_bf16_f32 v172, v48, v49
  v_cvt_pk_bf16_f32 v173, v50, v51
  v_cvt_pk_bf16_f32 v174, v52, v53
  v_cvt_pk_bf16_f32 v175, v54, v55
  ds_read_b128 v[216:219], v15 offset:1696
  ds_read_b128 v[220:223], v15 offset:1712
  s_waitcnt lgkmcnt(4)
  s_waitcnt vmcnt(6)
  v_mfma_f32_32x32x16_bf16 v[64:79], v[32:35], v[172:175], v[64:79]
  ds_read_b128 v[16:19], v3 offset:49152
  ds_read_b128 v[20:23], v3 offset:50176
  v_lshlrev_b32 v48, 16, v176
  v_and_b32 v49, s99, v176
  v_lshlrev_b32 v50, 16, v177
  v_and_b32 v51, s99, v177
  v_lshlrev_b32 v52, 16, v178
  v_mfma_f32_32x32x16_bf16 v[80:95], v[36:39], v[172:175], v[80:95]
  ds_read_b128 v[24:27], v3 offset:51200
  ds_read_b128 v[28:31], v3 offset:52224
  v_and_b32 v53, s99, v178
  v_lshlrev_b32 v54, 16, v179
  v_and_b32 v55, s99, v179
  v_fma_f32 v48, v48, v192, v200
  v_fma_f32 v49, v49, v193, v201
  v_mfma_f32_32x32x16_bf16 v[96:111], v[40:43], v[172:175], v[96:111]
  ds_read_b128 v[224:227], v15 offset:1792
  ds_read_b128 v[228:231], v15 offset:1808
  v_fma_f32 v50, v50, v194, v202
  v_fma_f32 v51, v51, v195, v203
  v_fma_f32 v52, v52, v196, v204
  v_fma_f32 v53, v53, v197, v205
  v_fma_f32 v54, v54, v198, v206
  buffer_load_dwordx4 v[140:143], v3, s[8:11], s35 offen offset:3072
  v_mfma_f32_32x32x16_bf16 v[112:127], v[44:47], v[172:175], v[112:127]
  v_fma_f32 v55, v55, v199, v207
  v_cvt_pk_bf16_f32 v176, v48, v49
  v_cvt_pk_bf16_f32 v177, v50, v51
  v_cvt_pk_bf16_f32 v178, v52, v53
  v_cvt_pk_bf16_f32 v179, v54, v55
  ds_read_b128 v[232:235], v15 offset:1824
  ds_read_b128 v[236:239], v15 offset:1840
  s_waitcnt lgkmcnt(4)
  s_waitcnt vmcnt(6)
  v_mfma_f32_32x32x16_bf16 v[64:79], v[16:19], v[176:179], v[64:79]
  ds_read_b128 v[32:35], v3 offset:53248
  ds_read_b128 v[36:39], v3 offset:54272
  v_lshlrev_b32 v48, 16, v180
  v_and_b32 v49, s99, v180
  v_lshlrev_b32 v50, 16, v181
  v_and_b32 v51, s99, v181
  v_lshlrev_b32 v52, 16, v182
  v_mfma_f32_32x32x16_bf16 v[80:95], v[20:23], v[176:179], v[80:95]
  ds_read_b128 v[40:43], v3 offset:55296
  ds_read_b128 v[44:47], v3 offset:56320
  v_and_b32 v53, s99, v182
  v_lshlrev_b32 v54, 16, v183
  v_and_b32 v55, s99, v183
  v_fma_f32 v48, v48, v208, v216
  v_fma_f32 v49, v49, v209, v217
  v_mfma_f32_32x32x16_bf16 v[96:111], v[24:27], v[176:179], v[96:111]
  ds_read_b128 v[192:195], v15 offset:1920
  ds_read_b128 v[196:199], v15 offset:1936
  v_fma_f32 v50, v50, v210, v218
  v_fma_f32 v51, v51, v211, v219
  v_fma_f32 v52, v52, v212, v220
  v_fma_f32 v53, v53, v213, v221
  v_fma_f32 v54, v54, v214, v222
  s_mov_b32 s36, s39
  s_add_u32 s39, s39, 4096
  buffer_load_dwordx4 v[144:147], v3, s[8:11], s36 offen offset:0
  v_mfma_f32_32x32x16_bf16 v[112:127], v[28:31], v[176:179], v[112:127]
  v_fma_f32 v55, v55, v215, v223
  v_cvt_pk_bf16_f32 v180, v48, v49
  v_cvt_pk_bf16_f32 v181, v50, v51
  v_cvt_pk_bf16_f32 v182, v52, v53
  v_cvt_pk_bf16_f32 v183, v54, v55
  ds_read_b128 v[200:203], v15 offset:1952
  ds_read_b128 v[204:207], v15 offset:1968
  s_waitcnt lgkmcnt(4)
  s_waitcnt vmcnt(6)
  v_mfma_f32_32x32x16_bf16 v[64:79], v[32:35], v[180:183], v[64:79]
  ds_read_b128 v[16:19], v3 offset:57344
  ds_read_b128 v[20:23], v3 offset:58368
  v_lshlrev_b32 v48, 16, v184
  v_and_b32 v49, s99, v184
  v_lshlrev_b32 v50, 16, v185
  v_and_b32 v51, s99, v185
  v_lshlrev_b32 v52, 16, v186
  v_mfma_f32_32x32x16_bf16 v[80:95], v[36:39], v[180:183], v[80:95]
  ds_read_b128 v[24:27], v3 offset:59392
  ds_read_b128 v[28:31], v3 offset:60416
  v_and_b32 v53, s99, v186
  v_lshlrev_b32 v54, 16, v187
  v_and_b32 v55, s99, v187
  v_fma_f32 v48, v48, v224, v232
  v_fma_f32 v49, v49, v225, v233
  v_mfma_f32_32x32x16_bf16 v[96:111], v[40:43], v[180:183], v[96:111]
  ds_read_b128 v[208:211], v15 offset:2048
  ds_read_b128 v[212:215], v15 offset:2064
  v_fma_f32 v50, v50, v226, v234
  v_fma_f32 v51, v51, v227, v235
  v_fma_f32 v52, v52, v228, v236
  v_fma_f32 v53, v53, v229, v237
  v_fma_f32 v54, v54, v230, v238
  buffer_load_dwordx4 v[148:151], v3, s[8:11], s36 offen offset:1024
  v_mfma_f32_32x32x16_bf16 v[112:127], v[44:47], v[180:183], v[112:127]
  v_fma_f32 v55, v55, v231, v239
  v_cvt_pk_bf16_f32 v184, v48, v49
  v_cvt_pk_bf16_f32 v185, v50, v51
  v_cvt_pk_bf16_f32 v186, v52, v53
  v_cvt_pk_bf16_f32 v187, v54, v55
  ds_read_b128 v[216:219], v15 offset:2080
  ds_read_b128 v[220:223], v15 offset:2096
  s_waitcnt lgkmcnt(4)
  s_waitcnt vmcnt(6)
  v_mfma_f32_32x32x16_bf16 v[64:79], v[16:19], v[184:187], v[64:79]
  ds_read_b128 v[32:35], v3 offset:61440
  ds_read_b128 v[36:39], v3 offset:62464
  v_lshlrev_b32 v48, 16, v188
  v_and_b32 v49, s99, v188
  v_lshlrev_b32 v50, 16, v189
  v_and_b32 v51, s99, v189
  v_lshlrev_b32 v52, 16, v190
  v_mfma_f32_32x32x16_bf16 v[80:95], v[20:23], v[184:187], v[80:95]
  ds_read_b128 v[40:43], v3 offset:63488
  ds_read_b128 v[44:47], v3 offset:64512
  v_and_b32 v53, s99, v190
  v_lshlrev_b32 v54, 16, v191
  v_and_b32 v55, s99, v191
  v_fma_f32 v48, v48, v192, v200
  v_fma_f32 v49, v49, v193, v201
  v_mfma_f32_32x32x16_bf16 v[96:111], v[24:27], v[184:187], v[96:111]
  ds_read_b128 v[224:227], v15 offset:2176
  ds_read_b128 v[228:231], v15 offset:2192
  v_fma_f32 v50, v50, v194, v202
  v_fma_f32 v51, v51, v195, v203
  v_fma_f32 v52, v52, v196, v204
  v_fma_f32 v53, v53, v197, v205
  v_fma_f32 v54, v54, v198, v206
  buffer_load_dwordx4 v[152:155], v3, s[8:11], s36 offen offset:2048
  v_mfma_f32_32x32x16_bf16 v[112:127], v[28:31], v[184:187], v[112:127]
  v_fma_f32 v55, v55, v199, v207
  v_cvt_pk_bf16_f32 v188, v48, v49
  v_cvt_pk_bf16_f32 v189, v50, v51
  v_cvt_pk_bf16_f32 v190, v52, v53
  v_cvt_pk_bf16_f32 v191, v54, v55
  ds_read_b128 v[232:235], v15 offset:2208
  ds_read_b128 v[236:239], v15 offset:2224
  s_waitcnt lgkmcnt(4)
  s_barrier
  s_waitcnt vmcnt(6)
  v_mfma_f32_32x32x16_bf16 v[64:79], v[32:35], v[188:191], v[64:79]
  ds_read_b128 v[16:19], v4 offset:0
  ds_read_b128 v[20:23], v4 offset:1024
  v_lshlrev_b32 v48, 16, v128
  v_and_b32 v49, s99, v128
  v_lshlrev_b32 v50, 16, v129
  v_and_b32 v51, s99, v129
  v_lshlrev_b32 v52, 16, v130
  v_mfma_f32_32x32x16_bf16 v[80:95], v[36:39], v[188:191], v[80:95]
  ds_read_b128 v[24:27], v4 offset:2048
  ds_read_b128 v[28:31], v4 offset:3072
  v_and_b32 v53, s99, v130
  v_lshlrev_b32 v54, 16, v131
  v_and_b32 v55, s99, v131
  v_fma_f32 v48, v48, v208, v216
  v_fma_f32 v49, v49, v209, v217
  v_mfma_f32_32x32x16_bf16 v[96:111], v[40:43], v[188:191], v[96:111]
  ds_read_b128 v[192:195], v15 offset:2304
  ds_read_b128 v[196:199], v15 offset:2320
  v_fma_f32 v50, v50, v210, v218
  v_fma_f32 v51, v51, v211, v219
  v_fma_f32 v52, v52, v212, v220
  v_fma_f32 v53, v53, v213, v221
  v_fma_f32 v54, v54, v214, v222
  buffer_load_dwordx4 v[156:159], v3, s[8:11], s36 offen offset:3072
  v_mfma_f32_32x32x16_bf16 v[112:127], v[44:47], v[188:191], v[112:127]
  v_fma_f32 v55, v55, v215, v223
  v_cvt_pk_bf16_f32 v128, v48, v49
  v_cvt_pk_bf16_f32 v129, v50, v51
  v_cvt_pk_bf16_f32 v130, v52, v53
  v_cvt_pk_bf16_f32 v131, v54, v55
  ds_read_b128 v[200:203], v15 offset:2336
  ds_read_b128 v[204:207], v15 offset:2352
  s_waitcnt lgkmcnt(4)
  s_waitcnt vmcnt(6)
  v_mfma_f32_32x32x16_bf16 v[64:79], v[16:19], v[128:131], v[64:79]
  ds_read_b128 v[32:35], v4 offset:4096
  ds_read_b128 v[36:39], v4 offset:5120
  v_lshlrev_b32 v48, 16, v132
  v_and_b32 v49, s99, v132
  v_lshlrev_b32 v50, 16, v133
  v_and_b32 v51, s99, v133
  v_lshlrev_b32 v52, 16, v134
  v_mfma_f32_32x32x16_bf16 v[80:95], v[20:23], v[128:131], v[80:95]
  ds_read_b128 v[40:43], v4 offset:6144
  ds_read_b128 v[44:47], v4 offset:7168
  v_and_b32 v53, s99, v134
  v_lshlrev_b32 v54, 16, v135
  v_and_b32 v55, s99, v135
  v_fma_f32 v48, v48, v224, v232
  v_fma_f32 v49, v49, v225, v233
  v_mfma_f32_32x32x16_bf16 v[96:111], v[24:27], v[128:131], v[96:111]
  ds_read_b128 v[208:211], v15 offset:2432
  ds_read_b128 v[212:215], v15 offset:2448
  v_fma_f32 v50, v50, v226, v234
  v_fma_f32 v51, v51, v227, v235
  v_fma_f32 v52, v52, v228, v236
  v_fma_f32 v53, v53, v229, v237
  v_fma_f32 v54, v54, v230, v238
  s_mov_b32 s35, s39
  s_add_u32 s39, s39, 4096
  buffer_load_dwordx4 v[160:163], v3, s[8:11], s35 offen offset:0
  v_mfma_f32_32x32x16_bf16 v[112:127], v[28:31], v[128:131], v[112:127]
  v_fma_f32 v55, v55, v231, v239
  v_cvt_pk_bf16_f32 v132, v48, v49
  v_cvt_pk_bf16_f32 v133, v50, v51
  v_cvt_pk_bf16_f32 v134, v52, v53
  v_cvt_pk_bf16_f32 v135, v54, v55
  ds_read_b128 v[216:219], v15 offset:2464
  ds_read_b128 v[220:223], v15 offset:2480
  s_waitcnt lgkmcnt(4)
  s_waitcnt vmcnt(6)
  v_mfma_f32_32x32x16_bf16 v[64:79], v[32:35], v[132:135], v[64:79]
  ds_read_b128 v[16:19], v4 offset:8192
  ds_read_b128 v[20:23], v4 offset:9216
  v_lshlrev_b32 v48, 16, v136
  v_and_b32 v49, s99, v136
  v_lshlrev_b32 v50, 16, v137
  v_and_b32 v51, s99, v137
  v_lshlrev_b32 v52, 16, v138
  v_mfma_f32_32x32x16_bf16 v[80:95], v[36:39], v[132:135], v[80:95]
  ds_read_b128 v[24:27], v4 offset:10240
  ds_read_b128 v[28:31], v4 offset:11264
  v_and_b32 v53, s99, v138
  v_lshlrev_b32 v54, 16, v139
  v_and_b32 v55, s99, v139
  v_fma_f32 v48, v48, v192, v200
  v_fma_f32 v49, v49, v193, v201
  v_mfma_f32_32x32x16_bf16 v[96:111], v[40:43], v[132:135], v[96:111]
  ds_read_b128 v[224:227], v15 offset:2560
  ds_read_b128 v[228:231], v15 offset:2576
  v_fma_f32 v50, v50, v194, v202
  v_fma_f32 v51, v51, v195, v203
  v_fma_f32 v52, v52, v196, v204
  v_fma_f32 v53, v53, v197, v205
  v_fma_f32 v54, v54, v198, v206
  buffer_load_dwordx4 v[164:167], v3, s[8:11], s35 offen offset:1024
  v_mfma_f32_32x32x16_bf16 v[112:127], v[44:47], v[132:135], v[112:127]
  v_fma_f32 v55, v55, v199, v207
  v_cvt_pk_bf16_f32 v136, v48, v49
  v_cvt_pk_bf16_f32 v137, v50, v51
  v_cvt_pk_bf16_f32 v138, v52, v53
  v_cvt_pk_bf16_f32 v139, v54, v55
  ds_read_b128 v[232:235], v15 offset:2592
  ds_read_b128 v[236:239], v15 offset:2608
  s_waitcnt lgkmcnt(4)
  s_waitcnt vmcnt(6)
  v_mfma_f32_32x32x16_bf16 v[64:79], v[16:19], v[136:139], v[64:79]
  ds_read_b128 v[32:35], v4 offset:12288
  ds_read_b128 v[36:39], v4 offset:13312
  v_lshlrev_b32 v48, 16, v140
  v_and_b32 v49, s99, v140
  v_lshlrev_b32 v50, 16, v141
  v_and_b32 v51, s99, v141
  v_lshlrev_b32 v52, 16, v142
  v_mfma_f32_32x32x16_bf16 v[80:95], v[20:23], v[136:139], v[80:95]
  ds_read_b128 v[40:43], v4 offset:14336
  ds_read_b128 v[44:47], v4 offset:15360
  v_and_b32 v53, s99, v142
  v_lshlrev_b32 v54, 16, v143
  v_and_b32 v55, s99, v143
  v_fma_f32 v48, v48, v208, v216
  v_fma_f32 v49, v49, v209, v217
  v_mfma_f32_32x32x16_bf16 v[96:111], v[24:27], v[136:139], v[96:111]
  ds_read_b128 v[192:195], v15 offset:2688
  ds_read_b128 v[196:199], v15 offset:2704
  v_fma_f32 v50, v50, v210, v218
  v_fma_f32 v51, v51, v211, v219
  v_fma_f32 v52, v52, v212, v220
  v_fma_f32 v53, v53, v213, v221
  v_fma_f32 v54, v54, v214, v222
  buffer_load_dwordx4 v[168:171], v3, s[8:11], s35 offen offset:2048
  v_mfma_f32_32x32x16_bf16 v[112:127], v[28:31], v[136:139], v[112:127]
  v_fma_f32 v55, v55, v215, v223
  v_cvt_pk_bf16_f32 v140, v48, v49
  v_cvt_pk_bf16_f32 v141, v50, v51
  v_cvt_pk_bf16_f32 v142, v52, v53
  v_cvt_pk_bf16_f32 v143, v54, v55
  ds_read_b128 v[200:203], v15 offset:2720
  ds_read_b128 v[204:207], v15 offset:2736
  s_waitcnt lgkmcnt(4)
  s_waitcnt vmcnt(6)
  v_mfma_f32_32x32x16_bf16 v[64:79], v[32:35], v[140:143], v[64:79]
  ds_read_b128 v[16:19], v4 offset:16384
  ds_read_b128 v[20:23], v4 offset:17408
  v_lshlrev_b32 v48, 16, v144
  v_and_b32 v49, s99, v144
  v_lshlrev_b32 v50, 16, v145
  v_and_b32 v51, s99, v145
  v_lshlrev_b32 v52, 16, v146
  v_mfma_f32_32x32x16_bf16 v[80:95], v[36:39], v[140:143], v[80:95]
  ds_read_b128 v[24:27], v4 offset:18432
  ds_read_b128 v[28:31], v4 offset:19456
  v_and_b32 v53, s99, v146
  v_lshlrev_b32 v54, 16, v147
  v_and_b32 v55, s99, v147
  v_fma_f32 v48, v48, v224, v232
  v_fma_f32 v49, v49, v225, v233
  v_mfma_f32_32x32x16_bf16 v[96:111], v[40:43], v[140:143], v[96:111]
  ds_read_b128 v[208:211], v15 offset:2816
  ds_read_b128 v[212:215], v15 offset:2832
  v_fma_f32 v50, v50, v226, v234
  v_fma_f32 v51, v51, v227, v235
  v_fma_f32 v52, v52, v228, v236
  v_fma_f32 v53, v53, v229, v237
  v_fma_f32 v54, v54, v230, v238
  buffer_load_dwordx4 v[172:175], v3, s[8:11], s35 offen offset:3072
  v_mfma_f32_32x32x16_bf16 v[112:127], v[44:47], v[140:143], v[112:127]
  v_fma_f32 v55, v55, v231, v239
  v_cvt_pk_bf16_f32 v144, v48, v49
  v_cvt_pk_bf16_f32 v145, v50, v51
  v_cvt_pk_bf16_f32 v146, v52, v53
  v_cvt_pk_bf16_f32 v147, v54, v55
  ds_read_b128 v[216:219], v15 offset:2848
  ds_read_b128 v[220:223], v15 offset:2864
  s_waitcnt lgkmcnt(4)
  s_waitcnt vmcnt(6)
  v_mfma_f32_32x32x16_bf16 v[64:79], v[16:19], v[144:147], v[64:79]
  ds_read_b128 v[32:35], v4 offset:20480
  ds_read_b128 v[36:39], v4 offset:21504
  v_lshlrev_b32 v48, 16, v148
  v_and_b32 v49, s99, v148
  v_lshlrev_b32 v50, 16, v149
  v_and_b32 v51, s99, v149
  v_lshlrev_b32 v52, 16, v150
  v_mfma_f32_32x32x16_bf16 v[80:95], v[20:23], v[144:147], v[80:95]
  ds_read_b128 v[40:43], v4 offset:22528
  ds_read_b128 v[44:47], v4 offset:23552
  v_and_b32 v53, s99, v150
  v_lshlrev_b32 v54, 16, v151
  v_and_b32 v55, s99, v151
  v_fma_f32 v48, v48, v192, v200
  v_fma_f32 v49, v49, v193, v201
  v_mfma_f32_32x32x16_bf16 v[96:111], v[24:27], v[144:147], v[96:111]
  ds_read_b128 v[224:227], v15 offset:2944
  ds_read_b128 v[228:231], v15 offset:2960
  v_fma_f32 v50, v50, v194, v202
  v_fma_f32 v51, v51, v195, v203
  v_fma_f32 v52, v52, v196, v204
  v_fma_f32 v53, v53, v197, v205
  v_fma_f32 v54, v54, v198, v206
  s_mov_b32 s36, s39
  s_add_u32 s39, s39, 4096
  buffer_load_dwordx4 v[176:179], v3, s[8:11], s36 offen offset:0
  v_mfma_f32_32x32x16_bf16 v[112:127], v[28:31], v[144:147], v[112:127]
  v_fma_f32 v55, v55, v199, v207
  v_cvt_pk_bf16_f32 v148, v48, v49
  v_cvt_pk_bf16_f32 v149, v50, v51
  v_cvt_pk_bf16_f32 v150, v52, v53
  v_cvt_pk_bf16_f32 v151, v54, v55
  ds_read_b128 v[232:235], v15 offset:2976
  ds_read_b128 v[236:239], v15 offset:2992
  s_waitcnt lgkmcnt(4)
  s_waitcnt vmcnt(6)
  v_mfma_f32_32x32x16_bf16 v[64:79], v[32:35], v[148:151], v[64:79]
  ds_read_b128 v[16:19], v4 offset:24576
  ds_read_b128 v[20:23], v4 offset:25600
  v_lshlrev_b32 v48, 16, v152
  v_and_b32 v49, s99, v152
  v_lshlrev_b32 v50, 16, v153
  v_and_b32 v51, s99, v153
  v_lshlrev_b32 v52, 16, v154
  v_mfma_f32_32x32x16_bf16 v[80:95], v[36:39], v[148:151], v[80:95]
  ds_read_b128 v[24:27], v4 offset:26624
  ds_read_b128 v[28:31], v4 offset:27648
  v_and_b32 v53, s99, v154
  v_lshlrev_b32 v54, 16, v155
  v_and_b32 v55, s99, v155
  v_fma_f32 v48, v48, v208, v216
  v_fma_f32 v49, v49, v209, v217
  v_mfma_f32_32x32x16_bf16 v[96:111], v[40:43], v[148:151], v[96:111]
  ds_read_b128 v[192:195], v15 offset:3072
  ds_read_b128 v[196:199], v15 offset:3088
  v_fma_f32 v50, v50, v210, v218
  v_fma_f32 v51, v51, v211, v219
  v_fma_f32 v52, v52, v212, v220
  v_fma_f32 v53, v53, v213, v221
  v_fma_f32 v54, v54, v214, v222
  buffer_load_dwordx4 v[180:183], v3, s[8:11], s36 offen offset:1024
  v_mfma_f32_32x32x16_bf16 v[112:127], v[44:47], v[148:151], v[112:127]
  v_fma_f32 v55, v55, v215, v223
  v_cvt_pk_bf16_f32 v152, v48, v49
  v_cvt_pk_bf16_f32 v153, v50, v51
  v_cvt_pk_bf16_f32 v154, v52, v53
  v_cvt_pk_bf16_f32 v155, v54, v55
  ds_read_b128 v[200:203], v15 offset:3104
  ds_read_b128 v[204:207], v15 offset:3120
  s_waitcnt lgkmcnt(4)
  s_waitcnt vmcnt(6)
  v_mfma_f32_32x32x16_bf16 v[64:79], v[16:19], v[152:155], v[64:79]
  ds_read_b128 v[32:35], v4 offset:28672
  ds_read_b128 v[36:39], v4 offset:29696
  v_lshlrev_b32 v48, 16, v156
  v_and_b32 v49, s99, v156
  v_lshlrev_b32 v50, 16, v157
  v_and_b32 v51, s99, v157
  v_lshlrev_b32 v52, 16, v158
  v_mfma_f32_32x32x16_bf16 v[80:95], v[20:23], v[152:155], v[80:95]
  ds_read_b128 v[40:43], v4 offset:30720
  ds_read_b128 v[44:47], v4 offset:31744
  v_and_b32 v53, s99, v158
  v_lshlrev_b32 v54, 16, v159
  v_and_b32 v55, s99, v159
  v_fma_f32 v48, v48, v224, v232
  v_fma_f32 v49, v49, v225, v233
  v_mfma_f32_32x32x16_bf16 v[96:111], v[24:27], v[152:155], v[96:111]
  ds_read_b128 v[208:211], v15 offset:3200
  ds_read_b128 v[212:215], v15 offset:3216
  v_fma_f32 v50, v50, v226, v234
  v_fma_f32 v51, v51, v227, v235
  v_fma_f32 v52, v52, v228, v236
  v_fma_f32 v53, v53, v229, v237
  v_fma_f32 v54, v54, v230, v238
  buffer_load_dwordx4 v[184:187], v3, s[8:11], s36 offen offset:2048
  v_mfma_f32_32x32x16_bf16 v[112:127], v[28:31], v[152:155], v[112:127]
  v_fma_f32 v55, v55, v231, v239
  v_cvt_pk_bf16_f32 v156, v48, v49
  v_cvt_pk_bf16_f32 v157, v50, v51
  v_cvt_pk_bf16_f32 v158, v52, v53
  v_cvt_pk_bf16_f32 v159, v54, v55
  ds_read_b128 v[216:219], v15 offset:3232
  ds_read_b128 v[220:223], v15 offset:3248
  s_waitcnt lgkmcnt(4)
  s_barrier
  s_waitcnt vmcnt(6)
  v_mfma_f32_32x32x16_bf16 v[64:79], v[32:35], v[156:159], v[64:79]
  ds_read_b128 v[16:19], v4 offset:32768
  ds_read_b128 v[20:23], v4 offset:33792
  v_lshlrev_b32 v48, 16, v160
  v_and_b32 v49, s99, v160
  v_lshlrev_b32 v50, 16, v161
  v_and_b32 v51, s99, v161
  v_lshlrev_b32 v52, 16, v162
  v_mfma_f32_32x32x16_bf16 v[80:95], v[36:39], v[156:159], v[80:95]
  ds_read_b128 v[24:27], v4 offset:34816
  ds_read_b128 v[28:31], v4 offset:35840
  v_and_b32 v53, s99, v162
  v_lshlrev_b32 v54, 16, v163
  v_and_b32 v55, s99, v163
  v_fma_f32 v48, v48, v192, v200
  v_fma_f32 v49, v49, v193, v201
  v_mfma_f32_32x32x16_bf16 v[96:111], v[40:43], v[156:159], v[96:111]
  ds_read_b128 v[224:227], v15 offset:3328
  ds_read_b128 v[228:231], v15 offset:3344
  v_fma_f32 v50, v50, v194, v202
  v_fma_f32 v51, v51, v195, v203
  v_fma_f32 v52, v52, v196, v204
  v_fma_f32 v53, v53, v197, v205
  v_fma_f32 v54, v54, v198, v206
  buffer_load_dwordx4 v[188:191], v3, s[8:11], s36 offen offset:3072
  v_mfma_f32_32x32x16_bf16 v[112:127], v[44:47], v[156:159], v[112:127]
  v_fma_f32 v55, v55, v199, v207
  v_cvt_pk_bf16_f32 v160, v48, v49
  v_cvt_pk_bf16_f32 v161, v50, v51
  v_cvt_pk_bf16_f32 v162, v52, v53
  v_cvt_pk_bf16_f32 v163, v54, v55
  ds_read_b128 v[232:235], v15 offset:3360
  ds_read_b128 v[236:239], v15 offset:3376
  s_waitcnt lgkmcnt(4)
  s_waitcnt vmcnt(6)
  v_mfma_f32_32x32x16_bf16 v[64:79], v[16:19], v[160:163], v[64:79]
  ds_read_b128 v[32:35], v4 offset:36864
  ds_read_b128 v[36:39], v4 offset:37888
  v_lshlrev_b32 v48, 16, v164
  v_and_b32 v49, s99, v164
  v_lshlrev_b32 v50, 16, v165
  v_and_b32 v51, s99, v165
  v_lshlrev_b32 v52, 16, v166
  v_mfma_f32_32x32x16_bf16 v[80:95], v[20:23], v[160:163], v[80:95]
  ds_read_b128 v[40:43], v4 offset:38912
  ds_read_b128 v[44:47], v4 offset:39936
  v_and_b32 v53, s99, v166
  v_lshlrev_b32 v54, 16, v167
  v_and_b32 v55, s99, v167
  v_fma_f32 v48, v48, v208, v216
  v_fma_f32 v49, v49, v209, v217
  v_mfma_f32_32x32x16_bf16 v[96:111], v[24:27], v[160:163], v[96:111]
  ds_read_b128 v[192:195], v15 offset:3456
  ds_read_b128 v[196:199], v15 offset:3472
  v_fma_f32 v50, v50, v210, v218
  v_fma_f32 v51, v51, v211, v219
  v_fma_f32 v52, v52, v212, v220
  v_fma_f32 v53, v53, v213, v221
  v_fma_f32 v54, v54, v214, v222
  s_mov_b32 s35, s39
  s_add_u32 s39, s39, 4096
  buffer_load_dwordx4 v[128:131], v3, s[8:11], s35 offen offset:0
  v_mfma_f32_32x32x16_bf16 v[112:127], v[28:31], v[160:163], v[112:127]
  v_fma_f32 v55, v55, v215, v223
  v_cvt_pk_bf16_f32 v164, v48, v49
  v_cvt_pk_bf16_f32 v165, v50, v51
  v_cvt_pk_bf16_f32 v166, v52, v53
  v_cvt_pk_bf16_f32 v167, v54, v55
  ds_read_b128 v[200:203], v15 offset:3488
  ds_read_b128 v[204:207], v15 offset:3504
  s_waitcnt lgkmcnt(4)
  s_waitcnt vmcnt(6)
  v_mfma_f32_32x32x16_bf16 v[64:79], v[32:35], v[164:167], v[64:79]
  ds_read_b128 v[16:19], v4 offset:40960
  ds_read_b128 v[20:23], v4 offset:41984
  v_lshlrev_b32 v48, 16, v168
  v_and_b32 v49, s99, v168
  v_lshlrev_b32 v50, 16, v169
  v_and_b32 v51, s99, v169
  v_lshlrev_b32 v52, 16, v170
  v_mfma_f32_32x32x16_bf16 v[80:95], v[36:39], v[164:167], v[80:95]
  ds_read_b128 v[24:27], v4 offset:43008
  ds_read_b128 v[28:31], v4 offset:44032
  v_and_b32 v53, s99, v170
  v_lshlrev_b32 v54, 16, v171
  v_and_b32 v55, s99, v171
  v_fma_f32 v48, v48, v224, v232
  v_fma_f32 v49, v49, v225, v233
  v_mfma_f32_32x32x16_bf16 v[96:111], v[40:43], v[164:167], v[96:111]
  ds_read_b128 v[208:211], v15 offset:3584
  ds_read_b128 v[212:215], v15 offset:3600
  v_fma_f32 v50, v50, v226, v234
  v_fma_f32 v51, v51, v227, v235
  v_fma_f32 v52, v52, v228, v236
  v_fma_f32 v53, v53, v229, v237
  v_fma_f32 v54, v54, v230, v238
  buffer_load_dwordx4 v[132:135], v3, s[8:11], s35 offen offset:1024
  v_mfma_f32_32x32x16_bf16 v[112:127], v[44:47], v[164:167], v[112:127]
  v_fma_f32 v55, v55, v231, v239
  v_cvt_pk_bf16_f32 v168, v48, v49
  v_cvt_pk_bf16_f32 v169, v50, v51
  v_cvt_pk_bf16_f32 v170, v52, v53
  v_cvt_pk_bf16_f32 v171, v54, v55
  ds_read_b128 v[216:219], v15 offset:3616
  ds_read_b128 v[220:223], v15 offset:3632
  s_waitcnt lgkmcnt(4)
  s_waitcnt vmcnt(6)
  v_mfma_f32_32x32x16_bf16 v[64:79], v[16:19], v[168:171], v[64:79]
  ds_read_b128 v[32:35], v4 offset:45056
  ds_read_b128 v[36:39], v4 offset:46080
  v_lshlrev_b32 v48, 16, v172
  v_and_b32 v49, s99, v172
  v_lshlrev_b32 v50, 16, v173
  v_and_b32 v51, s99, v173
  v_lshlrev_b32 v52, 16, v174
  v_mfma_f32_32x32x16_bf16 v[80:95], v[20:23], v[168:171], v[80:95]
  ds_read_b128 v[40:43], v4 offset:47104
  ds_read_b128 v[44:47], v4 offset:48128
  v_and_b32 v53, s99, v174
  v_lshlrev_b32 v54, 16, v175
  v_and_b32 v55, s99, v175
  v_fma_f32 v48, v48, v192, v200
  v_fma_f32 v49, v49, v193, v201
  v_mfma_f32_32x32x16_bf16 v[96:111], v[24:27], v[168:171], v[96:111]
  ds_read_b128 v[224:227], v15 offset:3712
  ds_read_b128 v[228:231], v15 offset:3728
  v_fma_f32 v50, v50, v194, v202
  v_fma_f32 v51, v51, v195, v203
  v_fma_f32 v52, v52, v196, v204
  v_fma_f32 v53, v53, v197, v205
  v_fma_f32 v54, v54, v198, v206
  buffer_load_dwordx4 v[136:139], v3, s[8:11], s35 offen offset:2048
  v_mfma_f32_32x32x16_bf16 v[112:127], v[28:31], v[168:171], v[112:127]
  v_fma_f32 v55, v55, v199, v207
  v_cvt_pk_bf16_f32 v172, v48, v49
  v_cvt_pk_bf16_f32 v173, v50, v51
  v_cvt_pk_bf16_f32 v174, v52, v53
  v_cvt_pk_bf16_f32 v175, v54, v55
  ds_read_b128 v[232:235], v15 offset:3744
  ds_read_b128 v[236:239], v15 offset:3760
  s_waitcnt lgkmcnt(4)
  s_waitcnt vmcnt(6)
  v_mfma_f32_32x32x16_bf16 v[64:79], v[32:35], v[172:175], v[64:79]
  ds_read_b128 v[16:19], v3 offset:0
  ds_read_b128 v[20:23], v3 offset:1024
  v_lshlrev_b32 v48, 16, v176
  v_and_b32 v49, s99, v176
  v_lshlrev_b32 v50, 16, v177
  v_and_b32 v51, s99, v177
  v_lshlrev_b32 v52, 16, v178
  v_mfma_f32_32x32x16_bf16 v[80:95], v[36:39], v[172:175], v[80:95]
  ds_read_b128 v[24:27], v3 offset:2048
  ds_read_b128 v[28:31], v3 offset:3072
  v_and_b32 v53, s99, v178
  v_lshlrev_b32 v54, 16, v179
  v_and_b32 v55, s99, v179
  v_fma_f32 v48, v48, v208, v216
  v_fma_f32 v49, v49, v209, v217
  v_mfma_f32_32x32x16_bf16 v[96:111], v[40:43], v[172:175], v[96:111]
  ds_read_b128 v[192:195], v15 offset:3840
  ds_read_b128 v[196:199], v15 offset:3856
  v_fma_f32 v50, v50, v210, v218
  v_fma_f32 v51, v51, v211, v219
  v_fma_f32 v52, v52, v212, v220
  v_fma_f32 v53, v53, v213, v221
  v_fma_f32 v54, v54, v214, v222
  buffer_load_dwordx4 v[140:143], v3, s[8:11], s35 offen offset:3072
  v_mfma_f32_32x32x16_bf16 v[112:127], v[44:47], v[172:175], v[112:127]
  v_fma_f32 v55, v55, v215, v223
  v_cvt_pk_bf16_f32 v176, v48, v49
  v_cvt_pk_bf16_f32 v177, v50, v51
  v_cvt_pk_bf16_f32 v178, v52, v53
  v_cvt_pk_bf16_f32 v179, v54, v55
  ds_read_b128 v[200:203], v15 offset:3872
  ds_read_b128 v[204:207], v15 offset:3888
  s_waitcnt lgkmcnt(4)
  s_waitcnt vmcnt(6)
  v_mfma_f32_32x32x16_bf16 v[64:79], v[16:19], v[176:179], v[64:79]
  ds_read_b128 v[32:35], v3 offset:4096
  ds_read_b128 v[36:39], v3 offset:5120
  v_lshlrev_b32 v48, 16, v180
  v_and_b32 v49, s99, v180
  v_lshlrev_b32 v50, 16, v181
  v_and_b32 v51, s99, v181
  v_lshlrev_b32 v52, 16, v182
  v_mfma_f32_32x32x16_bf16 v[80:95], v[20:23], v[176:179], v[80:95]
  ds_read_b128 v[40:43], v3 offset:6144
  ds_read_b128 v[44:47], v3 offset:7168
  v_and_b32 v53, s99, v182
  v_lshlrev_b32 v54, 16, v183
  v_and_b32 v55, s99, v183
  v_fma_f32 v48, v48, v224, v232
  v_fma_f32 v49, v49, v225, v233
  v_mfma_f32_32x32x16_bf16 v[96:111], v[24:27], v[176:179], v[96:111]
  ds_read_b128 v[208:211], v15 offset:3968
  ds_read_b128 v[212:215], v15 offset:3984
  v_fma_f32 v50, v50, v226, v234
  v_fma_f32 v51, v51, v227, v235
  v_fma_f32 v52, v52, v228, v236
  v_fma_f32 v53, v53, v229, v237
  v_fma_f32 v54, v54, v230, v238
  s_mov_b32 s36, s39
  s_add_u32 s39, s39, 4096
  buffer_load_dwordx4 v[144:147], v3, s[8:11], s36 offen offset:0
  v_mfma_f32_32x32x16_bf16 v[112:127], v[28:31], v[176:179], v[112:127]
  v_fma_f32 v55, v55, v231, v239
  v_cvt_pk_bf16_f32 v180, v48, v49
  v_cvt_pk_bf16_f32 v181, v50, v51
  v_cvt_pk_bf16_f32 v182, v52, v53
  v_cvt_pk_bf16_f32 v183, v54, v55
  ds_read_b128 v[216:219], v15 offset:4000
  ds_read_b128 v[220:223], v15 offset:4016
  s_waitcnt lgkmcnt(4)
  s_waitcnt vmcnt(6)
  v_mfma_f32_32x32x16_bf16 v[64:79], v[32:35], v[180:183], v[64:79]
  ds_read_b128 v[16:19], v3 offset:8192
  ds_read_b128 v[20:23], v3 offset:9216
  v_lshlrev_b32 v48, 16, v184
  v_and_b32 v49, s99, v184
  v_lshlrev_b32 v50, 16, v185
  v_and_b32 v51, s99, v185
  v_lshlrev_b32 v52, 16, v186
  v_mfma_f32_32x32x16_bf16 v[80:95], v[36:39], v[180:183], v[80:95]
  ds_read_b128 v[24:27], v3 offset:10240
  ds_read_b128 v[28:31], v3 offset:11264
  v_and_b32 v53, s99, v186
  v_lshlrev_b32 v54, 16, v187
  v_and_b32 v55, s99, v187
  v_fma_f32 v48, v48, v192, v200
  v_fma_f32 v49, v49, v193, v201
  v_mfma_f32_32x32x16_bf16 v[96:111], v[40:43], v[180:183], v[96:111]
  ds_read_b128 v[224:227], v15 offset:4096
  ds_read_b128 v[228:231], v15 offset:4112
  v_fma_f32 v50, v50, v194, v202
  v_fma_f32 v51, v51, v195, v203
  v_fma_f32 v52, v52, v196, v204
  v_fma_f32 v53, v53, v197, v205
  v_fma_f32 v54, v54, v198, v206
  buffer_load_dwordx4 v[148:151], v3, s[8:11], s36 offen offset:1024
  v_mfma_f32_32x32x16_bf16 v[112:127], v[44:47], v[180:183], v[112:127]
  v_fma_f32 v55, v55, v199, v207
  v_cvt_pk_bf16_f32 v184, v48, v49
  v_cvt_pk_bf16_f32 v185, v50, v51
  v_cvt_pk_bf16_f32 v186, v52, v53
  v_cvt_pk_bf16_f32 v187, v54, v55
  ds_read_b128 v[232:235], v15 offset:4128
  ds_read_b128 v[236:239], v15 offset:4144
  s_waitcnt lgkmcnt(4)
  s_waitcnt vmcnt(6)
  v_mfma_f32_32x32x16_bf16 v[64:79], v[16:19], v[184:187], v[64:79]
  ds_read_b128 v[32:35], v3 offset:12288
  ds_read_b128 v[36:39], v3 offset:13312
  v_lshlrev_b32 v48, 16, v188
  v_and_b32 v49, s99, v188
  v_lshlrev_b32 v50, 16, v189
  v_and_b32 v51, s99, v189
  v_lshlrev_b32 v52, 16, v190
  v_mfma_f32_32x32x16_bf16 v[80:95], v[20:23], v[184:187], v[80:95]
  ds_read_b128 v[40:43], v3 offset:14336
  ds_read_b128 v[44:47], v3 offset:15360
  v_and_b32 v53, s99, v190
  v_lshlrev_b32 v54, 16, v191
  v_and_b32 v55, s99, v191
  v_fma_f32 v48, v48, v208, v216
  v_fma_f32 v49, v49, v209, v217
  v_mfma_f32_32x32x16_bf16 v[96:111], v[24:27], v[184:187], v[96:111]
  ds_read_b128 v[192:195], v15 offset:4224
  ds_read_b128 v[196:199], v15 offset:4240
  v_fma_f32 v50, v50, v210, v218
  v_fma_f32 v51, v51, v211, v219
  v_fma_f32 v52, v52, v212, v220
  v_fma_f32 v53, v53, v213, v221
  v_fma_f32 v54, v54, v214, v222
  buffer_load_dwordx4 v[152:155], v3, s[8:11], s36 offen offset:2048
  v_mfma_f32_32x32x16_bf16 v[112:127], v[28:31], v[184:187], v[112:127]
  v_fma_f32 v55, v55, v215, v223
  v_cvt_pk_bf16_f32 v188, v48, v49
  v_cvt_pk_bf16_f32 v189, v50, v51
  v_cvt_pk_bf16_f32 v190, v52, v53
  v_cvt_pk_bf16_f32 v191, v54, v55
  ds_read_b128 v[200:203], v15 offset:4256
  ds_read_b128 v[204:207], v15 offset:4272
  s_waitcnt lgkmcnt(4)
  s_waitcnt vmcnt(6)
  v_mfma_f32_32x32x16_bf16 v[64:79], v[32:35], v[188:191], v[64:79]
  ds_read_b128 v[16:19], v3 offset:16384
  ds_read_b128 v[20:23], v3 offset:17408
  v_lshlrev_b32 v48, 16, v128
  v_and_b32 v49, s99, v128
  v_lshlrev_b32 v50, 16, v129
  v_and_b32 v51, s99, v129
  v_lshlrev_b32 v52, 16, v130
  v_mfma_f32_32x32x16_bf16 v[80:95], v[36:39], v[188:191], v[80:95]
  ds_read_b128 v[24:27], v3 offset:18432
  ds_read_b128 v[28:31], v3 offset:19456
  v_and_b32 v53, s99, v130
  v_lshlrev_b32 v54, 16, v131
  v_and_b32 v55, s99, v131
  v_fma_f32 v48, v48, v224, v232
  v_fma_f32 v49, v49, v225, v233
  v_mfma_f32_32x32x16_bf16 v[96:111], v[40:43], v[188:191], v[96:111]
  ds_read_b128 v[208:211], v15 offset:4352
  ds_read_b128 v[212:215], v15 offset:4368
  v_fma_f32 v50, v50, v226, v234
  v_fma_f32 v51, v51, v227, v235
  v_fma_f32 v52, v52, v228, v236
  v_fma_f32 v53, v53, v229, v237
  v_fma_f32 v54, v54, v230, v238
  buffer_load_dwordx4 v[156:159], v3, s[8:11], s36 offen offset:3072
  v_mfma_f32_32x32x16_bf16 v[112:127], v[44:47], v[188:191], v[112:127]
  v_fma_f32 v55, v55, v231, v239
  v_cvt_pk_bf16_f32 v128, v48, v49
  v_cvt_pk_bf16_f32 v129, v50, v51
  v_cvt_pk_bf16_f32 v130, v52, v53
  v_cvt_pk_bf16_f32 v131, v54, v55
  ds_read_b128 v[216:219], v15 offset:4384
  ds_read_b128 v[220:223], v15 offset:4400
  s_waitcnt lgkmcnt(4)
  s_waitcnt vmcnt(6)
  v_mfma_f32_32x32x16_bf16 v[64:79], v[16:19], v[128:131], v[64:79]
  ds_read_b128 v[32:35], v3 offset:20480
  ds_read_b128 v[36:39], v3 offset:21504
  v_lshlrev_b32 v48, 16, v132
  v_and_b32 v49, s99, v132
  v_lshlrev_b32 v50, 16, v133
  v_and_b32 v51, s99, v133
  v_lshlrev_b32 v52, 16, v134
  v_mfma_f32_32x32x16_bf16 v[80:95], v[20:23], v[128:131], v[80:95]
  ds_read_b128 v[40:43], v3 offset:22528
  ds_read_b128 v[44:47], v3 offset:23552
  v_and_b32 v53, s99, v134
  v_lshlrev_b32 v54, 16, v135
  v_and_b32 v55, s99, v135
  v_fma_f32 v48, v48, v192, v200
  v_fma_f32 v49, v49, v193, v201
  v_mfma_f32_32x32x16_bf16 v[96:111], v[24:27], v[128:131], v[96:111]
  ds_read_b128 v[224:227], v15 offset:4480
  ds_read_b128 v[228:231], v15 offset:4496
  v_fma_f32 v50, v50, v194, v202
  v_fma_f32 v51, v51, v195, v203
  v_fma_f32 v52, v52, v196, v204
  v_fma_f32 v53, v53, v197, v205
  v_fma_f32 v54, v54, v198, v206
  v_mfma_f32_32x32x16_bf16 v[112:127], v[28:31], v[128:131], v[112:127]
  v_fma_f32 v55, v55, v199, v207
  v_cvt_pk_bf16_f32 v132, v48, v49
  v_cvt_pk_bf16_f32 v133, v50, v51
  v_cvt_pk_bf16_f32 v134, v52, v53
  v_cvt_pk_bf16_f32 v135, v54, v55
  ds_read_b128 v[232:235], v15 offset:4512
  ds_read_b128 v[236:239], v15 offset:4528
  s_waitcnt lgkmcnt(4)
  s_waitcnt vmcnt(5)
  v_mfma_f32_32x32x16_bf16 v[64:79], v[32:35], v[132:135], v[64:79]
  ds_read_b128 v[16:19], v3 offset:24576
  ds_read_b128 v[20:23], v3 offset:25600
  v_lshlrev_b32 v48, 16, v136
  v_and_b32 v49, s99, v136
  v_lshlrev_b32 v50, 16, v137
  v_and_b32 v51, s99, v137
  v_lshlrev_b32 v52, 16, v138
  v_mfma_f32_32x32x16_bf16 v[80:95], v[36:39], v[132:135], v[80:95]
  ds_read_b128 v[24:27], v3 offset:26624
  ds_read_b128 v[28:31], v3 offset:27648
  v_and_b32 v53, s99, v138
  v_lshlrev_b32 v54, 16, v139
  v_and_b32 v55, s99, v139
  v_fma_f32 v48, v48, v208, v216
  v_fma_f32 v49, v49, v209, v217
  v_mfma_f32_32x32x16_bf16 v[96:111], v[40:43], v[132:135], v[96:111]
  ds_read_b128 v[192:195], v15 offset:4608
  ds_read_b128 v[196:199], v15 offset:4624
  v_fma_f32 v50, v50, v210, v218
  v_fma_f32 v51, v51, v211, v219
  v_fma_f32 v52, v52, v212, v220
  v_fma_f32 v53, v53, v213, v221
  v_fma_f32 v54, v54, v214, v222
  v_mfma_f32_32x32x16_bf16 v[112:127], v[44:47], v[132:135], v[112:127]
  v_fma_f32 v55, v55, v215, v223
  v_cvt_pk_bf16_f32 v136, v48, v49
  v_cvt_pk_bf16_f32 v137, v50, v51
  v_cvt_pk_bf16_f32 v138, v52, v53
  v_cvt_pk_bf16_f32 v139, v54, v55
  ds_read_b128 v[200:203], v15 offset:4640
  ds_read_b128 v[204:207], v15 offset:4656
  s_waitcnt lgkmcnt(4)
  s_waitcnt vmcnt(4)
  v_mfma_f32_32x32x16_bf16 v[64:79], v[16:19], v[136:139], v[64:79]
  ds_read_b128 v[32:35], v3 offset:28672
  ds_read_b128 v[36:39], v3 offset:29696
  v_lshlrev_b32 v48, 16, v140
  v_and_b32 v49, s99, v140
  v_lshlrev_b32 v50, 16, v141
  v_and_b32 v51, s99, v141
  v_lshlrev_b32 v52, 16, v142
  v_mfma_f32_32x32x16_bf16 v[80:95], v[20:23], v[136:139], v[80:95]
  ds_read_b128 v[40:43], v3 offset:30720
  ds_read_b128 v[44:47], v3 offset:31744
  v_and_b32 v53, s99, v142
  v_lshlrev_b32 v54, 16, v143
  v_and_b32 v55, s99, v143
  v_fma_f32 v48, v48, v224, v232
  v_fma_f32 v49, v49, v225, v233
  v_mfma_f32_32x32x16_bf16 v[96:111], v[24:27], v[136:139], v[96:111]
  ds_read_b128 v[208:211], v15 offset:4736
  ds_read_b128 v[212:215], v15 offset:4752
  v_fma_f32 v50, v50, v226, v234
  v_fma_f32 v51, v51, v227, v235
  v_fma_f32 v52, v52, v228, v236
  v_fma_f32 v53, v53, v229, v237
  v_fma_f32 v54, v54, v230, v238
  v_mfma_f32_32x32x16_bf16 v[112:127], v[28:31], v[136:139], v[112:127]
  v_fma_f32 v55, v55, v231, v239
  v_cvt_pk_bf16_f32 v140, v48, v49
  v_cvt_pk_bf16_f32 v141, v50, v51
  v_cvt_pk_bf16_f32 v142, v52, v53
  v_cvt_pk_bf16_f32 v143, v54, v55
  ds_read_b128 v[216:219], v15 offset:4768
  ds_read_b128 v[220:223], v15 offset:4784
  s_waitcnt lgkmcnt(4)
  s_waitcnt vmcnt(3)
  v_mfma_f32_32x32x16_bf16 v[64:79], v[32:35], v[140:143], v[64:79]
  ds_read_b128 v[16:19], v3 offset:32768
  ds_read_b128 v[20:23], v3 offset:33792
  v_lshlrev_b32 v48, 16, v144
  v_and_b32 v49, s99, v144
  v_lshlrev_b32 v50, 16, v145
  v_and_b32 v51, s99, v145
  v_lshlrev_b32 v52, 16, v146
  v_mfma_f32_32x32x16_bf16 v[80:95], v[36:39], v[140:143], v[80:95]
  ds_read_b128 v[24:27], v3 offset:34816
  ds_read_b128 v[28:31], v3 offset:35840
  v_and_b32 v53, s99, v146
  v_lshlrev_b32 v54, 16, v147
  v_and_b32 v55, s99, v147
  v_fma_f32 v48, v48, v192, v200
  v_fma_f32 v49, v49, v193, v201
  v_mfma_f32_32x32x16_bf16 v[96:111], v[40:43], v[140:143], v[96:111]
  ds_read_b128 v[224:227], v15 offset:4864
  ds_read_b128 v[228:231], v15 offset:4880
  v_fma_f32 v50, v50, v194, v202
  v_fma_f32 v51, v51, v195, v203
  v_fma_f32 v52, v52, v196, v204
  v_fma_f32 v53, v53, v197, v205
  v_fma_f32 v54, v54, v198, v206
  v_mfma_f32_32x32x16_bf16 v[112:127], v[44:47], v[140:143], v[112:127]
  v_fma_f32 v55, v55, v199, v207
  v_cvt_pk_bf16_f32 v144, v48, v49
  v_cvt_pk_bf16_f32 v145, v50, v51
  v_cvt_pk_bf16_f32 v146, v52, v53
  v_cvt_pk_bf16_f32 v147, v54, v55
  ds_read_b128 v[232:235], v15 offset:4896
  ds_read_b128 v[236:239], v15 offset:4912
  s_waitcnt lgkmcnt(4)
  s_waitcnt vmcnt(2)
  v_mfma_f32_32x32x16_bf16 v[64:79], v[16:19], v[144:147], v[64:79]
  ds_read_b128 v[32:35], v3 offset:36864
  ds_read_b128 v[36:39], v3 offset:37888
  v_lshlrev_b32 v48, 16, v148
  v_and_b32 v49, s99, v148
  v_lshlrev_b32 v50, 16, v149
  v_and_b32 v51, s99, v149
  v_lshlrev_b32 v52, 16, v150
  v_mfma_f32_32x32x16_bf16 v[80:95], v[20:23], v[144:147], v[80:95]
  ds_read_b128 v[40:43], v3 offset:38912
  ds_read_b128 v[44:47], v3 offset:39936
  v_and_b32 v53, s99, v150
  v_lshlrev_b32 v54, 16, v151
  v_and_b32 v55, s99, v151
  v_fma_f32 v48, v48, v208, v216
  v_fma_f32 v49, v49, v209, v217
  v_mfma_f32_32x32x16_bf16 v[96:111], v[24:27], v[144:147], v[96:111]
  ds_read_b128 v[192:195], v15 offset:4992
  ds_read_b128 v[196:199], v15 offset:5008
  v_fma_f32 v50, v50, v210, v218
  v_fma_f32 v51, v51, v211, v219
  v_fma_f32 v52, v52, v212, v220
  v_fma_f32 v53, v53, v213, v221
  v_fma_f32 v54, v54, v214, v222
  v_mfma_f32_32x32x16_bf16 v[112:127], v[28:31], v[144:147], v[112:127]
  v_fma_f32 v55, v55, v215, v223
  v_cvt_pk_bf16_f32 v148, v48, v49
  v_cvt_pk_bf16_f32 v149, v50, v51
  v_cvt_pk_bf16_f32 v150, v52, v53
  v_cvt_pk_bf16_f32 v151, v54, v55
  ds_read_b128 v[200:203], v15 offset:5024
  ds_read_b128 v[204:207], v15 offset:5040
  s_waitcnt lgkmcnt(4)
  s_waitcnt vmcnt(1)
  v_mfma_f32_32x32x16_bf16 v[64:79], v[32:35], v[148:151], v[64:79]
  ds_read_b128 v[16:19], v3 offset:40960
  ds_read_b128 v[20:23], v3 offset:41984
  v_lshlrev_b32 v48, 16, v152
  v_and_b32 v49, s99, v152
  v_lshlrev_b32 v50, 16, v153
  v_and_b32 v51, s99, v153
  v_lshlrev_b32 v52, 16, v154
  v_mfma_f32_32x32x16_bf16 v[80:95], v[36:39], v[148:151], v[80:95]
  ds_read_b128 v[24:27], v3 offset:43008
  ds_read_b128 v[28:31], v3 offset:44032
  v_and_b32 v53, s99, v154
  v_lshlrev_b32 v54, 16, v155
  v_and_b32 v55, s99, v155
  v_fma_f32 v48, v48, v224, v232
  v_fma_f32 v49, v49, v225, v233
  v_mfma_f32_32x32x16_bf16 v[96:111], v[40:43], v[148:151], v[96:111]
  v_fma_f32 v50, v50, v226, v234
  v_fma_f32 v51, v51, v227, v235
  v_fma_f32 v52, v52, v228, v236
  v_fma_f32 v53, v53, v229, v237
  v_fma_f32 v54, v54, v230, v238
  v_mfma_f32_32x32x16_bf16 v[112:127], v[44:47], v[148:151], v[112:127]
  v_fma_f32 v55, v55, v231, v239
  v_cvt_pk_bf16_f32 v152, v48, v49
  v_cvt_pk_bf16_f32 v153, v50, v51
  v_cvt_pk_bf16_f32 v154, v52, v53
  v_cvt_pk_bf16_f32 v155, v54, v55
  s_nop 1
  s_waitcnt lgkmcnt(0)
  s_waitcnt vmcnt(0)
  v_mfma_f32_32x32x16_bf16 v[64:79], v[16:19], v[152:155], v[64:79]
  ds_read_b128 v[32:35], v3 offset:45056
  ds_read_b128 v[36:39], v3 offset:46080
  v_lshlrev_b32 v48, 16, v156
  v_and_b32 v49, s99, v156
  v_lshlrev_b32 v50, 16, v157
  v_and_b32 v51, s99, v157
  v_lshlrev_b32 v52, 16, v158
  v_mfma_f32_32x32x16_bf16 v[80:95], v[20:23], v[152:155], v[80:95]
  ds_read_b128 v[40:43], v3 offset:47104
  ds_read_b128 v[44:47], v3 offset:48128
  v_and_b32 v53, s99, v158
  v_lshlrev_b32 v54, 16, v159
  v_and_b32 v55, s99, v159
  v_fma_f32 v48, v48, v192, v200
  v_fma_f32 v49, v49, v193, v201
  v_mfma_f32_32x32x16_bf16 v[96:111], v[24:27], v[152:155], v[96:111]
  v_fma_f32 v50, v50, v194, v202
  v_fma_f32 v51, v51, v195, v203
  v_fma_f32 v52, v52, v196, v204
  v_fma_f32 v53, v53, v197, v205
  v_fma_f32 v54, v54, v198, v206
  v_mfma_f32_32x32x16_bf16 v[112:127], v[28:31], v[152:155], v[112:127]
  v_fma_f32 v55, v55, v199, v207
  v_cvt_pk_bf16_f32 v156, v48, v49
  v_cvt_pk_bf16_f32 v157, v50, v51
  v_cvt_pk_bf16_f32 v158, v52, v53
  v_cvt_pk_bf16_f32 v159, v54, v55
  s_nop 1
  s_waitcnt lgkmcnt(0)
  v_mfma_f32_32x32x16_bf16 v[64:79], v[32:35], v[156:159], v[64:79]
  v_mfma_f32_32x32x16_bf16 v[80:95], v[36:39], v[156:159], v[80:95]
  v_mfma_f32_32x32x16_bf16 v[96:111], v[40:43], v[156:159], v[96:111]
  v_mfma_f32_32x32x16_bf16 v[112:127], v[44:47], v[156:159], v[112:127]
  s_nop 1
  s_add_u32 s20, s4, 0xe74000
  s_addc_u32 s21, s5, 0
  s_and_b32 s21, s21, 0xffff
  s_mov_b32 s22, 0x200000
  s_mov_b32 s23, 0x20000
  s_add_u32 s24, s4, 0x1074000
  s_addc_u32 s25, s5, 0
  s_and_b32 s25, s25, 0xffff
  s_mov_b32 s26, 0x100000
  s_mov_b32 s27, 0x20000
  v_lshlrev_b32 v6, 3, v2
  v_lshrrev_b32 v7, 5, v2
  v_and_b32 v8, 31, v2
  v_cmp_eq_u32 s[46:47], 0, v7
  s_add_u32 s44, s3, 8
  s_lshl_b32 s45, s44, 11
  s_add_u32 s45, s45, 18432
  v_lshlrev_b32 v11, 6, v8
  v_add_u32 v11, s45, v11
  v_lshrrev_b32 v8, 1, v8
  v_and_b32 v8, 7, v8
  v_mov_b32 v12, 5
  v_cndmask_b32 v12, 0, v12, s[46:47]
  v_xor_b32 v12, v12, v8
  v_lshl_add_u32 v12, v12, 3, v11
  v_add_u32 v13, 1, v7
  v_xor_b32 v13, v13, v8
  v_lshl_add_u32 v13, v13, 3, v11
  v_add_u32 v14, 3, v7
  v_xor_b32 v14, v14, v8
  v_lshl_add_u32 v14, v14, 3, v11
  v_add_u32 v15, 6, v7
  v_xor_b32 v15, v15, v8
  v_lshl_add_u32 v15, v15, 3, v11
  v_mov_b32 v36, 0x3f80
  v_mov_b32 v37, 0
  v_cndmask_b32 v38, 0, v36, s[46:47]
  v_mov_b32 v39, 0
  s_barrier
  v_cvt_pk_bf16_f32 v16, v84, v85
  v_cvt_pk_bf16_f32 v17, v86, v87
  v_cvt_pk_bf16_f32 v18, v88, v89
  v_cvt_pk_bf16_f32 v19, v90, v91
  v_cvt_pk_bf16_f32 v20, v92, v93
  v_cvt_pk_bf16_f32 v21, v94, v95
  v_cndmask_b32 v22, v16, v36, s[46:47]
  v_cndmask_b32 v23, v17, v37, s[46:47]
  ds_write_b64 v13, v[18:19] offset:0
  ds_write_b64 v14, v[20:21] offset:0
  ds_write_b64 v12, v[22:23] offset:0
  ds_write_b64 v15, v[38:39] offset:0
  v_cvt_pk_bf16_f32 v26, v116, v117
  v_cvt_pk_bf16_f32 v27, v118, v119
  v_cvt_pk_bf16_f32 v28, v120, v121
  v_cvt_pk_bf16_f32 v29, v122, v123
  v_cvt_pk_bf16_f32 v30, v124, v125
  v_cvt_pk_bf16_f32 v31, v126, v127
  v_cndmask_b32 v32, v26, v36, s[46:47]
  v_cndmask_b32 v33, v27, v37, s[46:47]
  ds_write_b64 v13, v[28:29] offset:43008
  ds_write_b64 v14, v[30:31] offset:43008
  ds_write_b64 v12, v[32:33] offset:43008
  ds_write_b64 v15, v[38:39] offset:43008
  s_waitcnt lgkmcnt(0)
  s_barrier
  s_lshl_b32 s45, s44, 10
  v_add_u32 v9, s45, v3
  s_lshl_b32 s45, s44, 9
  s_add_u32 s45, s45, 12288
  v_add_u32 v10, s45, v6
  s_mul_i32 s45, s3, 1536
  s_add_u32 s45, s45, 106496
  v_add_u32 v14, s45, v3
  v_add_u32 v15, s45, v6
  v_cvt_pk_bf16_f32 v40, v76, v77
  v_cvt_pk_bf16_f32 v41, v78, v79
  v_cvt_pk_bf16_f32 v42, v80, v81
  v_cvt_pk_bf16_f32 v43, v82, v83
  s_lshl_b32 s45, s31, 1
  s_add_u32 s45, s45, 0
  s_lshl_b32 s48, s45, 6
  s_add_u32 s48, s48, s32
  s_lshl_b32 s49, s48, 10
  s_lshl_b32 s53, s48, 9
  buffer_store_dwordx4 v[40:43], v3, s[20:23], s49 offen sc1
  buffer_store_dwordx2 v[16:17], v6, s[24:27], s53 offen sc1
  ds_write_b128 v9, v[40:43] offset:0
  ds_write_b64 v10, v[16:17] offset:0
  v_cvt_pk_bf16_f32 v224, v64, v65
  v_cvt_pk_bf16_f32 v225, v66, v67
  v_cvt_pk_bf16_f32 v226, v68, v69
  v_cvt_pk_bf16_f32 v227, v70, v71
  v_cvt_pk_bf16_f32 v228, v72, v73
  v_cvt_pk_bf16_f32 v229, v74, v75
  v_cvt_pk_bf16_f32 v44, v108, v109
  v_cvt_pk_bf16_f32 v45, v110, v111
  v_cvt_pk_bf16_f32 v46, v112, v113
  v_cvt_pk_bf16_f32 v47, v114, v115
  s_lshl_b32 s45, s31, 1
  s_add_u32 s45, s45, 1
  s_lshl_b32 s48, s45, 6
  s_add_u32 s48, s48, s32
  s_lshl_b32 s49, s48, 10
  s_lshl_b32 s53, s48, 9
  buffer_store_dwordx4 v[44:47], v3, s[20:23], s49 offen sc1
  buffer_store_dwordx2 v[26:27], v6, s[24:27], s53 offen sc1
  ds_write_b128 v9, v[44:47] offset:43008
  ds_write_b64 v10, v[26:27] offset:43008
  v_cvt_pk_bf16_f32 v48, v96, v97
  v_cvt_pk_bf16_f32 v49, v98, v99
  v_cvt_pk_bf16_f32 v50, v100, v101
  v_cvt_pk_bf16_f32 v51, v102, v103
  v_cvt_pk_bf16_f32 v52, v104, v105
  v_cvt_pk_bf16_f32 v53, v106, v107
  ds_write_b128 v14, v[48:51]
  ds_write_b64 v15, v[52:53] offset:1024
  s_waitcnt lgkmcnt(0)
  s_waitcnt vmcnt(0)
  v_mov_b32 v12, 161792
  v_mov_b32 v13, 1
  s_mov_b64 exec, 1
  ds_add_u32 v12, v13
  s_mov_b64 exec, -1
  s_cmp_lg_u32 s3, 0
  s_cbranch_scc1 L_p_k3_1
  v_mov_b32 v12, 161792
  s_mov_b32 s63, 320000
L_p_lw_3:
  ds_read_b32 v14, v12
  s_waitcnt lgkmcnt(0)
  v_readfirstlane_b32 s60, v14
  s_cmp_ge_u32 s60, 8
  s_cbranch_scc1 L_p_lwd_4
  s_sub_u32 s63, s63, 1
  s_cmp_lg_u32 s63, 0
  s_cbranch_scc1 L_p_lw_3
L_p_lwd_4:
  s_lshl_b32 s60, s30, 4
  s_add_u32 s60, s60, s31
  s_lshl_b32 s60, s60, 7
  v_mov_b32 v12, s60
  v_mov_b32 v13, 1
  s_mov_b64 exec, 1
  buffer_store_dword v13, v12, s[16:19], 0 offen sc1
  s_mov_b64 exec, -1
  s_cmp_eq_u32 s30, 0
  s_cbranch_scc1 L_p_k3b_2
  s_sub_u32 s61, s60, 2048
  s_sub_u32 s62, s61, 2048
  s_cmp_eq_u32 s30, 1
  s_cselect_b32 s62, s61, s62
  v_mov_b32 v12, s62
  v_writelane_b32 v12, s61, 0
  s_mov_b64 exec, 3
  s_mov_b32 s63, 40000
L_p_poll_5:
  buffer_load_dword v14, v12, s[16:19], 0 offen sc1
  s_waitcnt vmcnt(0)
  v_cmp_le_u32 vcc, 1, v14
  s_nop 1
  s_cmp_eq_u64 vcc, exec
  s_cbranch_scc1 L_p_polled_6
  s_sub_u32 s63, s63, 1
  s_cmp_lg_u32 s63, 0
  s_cbranch_scc1 L_p_poll_5
L_p_polled_6:
  s_mov_b64 exec, -1
L_p_k3b_2:
  v_mov_b32 v12, 161796
  v_mov_b32 v13, 1
  s_mov_b64 exec, 1
  ds_write_b32 v12, v13
  s_mov_b64 exec, -1
  s_branch L_C_fetch
L_p_k3_1:
  v_mov_b32 v12, 161796
  s_mov_b32 s63, 320000
L_p_lw_7:
  ds_read_b32 v14, v12
  s_waitcnt lgkmcnt(0)
  v_readfirstlane_b32 s60, v14
  s_cmp_ge_u32 s60, 1
  s_cbranch_scc1 L_p_lwd_8
  s_sub_u32 s63, s63, 1
  s_cmp_lg_u32 s63, 0
  s_cbranch_scc1 L_p_lw_7
L_p_lwd_8:
  s_branch L_C_fetch
L_H_qkv:
  v_lshlrev_b32 v12, 2, v2
  v_add_u32 v12, 161792, v12
  v_mov_b32 v13, 0
  ds_write_b32 v12, v13
  s_mov_b32 s28, s34
  s_add_u32 s20, s4, 0x236c000
  s_addc_u32 s21, s5, 0
  s_and_b32 s21, s21, 0xffff
  s_mov_b32 s22, 0x7800
  s_mov_b32 s23, 0x20000
  s_lshl_b32 s59, s29, 10
  v_add_u32 v8, s59, v3
  s_mov_b32 s59, 0
  buffer_load_dwordx4 v[112:115], v8, s[20:23], s59 offen
  s_mov_b32 s59, 15360
  buffer_load_dwordx4 v[116:119], v8, s[20:23], s59 offen
  s_mov_b32 s59, 2560
  buffer_load_dwordx4 v[120:123], v8, s[20:23], s59 offen
  s_mov_b32 s59, 17920
  buffer_load_dwordx4 v[124:127], v8, s[20:23], s59 offen
  s_mul_i32 s62, s29, 4096
  s_add_u32 m0, s62, 0
  s_add_u32 s61, s28, s62
  s_add_u32 s28, s28, 16384
  buffer_load_dwordx4 v3, s[12:15], s61 offen offset:0  lds
  buffer_load_dwordx4 v3, s[12:15], s61 offen offset:1024  lds
  buffer_load_dwordx4 v3, s[12:15], s61 offen offset:2048  lds
  buffer_load_dwordx4 v3, s[12:15], s61 offen offset:3072  lds
  s_add_u32 m0, s62, 16384
  s_add_u32 s61, s28, s62
  s_add_u32 s28, s28, 16384
  buffer_load_dwordx4 v3, s[12:15], s61 offen offset:0  lds
  buffer_load_dwordx4 v3, s[12:15], s61 offen offset:1024  lds
  buffer_load_dwordx4 v3, s[12:15], s61 offen offset:2048  lds
  buffer_load_dwordx4 v3, s[12:15], s61 offen offset:3072  lds
  s_waitcnt vmcnt(8)
  v_add_f32 v112, v112, v116
  v_add_f32 v113, v113, v117
  v_add_f32 v114, v114, v118
  v_add_f32 v115, v115, v119
  v_cvt_pk_bf16_f32 v116, v112, v113
  v_lshlrev_b32 v112, 16, v116
  v_and_b32 v113, 0xffff0000, v116
  v_cvt_pk_bf16_f32 v116, v114, v115
  v_lshlrev_b32 v114, 16, v116
  v_and_b32 v115, 0xffff0000, v116
  v_add_f32 v120, v120, v124
  v_add_f32 v121, v121, v125
  v_add_f32 v122, v122, v126
  v_add_f32 v123, v123, v127
  v_cvt_pk_bf16_f32 v124, v120, v121
  v_lshlrev_b32 v120, 16, v124
  v_and_b32 v121, 0xffff0000, v124
  v_cvt_pk_bf16_f32 v124, v122, v123
  v_lshlrev_b32 v122, 16, v124
  v_and_b32 v123, 0xffff0000, v124
  v_add_f32 v120, 1.0, v120
  v_add_f32 v121, 1.0, v121
  v_add_f32 v122, 1.0, v122
  v_add_f32 v123, 1.0, v123
  v_cvt_pk_bf16_f32 v124, v120, v121
  v_lshlrev_b32 v120, 16, v124
  v_and_b32 v121, 0xffff0000, v124
  v_cvt_pk_bf16_f32 v124, v122, v123
  v_lshlrev_b32 v122, 16, v124
  v_and_b32 v123, 0xffff0000, v124
  v_lshrrev_b32 v9, 5, v8
  v_lshlrev_b32 v9, 6, v9
  v_and_b32 v10, 16, v8
  v_add_u32 v9, v9, v10
  v_add_u32 v9, 147456, v9
  s_movk_i32 s59, 160*16
  v_cmp_gt_u32 vcc, s59, v8
  s_nop 1
  s_and_saveexec_b64 s[44:45], vcc
  ds_write_b128 v9, v[120:123]
  ds_write_b128 v9, v[112:115] offset:32
  s_mov_b64 exec, s[44:45]
  s_waitcnt lgkmcnt(0)
  s_barrier
  s_waitcnt lgkmcnt(0)
  s_waitcnt vmcnt(0)
  s_barrier
  s_add_u32 m0, s62, 32768
  s_add_u32 s61, s28, s62
  s_add_u32 s28, s28, 16384
  buffer_load_dwordx4 v3, s[12:15], s61 offen offset:0  lds
  buffer_load_dwordx4 v3, s[12:15], s61 offen offset:1024  lds
  buffer_load_dwordx4 v3, s[12:15], s61 offen offset:2048  lds
  buffer_load_dwordx4 v3, s[12:15], s61 offen offset:3072  lds
  s_add_u32 m0, s62, 49152
  s_add_u32 s61, s28, s62
  s_add_u32 s28, s28, 16384
  buffer_load_dwordx4 v3, s[12:15], s61 offen offset:0  lds
  buffer_load_dwordx4 v3, s[12:15], s61 offen offset:1024  lds
  buffer_load_dwordx4 v3, s[12:15], s61 offen offset:2048  lds
  buffer_load_dwordx4 v3, s[12:15], s61 offen offset:3072  lds
  s_add_u32 m0, s62, 65536
  s_add_u32 s61, s28, s62
  s_add_u32 s28, s28, 16384
  buffer_load_dwordx4 v3, s[12:15], s61 offen offset:0  lds
  buffer_load_dwordx4 v3, s[12:15], s61 offen offset:1024  lds
  buffer_load_dwordx4 v3, s[12:15], s61 offen offset:2048  lds
  buffer_load_dwordx4 v3, s[12:15], s61 offen offset:3072  lds
  s_add_u32 m0, s62, 81920
  s_add_u32 s61, s28, s62
  s_add_u32 s28, s28, 16384
  buffer_load_dwordx4 v3, s[12:15], s61 offen offset:0  lds
  buffer_load_dwordx4 v3, s[12:15], s61 offen offset:1024  lds
  buffer_load_dwordx4 v3, s[12:15], s61 offen offset:2048  lds
  buffer_load_dwordx4 v3, s[12:15], s61 offen offset:3072  lds
  s_waitcnt vmcnt(8)
  s_barrier
  s_add_u32 m0, s62, 98304
  s_add_u32 s61, s28, s62
  s_add_u32 s28, s28, 16384
  buffer_load_dwordx4 v3, s[12:15], s61 offen offset:0  lds
  buffer_load_dwordx4 v3, s[12:15], s61 offen offset:1024  lds
  buffer_load_dwordx4 v3, s[12:15], s61 offen offset:2048  lds
  buffer_load_dwordx4 v3, s[12:15], s61 offen offset:3072  lds
  s_add_u32 m0, s62, 0
  s_add_u32 s61, s28, s62
  s_add_u32 s28, s28, 16384
  buffer_load_dwordx4 v3, s[12:15], s61 offen offset:0  lds
  buffer_load_dwordx4 v3, s[12:15], s61 offen offset:1024  lds
  buffer_load_dwordx4 v3, s[12:15], s61 offen offset:2048  lds
  buffer_load_dwordx4 v3, s[12:15], s61 offen offset:3072  lds
  s_add_u32 m0, s62, 16384
  s_add_u32 s61, s28, s62
  s_add_u32 s28, s28, 16384
  buffer_load_dwordx4 v3, s[12:15], s61 offen offset:0  lds
  buffer_load_dwordx4 v3, s[12:15], s61 offen offset:1024  lds
  buffer_load_dwordx4 v3, s[12:15], s61 offen offset:2048  lds
  buffer_load_dwordx4 v3, s[12:15], s61 offen offset:3072  lds
  s_waitcnt vmcnt(12)
  s_barrier
  s_add_u32 m0, s62, 32768
  s_add_u32 s61, s28, s62
  s_add_u32 s28, s28, 16384
  buffer_load_dwordx4 v3, s[12:15], s61 offen offset:0  lds
  buffer_load_dwordx4 v3, s[12:15], s61 offen offset:1024  lds
  buffer_load_dwordx4 v3, s[12:15], s61 offen offset:2048  lds
  buffer_load_dwordx4 v3, s[12:15], s61 offen offset:3072  lds
  s_waitcnt vmcnt(0)
  s_barrier
  s_add_u32 s40, s4, 0x1174000
  s_addc_u32 s41, s5, 0
  s_and_b32 s41, s41, 0xffff
  s_mov_b32 s42, 0x400000
  s_mov_b32 s43, 0x20000
  s_add_u32 s44, s29, 8
  s_lshl_b32 s45, s44, 11
  s_add_u32 s45, s45, 18432
  v_add_u32 v9, s45, v3
  s_barrier
  s_barrier
  ds_read_b128 v[16:19], v9 offset:0
  ds_read_b128 v[20:23], v9 offset:1024
  ds_read_b128 v[24:27], v9 offset:43008
  ds_read_b128 v[28:31], v9 offset:44032
  s_lshl_b32 s45, s31, 1
  s_add_u32 s45, s45, 0
  s_lshl_b32 s45, s45, 17
  s_lshl_b32 s48, s32, 11
  s_add_u32 s45, s45, s48
  s_waitcnt lgkmcnt(2)
  buffer_store_dwordx4 v[16:19], v3, s[40:43], s45 offen offset:0 sc1
  buffer_store_dwordx4 v[20:23], v3, s[40:43], s45 offen offset:1024 sc1
  s_lshl_b32 s45, s31, 1
  s_add_u32 s45, s45, 1
  s_lshl_b32 s45, s45, 17
  s_lshl_b32 s48, s32, 11
  s_add_u32 s45, s45, s48
  s_waitcnt lgkmcnt(0)
  buffer_store_dwordx4 v[24:27], v3, s[40:43], s45 offen offset:0 sc1
  buffer_store_dwordx4 v[28:31], v3, s[40:43], s45 offen offset:1024 sc1
  s_waitcnt vmcnt(0)
  v_mov_b32 v12, 161792
  v_mov_b32 v13, 1
  s_mov_b64 exec, 1
  ds_add_u32 v12, v13
  s_mov_b64 exec, -1
  s_mul_i32 s61, s29, 3
  s_add_u32 s61, s61, 0
  s_lshl_b32 s59, s61, 6
  v_add_u32 v16, s59, v2
  v_mul_u32_u24 v17, 6554, v16
  v_lshrrev_b32 v17, 16, v17
  v_mul_u32_u24 v18, 10, v17
  v_sub_u32 v18, v16, v18
  v_mul_u32_u24 v17, 1280, v17
  v_lshlrev_b32 v18, 4, v18
  v_add_u32 v59, v17, v18
  v_cmp_le_u32 vcc, 640, v16
  v_mov_b32 v17, 0x40000000
  s_nop 0
  v_cndmask_b32 v59, v59, v17, vcc
  s_mul_i32 s61, s29, 3
  s_add_u32 s61, s61, 1
  s_lshl_b32 s59, s61, 6
  v_add_u32 v16, s59, v2
  v_mul_u32_u24 v17, 6554, v16
  v_lshrrev_b32 v17, 16, v17
  v_mul_u32_u24 v18, 10, v17
  v_sub_u32 v18, v16, v18
  v_mul_u32_u24 v17, 1280, v17
  v_lshlrev_b32 v18, 4, v18
  v_add_u32 v60, v17, v18
  v_cmp_le_u32 vcc, 640, v16
  v_mov_b32 v17, 0x40000000
  s_nop 0
  v_cndmask_b32 v60, v60, v17, vcc
  s_mul_i32 s61, s29, 3
  s_add_u32 s61, s61, 2
  s_lshl_b32 s59, s61, 6
  v_add_u32 v16, s59, v2
  v_mul_u32_u24 v17, 6554, v16
  v_lshrrev_b32 v17, 16, v17
  v_mul_u32_u24 v18, 10, v17
  v_sub_u32 v18, v16, v18
  v_mul_u32_u24 v17, 1280, v17
  v_lshlrev_b32 v18, 4, v18
  v_add_u32 v61, v17, v18
  v_cmp_le_u32 vcc, 640, v16
  v_mov_b32 v17, 0x40000000
  s_nop 0
  v_cndmask_b32 v61, v61, v17, vcc
  s_add_u32 s20, s4, 0x236c000
  s_addc_u32 s21, s5, 0
  s_and_b32 s21, s21, 0xffff
  s_mov_b32 s22, 0x7800
  s_mov_b32 s23, 0x20000
  s_cmp_eq_u32 s29, 0
  s_cselect_b32 s60, 2, 4
  s_cmp_eq_u32 s29, 1
  s_cselect_b32 s60, 5, s60
  s_mul_i32 s60, s60, 2560
  s_mul_i32 s61, s38, 320
  s_add_u32 s60, s60, s61
  v_add_u32 v9, s60, v3
  buffer_load_dwordx4 v[16:19], v9, s[20:23], 0 offen
  s_mov_b32 s59, 15360
  buffer_load_dwordx4 v[20:23], v9, s[20:23], s59 offen
  s_waitcnt vmcnt(0)
  v_add_f32 v16, v16, v20
  v_add_f32 v17, v17, v21
  v_add_f32 v18, v18, v22
  v_add_f32 v19, v19, v23
  v_cvt_pk_bf16_f32 v20, v16, v17
  v_lshlrev_b32 v16, 16, v20
  v_and_b32 v17, 0xffff0000, v20
  v_cvt_pk_bf16_f32 v20, v18, v19
  v_lshlrev_b32 v18, 16, v20
  v_and_b32 v19, 0xffff0000, v20
  s_cmp_lt_u32 s29, 2
  s_cbranch_scc1 L_p_noc2_9
  v_add_f32 v16, 1.0, v16
  v_add_f32 v17, 1.0, v17
  v_add_f32 v18, 1.0, v18
  v_add_f32 v19, 1.0, v19
  v_cvt_pk_bf16_f32 v20, v16, v17
  v_lshlrev_b32 v16, 16, v20
  v_and_b32 v17, 0xffff0000, v20
  v_cvt_pk_bf16_f32 v20, v18, v19
  v_lshlrev_b32 v18, 16, v20
  v_and_b32 v19, 0xffff0000, v20
L_p_noc2_9:
  s_min_u32 s59, s29, 2
  s_mul_i32 s59, s59, 320
  s_add_u32 s59, s59, 157696
  v_add_u32 v9, s59, v3
  s_cmp_eq_u32 s29, 3
  s_cselect_b32 s60, 0, 0xfffff
  s_mov_b32 exec_lo, s60
  s_mov_b32 exec_hi, 0
  ds_write_b128 v9, v[16:19]
  s_mov_b64 exec, -1
  s_waitcnt lgkmcnt(0)
  s_cmp_lg_u32 s29, 0
  s_cbranch_scc1 L_p_csp_10
  s_mul_i32 s44, s30, 5
  s_lshr_b32 s45, s44, 1
  s_lshl_b32 s46, s45, 6
  v_lshlrev_b32 v24, 4, v2
  v_add_u32 v24, s46, v24
  s_mov_b32 s59, 7680
  buffer_load_dwordx4 v[28:31], v24, s[20:23], s59 offen
  s_mov_b32 s59, 23040
  buffer_load_dwordx4 v[32:35], v24, s[20:23], s59 offen
  s_mov_b32 s59, 10240
  buffer_load_dwordx4 v[36:39], v24, s[20:23], s59 offen
  s_mov_b32 s59, 25600
  buffer_load_dwordx4 v[40:43], v24, s[20:23], s59 offen
  s_waitcnt vmcnt(0)
  v_add_f32 v28, v28, v32
  v_add_f32 v29, v29, v33
  v_add_f32 v30, v30, v34
  v_add_f32 v31, v31, v35
  v_cvt_pk_bf16_f32 v32, v28, v29
  v_lshlrev_b32 v28, 16, v32
  v_and_b32 v29, 0xffff0000, v32
  v_cvt_pk_bf16_f32 v32, v30, v31
  v_lshlrev_b32 v30, 16, v32
  v_and_b32 v31, 0xffff0000, v32
  v_add_f32 v36, v36, v40
  v_add_f32 v37, v37, v41
  v_add_f32 v38, v38, v42
  v_add_f32 v39, v39, v43
  v_cvt_pk_bf16_f32 v40, v36, v37
  v_lshlrev_b32 v36, 16, v40
  v_and_b32 v37, 0xffff0000, v40
  v_cvt_pk_bf16_f32 v40, v38, v39
  v_lshlrev_b32 v38, 16, v40
  v_and_b32 v39, 0xffff0000, v40
  v_add_f32 v36, 1.0, v36
  v_add_f32 v37, 1.0, v37
  v_add_f32 v38, 1.0, v38
  v_add_f32 v39, 1.0, v39
  v_cvt_pk_bf16_f32 v40, v36, v37
  v_lshlrev_b32 v36, 16, v40
  v_and_b32 v37, 0xffff0000, v40
  v_cvt_pk_bf16_f32 v40, v38, v39
  v_lshlrev_b32 v38, 16, v40
  v_and_b32 v39, 0xffff0000, v40
  v_lshrrev_b32 v25, 1, v2
  s_lshl_b32 s46, s45, 1
  s_sub_u32 s46, s46, s44
  v_add_u32 v26, s46, v25
  v_cmp_gt_u32 vcc, 5, v26
  s_nop 1
  v_cndmask_b32 v28, 0, v28, vcc
  v_cndmask_b32 v36, 0, v36, vcc
  v_cndmask_b32 v29, 0, v29, vcc
  v_cndmask_b32 v37, 0, v37, vcc
  v_cndmask_b32 v30, 0, v30, vcc
  v_cndmask_b32 v38, 0, v38, vcc
  v_cndmask_b32 v31, 0, v31, vcc
  v_cndmask_b32 v39, 0, v39, vcc
  v_lshlrev_b32 v25, 6, v25
  v_and_b32 v26, 1, v2
  v_lshl_add_u32 v25, v26, 4, v25
  v_add_u32 v25, 158720, v25
  s_mov_b64 exec, 0xfff
  ds_write_b128 v25, v[36:39]
  ds_write_b128 v25, v[28:31] offset:32
  s_mov_b64 exec, -1
  s_waitcnt lgkmcnt(0)
L_p_csp_10:
  v_mov_b32 v12, 161796
  s_mov_b32 s63, 320000
L_p_lw_11:
  ds_read_b32 v14, v12
  s_waitcnt lgkmcnt(0)
  v_readfirstlane_b32 s60, v14
  s_cmp_ge_u32 s60, 1
  s_cbranch_scc1 L_p_lwd_12
  s_sub_u32 s63, s63, 1
  s_cmp_lg_u32 s63, 0
  s_cbranch_scc1 L_p_lw_11
L_p_lwd_12:
  s_mul_i32 s45, s29, 1536
  s_add_u32 s45, s45, 106496
  v_add_u32 v14, s45, v3
  v_lshlrev_b32 v6, 3, v2
  v_add_u32 v15, s45, v6
  ds_read_b128 v[224:227], v14
  ds_read_b64 v[228:229], v15 offset:1024
L_C_fetch:
  s_add_u32 s20, s4, 0xe74000
  s_addc_u32 s21, s5, 0
  s_and_b32 s21, s21, 0xffff
  s_mov_b32 s22, 0x200000
  s_mov_b32 s23, 0x20000
  s_add_u32 s24, s4, 0x1074000
  s_addc_u32 s25, s5, 0
  s_and_b32 s25, s25, 0xffff
  s_mov_b32 s26, 0x100000
  s_mov_b32 s27, 0x20000
  s_add_u32 s40, s4, 0x1174000
  s_addc_u32 s41, s5, 0
  s_and_b32 s41, s41, 0xffff
  s_mov_b32 s42, 0x400000
  s_mov_b32 s43, 0x20000
  v_lshlrev_b32 v6, 3, v2
  s_lshl_b32 s45, s30, 2
  s_sub_i32 s45, s45, 8
  s_add_i32 s47, s45, s3
  s_cmp_lt_i32 s47, 0
  s_cbranch_scc1 L_p_nonb_13
  s_lshl_b32 s48, s31, 1
  s_add_u32 s48, s48, 0
  s_lshl_b32 s49, s48, 6
  s_add_u32 s49, s49, s47
  s_lshl_b32 s50, s49, 10
  s_lshl_b32 s51, s49, 9
  buffer_load_dwordx4 v[160:163], v3, s[20:23], s50 offen sc1
  buffer_load_dwordx2 v[164:165], v6, s[24:27], s51 offen sc1
  s_lshl_b32 s48, s31, 1
  s_add_u32 s48, s48, 1
  s_lshl_b32 s49, s48, 6
  s_add_u32 s49, s49, s47
  s_lshl_b32 s50, s49, 10
  s_lshl_b32 s51, s49, 9
  buffer_load_dwordx4 v[168:171], v3, s[20:23], s50 offen sc1
  buffer_load_dwordx2 v[172:173], v6, s[24:27], s51 offen sc1
  s_lshl_b32 s48, s31, 1
  s_add_u32 s48, s48, 0
  s_lshl_b32 s52, s48, 17
  s_lshl_b32 s53, s47, 11
  s_add_u32 s52, s52, s53
  buffer_load_dwordx4 v[176:179], v3, s[40:43], s52 offen offset:0 sc1
  buffer_load_dwordx4 v[180:183], v3, s[40:43], s52 offen offset:1024 sc1
  s_lshl_b32 s48, s31, 1
  s_add_u32 s48, s48, 1
  s_lshl_b32 s52, s48, 17
  s_lshl_b32 s53, s47, 11
  s_add_u32 s52, s52, s53
  buffer_load_dwordx4 v[184:187], v3, s[40:43], s52 offen offset:0 sc1
  buffer_load_dwordx4 v[188:191], v3, s[40:43], s52 offen offset:1024 sc1
  s_lshl_b32 s48, s3, 10
  v_add_u32 v9, s48, v3
  s_lshl_b32 s48, s3, 9
  s_add_u32 s48, s48, 12288
  v_add_u32 v10, s48, v6
  s_lshl_b32 s48, s3, 11
  s_add_u32 s48, s48, 18432
  v_add_u32 v56, s48, v3
  v_mov_b32 v57, v9
  v_mov_b32 v58, v10
L_p_nonb_13:
  v_and_b32 v9, 31, v2
  v_lshrrev_b32 v10, 5, v2
  v_lshlrev_b32 v10, 2, v10
  v_sub_u32 v9, v9, v10
  v_cmp_le_i32 s[64:65], 0, v9
  v_cmp_le_i32 s[66:67], 1, v9
  v_cmp_le_i32 s[68:69], 2, v9
  v_cmp_le_i32 s[70:71], 3, v9
  v_cmp_le_i32 s[72:73], 8, v9
  v_cmp_le_i32 s[74:75], 9, v9
  v_cmp_le_i32 s[76:77], 10, v9
  v_cmp_le_i32 s[78:79], 11, v9
  v_cmp_le_i32 s[80:81], 16, v9
  v_cmp_le_i32 s[82:83], 17, v9
  v_cmp_le_i32 s[84:85], 18, v9
  v_cmp_le_i32 s[86:87], 19, v9
  v_cmp_le_i32 s[88:89], 24, v9
  v_cmp_le_i32 s[90:91], 25, v9
  v_cmp_le_i32 s[92:93], 26, v9
  v_cmp_le_i32 s[94:95], 27, v9
  s_lshr_b32 s46, s3, 2
  s_mul_i32 s44, s46, 43008
  s_lshl_b32 s46, s29, 10
  s_add_u32 s46, s46, s44
  v_add_u32 v14, s46, v3
  s_lshl_b32 s46, s29, 9
  s_add_u32 s46, s46, s44
  s_add_u32 s46, s46, 12288
  v_add_u32 v15, s46, v6
  v_lshrrev_b32 v9, 5, v2
  v_lshlrev_b32 v9, 2, v9
  v_and_b32 v10, 15, v2
  v_lshrrev_b32 v10, 2, v10
  v_add_u32 v9, v9, v10
  v_lshrrev_b32 v10, 4, v2
  v_and_b32 v10, 1, v10
  v_lshlrev_b32 v10, 2, v10
  v_and_b32 v11, 3, v2
  v_add_u32 v10, v10, v11
  v_lshrrev_b32 v11, 1, v9
  v_xor_b32 v10, v10, v11
  v_lshlrev_b32 v9, 6, v9
  s_lshl_b32 s46, s29, 11
  s_add_u32 s46, s46, s44
  s_add_u32 s46, s46, 18432
  v_add_u32 v9, s46, v9
  v_lshl_add_u32 v7, v10, 3, v9
  v_xor_b32 v10, 4, v10
  v_lshl_add_u32 v13, v10, 3, v9
  v_add_u32 v13, 512, v13
  s_sub_i32 s49, 8, s32
  s_max_i32 s49, s49, 0
  s_mov_b32 s58, 0x3ea52b5c
  v_mov_b32 v9, 0xffff
  v_mov_b32 v10, 0xffff0000
  v_cndmask_b32 v230, 0, v9, s[64:65]
  v_cndmask_b32 v11, 0, v10, s[66:67]
  v_or_b32 v230, v230, v11
  v_cndmask_b32 v231, 0, v9, s[68:69]
  v_cndmask_b32 v11, 0, v10, s[70:71]
  v_or_b32 v231, v231, v11
  v_cndmask_b32 v232, 0, v9, s[72:73]
  v_cndmask_b32 v11, 0, v10, s[74:75]
  v_or_b32 v232, v232, v11
  v_cndmask_b32 v233, 0, v9, s[76:77]
  v_cndmask_b32 v11, 0, v10, s[78:79]
  v_or_b32 v233, v233, v11
  v_cndmask_b32 v234, 0, v9, s[80:81]
  v_cndmask_b32 v11, 0, v10, s[82:83]
  v_or_b32 v234, v234, v11
  v_cndmask_b32 v235, 0, v9, s[84:85]
  v_cndmask_b32 v11, 0, v10, s[86:87]
  v_or_b32 v235, v235, v11
  v_cndmask_b32 v236, 0, v9, s[88:89]
  v_cndmask_b32 v11, 0, v10, s[90:91]
  v_or_b32 v236, v236, v11
  v_cndmask_b32 v237, 0, v9, s[92:93]
  v_cndmask_b32 v11, 0, v10, s[94:95]
  v_or_b32 v237, v237, v11
  s_cmp_lt_i32 s47, 0
  s_cbranch_scc1 L_p_nonb2_14
  s_waitcnt vmcnt(4)
  ds_write_b128 v57, v[160:163] offset:0
  ds_write_b64 v58, v[164:165] offset:0
  ds_write_b128 v57, v[168:171] offset:43008
  ds_write_b64 v58, v[172:173] offset:43008
L_p_nonb2_14:
  s_cmp_lt_i32 s47, 0
  s_cbranch_scc1 L_p_nonb3_15
  s_waitcnt vmcnt(0)
  ds_write_b128 v56, v[176:179] offset:0
  ds_write_b128 v56, v[180:183] offset:1024
  ds_write_b128 v56, v[184:187] offset:43008
  ds_write_b128 v56, v[188:191] offset:44032
L_p_nonb3_15:
  s_waitcnt lgkmcnt(0)
  s_barrier
  s_cmp_lg_u32 s49, 0
  s_cbranch_scc1 L_p_slow_16
  s_cmp_ge_u32 s3, 4
  s_cbranch_scc1 L_p_fasth_18
  v_mov_b32 v31, 0xf149f2ca
  v_mov_b32 v208, 0
  v_mov_b32 v209, 0
  v_mov_b32 v210, 0
  v_mov_b32 v211, 0
  v_mov_b32 v212, 0
  v_mov_b32 v213, 0
  v_mov_b32 v214, 0
  v_mov_b32 v215, 0
  v_mov_b32 v216, 0
  v_mov_b32 v217, 0
  v_mov_b32 v218, 0
  v_mov_b32 v219, 0
  v_mov_b32 v220, 0
  v_mov_b32 v221, 0
  v_mov_b32 v222, 0
  v_mov_b32 v223, 0
  ds_read_b128 v[16:19], v14 offset:8192
  ds_read_b64 v[20:21], v15 offset:4096
  ds_read_b128 v[22:25], v14 offset:0
  ds_read_b64 v[26:27], v15 offset:0
  s_waitcnt lgkmcnt(2)
  v_mfma_f32_32x32x16_bf16 v[192:207], v[16:19], v[224:227], 0
  v_mfma_f32_32x32x8_bf16 v[192:207], v[20:21], v[228:229], v[192:207]
  ds_read_b128 v[16:19], v14 offset:1024
  ds_read_b64 v[20:21], v15 offset:512
  s_waitcnt lgkmcnt(2)
  v_mfma_f32_32x32x16_bf16 v[64:79], v[22:25], v[224:227], 0
  v_mfma_f32_32x32x8_bf16 v[64:79], v[26:27], v[228:229], v[64:79]
  ds_read_b128 v[22:25], v14 offset:2048
  ds_read_b64 v[26:27], v15 offset:1024
  s_waitcnt lgkmcnt(2)
  v_mfma_f32_32x32x16_bf16 v[80:95], v[16:19], v[224:227], 0
  v_mfma_f32_32x32x8_bf16 v[80:95], v[20:21], v[228:229], v[80:95]
  ds_read_b128 v[16:19], v14 offset:3072
  ds_read_b64 v[20:21], v15 offset:1536
  s_waitcnt lgkmcnt(2)
  v_mfma_f32_32x32x16_bf16 v[96:111], v[22:25], v[224:227], 0
  v_mfma_f32_32x32x8_bf16 v[96:111], v[26:27], v[228:229], v[96:111]
  ds_read_b128 v[22:25], v14 offset:4096
  ds_read_b64 v[26:27], v15 offset:2048
  s_waitcnt lgkmcnt(2)
  v_mfma_f32_32x32x16_bf16 v[112:127], v[16:19], v[224:227], 0
  v_cndmask_b32 v64, v64, v192, s[64:65]
  v_cndmask_b32 v65, v65, v193, s[66:67]
  v_cndmask_b32 v66, v66, v194, s[68:69]
  v_cndmask_b32 v67, v67, v195, s[70:71]
  v_cndmask_b32 v68, v68, v196, s[72:73]
  v_cndmask_b32 v69, v69, v197, s[74:75]
  v_cndmask_b32 v70, v70, v198, s[76:77]
  v_cndmask_b32 v71, v71, v199, s[78:79]
  v_mfma_f32_32x32x8_bf16 v[112:127], v[20:21], v[228:229], v[112:127]
  v_cndmask_b32 v72, v72, v200, s[80:81]
  v_cndmask_b32 v73, v73, v201, s[82:83]
  v_cndmask_b32 v74, v74, v202, s[84:85]
  v_cndmask_b32 v75, v75, v203, s[86:87]
  v_cndmask_b32 v76, v76, v204, s[88:89]
  v_cndmask_b32 v77, v77, v205, s[90:91]
  v_cndmask_b32 v78, v78, v206, s[92:93]
  v_cndmask_b32 v79, v79, v207, s[94:95]
  ds_read_b128 v[16:19], v14 offset:5120
  ds_read_b64 v[20:21], v15 offset:2560
  s_waitcnt lgkmcnt(2)
  v_mfma_f32_32x32x16_bf16 v[128:143], v[22:25], v[224:227], 0
  v_max3_f32 v28, v64, v65, v66
  v_max3_f32 v29, v67, v68, v69
  v_max3_f32 v28, v28, v70, v71
  v_max3_f32 v29, v29, v72, v73
  v_max3_f32 v28, v28, v74, v75
  v_max3_f32 v29, v29, v76, v77
  v_max3_f32 v28, v28, v78, v79
  v_max3_f32 v28, v28, v80, v81
  v_mfma_f32_32x32x8_bf16 v[128:143], v[26:27], v[228:229], v[128:143]
  v_max3_f32 v29, v29, v82, v83
  v_max3_f32 v28, v28, v84, v85
  v_max3_f32 v29, v29, v86, v87
  v_max3_f32 v28, v28, v88, v89
  v_max3_f32 v29, v29, v90, v91
  v_max3_f32 v28, v28, v92, v93
  v_max3_f32 v29, v29, v94, v95
  ds_read_b128 v[22:25], v14 offset:6144
  ds_read_b64 v[26:27], v15 offset:3072
  s_waitcnt lgkmcnt(2)
  v_mfma_f32_32x32x16_bf16 v[144:159], v[16:19], v[224:227], 0
  v_max3_f32 v28, v28, v96, v97
  v_max3_f32 v29, v29, v98, v99
  v_max3_f32 v28, v28, v100, v101
  v_max3_f32 v29, v29, v102, v103
  v_mfma_f32_32x32x8_bf16 v[144:159], v[20:21], v[228:229], v[144:159]
  v_max3_f32 v28, v28, v104, v105
  v_max3_f32 v29, v29, v106, v107
  v_max3_f32 v28, v28, v108, v109
  v_max3_f32 v29, v29, v110, v111
  ds_read_b128 v[16:19], v14 offset:7168
  ds_read_b64 v[20:21], v15 offset:3584
  s_waitcnt lgkmcnt(2)
  v_mfma_f32_32x32x16_bf16 v[160:175], v[22:25], v[224:227], 0
  v_max3_f32 v28, v28, v112, v113
  v_max3_f32 v29, v29, v114, v115
  v_max3_f32 v28, v28, v116, v117
  v_max3_f32 v29, v29, v118, v119
  v_mfma_f32_32x32x8_bf16 v[160:175], v[26:27], v[228:229], v[160:175]
  v_max3_f32 v28, v28, v120, v121
  v_max3_f32 v29, v29, v122, v123
  v_max3_f32 v28, v28, v124, v125
  v_max3_f32 v29, v29, v126, v127
  s_waitcnt lgkmcnt(0)
  v_mfma_f32_32x32x16_bf16 v[176:191], v[16:19], v[224:227], 0
  v_max3_f32 v28, v28, v128, v129
  v_max3_f32 v29, v29, v130, v131
  v_max3_f32 v28, v28, v132, v133
  v_max3_f32 v29, v29, v134, v135
  v_mfma_f32_32x32x8_bf16 v[176:191], v[20:21], v[228:229], v[176:191]
  v_max3_f32 v28, v28, v136, v137
  v_max3_f32 v29, v29, v138, v139
  v_max3_f32 v28, v28, v140, v141
  v_max3_f32 v29, v29, v142, v143
  v_max3_f32 v28, v28, v144, v145
  v_max3_f32 v29, v29, v146, v147
  v_max3_f32 v28, v28, v148, v149
  v_max3_f32 v29, v29, v150, v151
  v_max3_f32 v28, v28, v152, v153
  v_max3_f32 v29, v29, v154, v155
  v_max3_f32 v28, v28, v156, v157
  v_max3_f32 v29, v29, v158, v159
  s_nop 7
  v_max3_f32 v28, v28, v160, v161
  v_max3_f32 v29, v29, v162, v163
  v_max3_f32 v28, v28, v164, v165
  v_max3_f32 v29, v29, v166, v167
  v_max3_f32 v28, v28, v168, v169
  v_max3_f32 v29, v29, v170, v171
  v_max3_f32 v28, v28, v172, v173
  v_max3_f32 v29, v29, v174, v175
  s_nop 3
  v_max3_f32 v28, v28, v176, v177
  v_max3_f32 v29, v29, v178, v179
  v_max3_f32 v28, v28, v180, v181
  v_max3_f32 v29, v29, v182, v183
  v_max3_f32 v28, v28, v184, v185
  v_max3_f32 v29, v29, v186, v187
  v_max3_f32 v28, v28, v188, v189
  v_max3_f32 v29, v29, v190, v191
  v_max_f32 v28, v28, v29
  v_mov_b32 v29, v28
  s_nop 1
  v_permlane32_swap_b32 v28, v29
  s_nop 1
  v_max_f32 v28, v28, v29
  v_mul_f32 v30, s58, v28
  ds_read_b64_tr_b16 v[32:33], v7 offset:2048
  ds_read_b64_tr_b16 v[34:35], v13 offset:2048
  ds_read_b64_tr_b16 v[36:37], v7 offset:3072
  ds_read_b64_tr_b16 v[38:39], v13 offset:3072
  v_fma_f32 v80, v80, s58, -v30
  v_fma_f32 v81, v81, s58, -v30
  v_fma_f32 v82, v82, s58, -v30
  v_fma_f32 v83, v83, s58, -v30
  v_fma_f32 v84, v84, s58, -v30
  v_fma_f32 v85, v85, s58, -v30
  v_fma_f32 v86, v86, s58, -v30
  v_fma_f32 v87, v87, s58, -v30
  v_fma_f32 v88, v88, s58, -v30
  v_fma_f32 v89, v89, s58, -v30
  v_fma_f32 v90, v90, s58, -v30
  v_fma_f32 v91, v91, s58, -v30
  v_fma_f32 v92, v92, s58, -v30
  v_fma_f32 v93, v93, s58, -v30
  v_fma_f32 v94, v94, s58, -v30
  v_fma_f32 v95, v95, s58, -v30
  v_exp_f32 v80, v80
  v_exp_f32 v81, v81
  v_exp_f32 v82, v82
  v_exp_f32 v83, v83
  v_exp_f32 v84, v84
  v_exp_f32 v85, v85
  v_exp_f32 v86, v86
  v_exp_f32 v87, v87
  v_exp_f32 v88, v88
  v_exp_f32 v89, v89
  v_exp_f32 v90, v90
  v_exp_f32 v91, v91
  v_exp_f32 v92, v92
  v_exp_f32 v93, v93
  v_exp_f32 v94, v94
  v_exp_f32 v95, v95
  v_cvt_pk_bf16_f32 v80, v80, v81
  v_cvt_pk_bf16_f32 v81, v82, v83
  v_cvt_pk_bf16_f32 v82, v84, v85
  v_cvt_pk_bf16_f32 v83, v86, v87
  v_cvt_pk_bf16_f32 v84, v88, v89
  v_cvt_pk_bf16_f32 v85, v90, v91
  v_cvt_pk_bf16_f32 v86, v92, v93
  v_cvt_pk_bf16_f32 v87, v94, v95
  ds_read_b64_tr_b16 v[40:41], v7 offset:4096
  ds_read_b64_tr_b16 v[42:43], v13 offset:4096
  ds_read_b64_tr_b16 v[44:45], v7 offset:5120
  ds_read_b64_tr_b16 v[46:47], v13 offset:5120
  v_fma_f32 v96, v96, s58, -v30
  v_fma_f32 v97, v97, s58, -v30
  v_fma_f32 v98, v98, s58, -v30
  v_fma_f32 v99, v99, s58, -v30
  v_fma_f32 v100, v100, s58, -v30
  v_fma_f32 v101, v101, s58, -v30
  s_waitcnt lgkmcnt(4)
  v_mfma_f32_32x32x16_bf16 v[208:223], v[32:35], v[80:83], v[208:223]
  v_fma_f32 v102, v102, s58, -v30
  v_fma_f32 v103, v103, s58, -v30
  v_fma_f32 v104, v104, s58, -v30
  v_fma_f32 v105, v105, s58, -v30
  v_fma_f32 v106, v106, s58, -v30
  v_fma_f32 v107, v107, s58, -v30
  v_fma_f32 v108, v108, s58, -v30
  v_fma_f32 v109, v109, s58, -v30
  v_fma_f32 v110, v110, s58, -v30
  v_fma_f32 v111, v111, s58, -v30
  v_exp_f32 v96, v96
  v_exp_f32 v97, v97
  v_exp_f32 v98, v98
  v_exp_f32 v99, v99
  v_mfma_f32_32x32x16_bf16 v[208:223], v[36:39], v[84:87], v[208:223]
  v_exp_f32 v100, v100
  v_exp_f32 v101, v101
  v_exp_f32 v102, v102
  v_exp_f32 v103, v103
  v_exp_f32 v104, v104
  v_exp_f32 v105, v105
  v_exp_f32 v106, v106
  v_exp_f32 v107, v107
  v_exp_f32 v108, v108
  v_exp_f32 v109, v109
  v_exp_f32 v110, v110
  v_exp_f32 v111, v111
  v_cvt_pk_bf16_f32 v96, v96, v97
  v_cvt_pk_bf16_f32 v97, v98, v99
  v_cvt_pk_bf16_f32 v98, v100, v101
  v_cvt_pk_bf16_f32 v99, v102, v103
  v_cvt_pk_bf16_f32 v100, v104, v105
  v_cvt_pk_bf16_f32 v101, v106, v107
  v_cvt_pk_bf16_f32 v102, v108, v109
  v_cvt_pk_bf16_f32 v103, v110, v111
  ds_read_b64_tr_b16 v[32:33], v7 offset:6144
  ds_read_b64_tr_b16 v[34:35], v13 offset:6144
  ds_read_b64_tr_b16 v[36:37], v7 offset:7168
  ds_read_b64_tr_b16 v[38:39], v13 offset:7168
  v_fma_f32 v112, v112, s58, -v30
  v_fma_f32 v113, v113, s58, -v30
  v_fma_f32 v114, v114, s58, -v30
  v_fma_f32 v115, v115, s58, -v30
  v_fma_f32 v116, v116, s58, -v30
  v_fma_f32 v117, v117, s58, -v30
  s_waitcnt lgkmcnt(4)
  v_mfma_f32_32x32x16_bf16 v[208:223], v[40:43], v[96:99], v[208:223]
  v_fma_f32 v118, v118, s58, -v30
  v_fma_f32 v119, v119, s58, -v30
  v_fma_f32 v120, v120, s58, -v30
  v_fma_f32 v121, v121, s58, -v30
  v_fma_f32 v122, v122, s58, -v30
  v_fma_f32 v123, v123, s58, -v30
  v_fma_f32 v124, v124, s58, -v30
  v_fma_f32 v125, v125, s58, -v30
  v_fma_f32 v126, v126, s58, -v30
  v_fma_f32 v127, v127, s58, -v30
  v_exp_f32 v112, v112
  v_exp_f32 v113, v113
  v_exp_f32 v114, v114
  v_exp_f32 v115, v115
  v_mfma_f32_32x32x16_bf16 v[208:223], v[44:47], v[100:103], v[208:223]
  v_exp_f32 v116, v116
  v_exp_f32 v117, v117
  v_exp_f32 v118, v118
  v_exp_f32 v119, v119
  v_exp_f32 v120, v120
  v_exp_f32 v121, v121
  v_exp_f32 v122, v122
  v_exp_f32 v123, v123
  v_exp_f32 v124, v124
  v_exp_f32 v125, v125
  v_exp_f32 v126, v126
  v_exp_f32 v127, v127
  v_cvt_pk_bf16_f32 v112, v112, v113
  v_cvt_pk_bf16_f32 v113, v114, v115
  v_cvt_pk_bf16_f32 v114, v116, v117
  v_cvt_pk_bf16_f32 v115, v118, v119
  v_cvt_pk_bf16_f32 v116, v120, v121
  v_cvt_pk_bf16_f32 v117, v122, v123
  v_cvt_pk_bf16_f32 v118, v124, v125
  v_cvt_pk_bf16_f32 v119, v126, v127
  ds_read_b64_tr_b16 v[40:41], v7 offset:8192
  ds_read_b64_tr_b16 v[42:43], v13 offset:8192
  ds_read_b64_tr_b16 v[44:45], v7 offset:9216
  ds_read_b64_tr_b16 v[46:47], v13 offset:9216
  v_fma_f32 v128, v128, s58, -v30
  v_fma_f32 v129, v129, s58, -v30
  v_fma_f32 v130, v130, s58, -v30
  v_fma_f32 v131, v131, s58, -v30
  v_fma_f32 v132, v132, s58, -v30
  v_fma_f32 v133, v133, s58, -v30
  s_waitcnt lgkmcnt(4)
  v_mfma_f32_32x32x16_bf16 v[208:223], v[32:35], v[112:115], v[208:223]
  v_fma_f32 v134, v134, s58, -v30
  v_fma_f32 v135, v135, s58, -v30
  v_fma_f32 v136, v136, s58, -v30
  v_fma_f32 v137, v137, s58, -v30
  v_fma_f32 v138, v138, s58, -v30
  v_fma_f32 v139, v139, s58, -v30
  v_fma_f32 v140, v140, s58, -v30
  v_fma_f32 v141, v141, s58, -v30
  v_fma_f32 v142, v142, s58, -v30
  v_fma_f32 v143, v143, s58, -v30
  v_exp_f32 v128, v128
  v_exp_f32 v129, v129
  v_exp_f32 v130, v130
  v_exp_f32 v131, v131
  v_mfma_f32_32x32x16_bf16 v[208:223], v[36:39], v[116:119], v[208:223]
  v_exp_f32 v132, v132
  v_exp_f32 v133, v133
  v_exp_f32 v134, v134
  v_exp_f32 v135, v135
  v_exp_f32 v136, v136
  v_exp_f32 v137, v137
  v_exp_f32 v138, v138
  v_exp_f32 v139, v139
  v_exp_f32 v140, v140
  v_exp_f32 v141, v141
  v_exp_f32 v142, v142
  v_exp_f32 v143, v143
  v_cvt_pk_bf16_f32 v128, v128, v129
  v_cvt_pk_bf16_f32 v129, v130, v131
  v_cvt_pk_bf16_f32 v130, v132, v133
  v_cvt_pk_bf16_f32 v131, v134, v135
  v_cvt_pk_bf16_f32 v132, v136, v137
  v_cvt_pk_bf16_f32 v133, v138, v139
  v_cvt_pk_bf16_f32 v134, v140, v141
  v_cvt_pk_bf16_f32 v135, v142, v143
  ds_read_b64_tr_b16 v[32:33], v7 offset:10240
  ds_read_b64_tr_b16 v[34:35], v13 offset:10240
  ds_read_b64_tr_b16 v[36:37], v7 offset:11264
  ds_read_b64_tr_b16 v[38:39], v13 offset:11264
  v_fma_f32 v144, v144, s58, -v30
  v_fma_f32 v145, v145, s58, -v30
  v_fma_f32 v146, v146, s58, -v30
  v_fma_f32 v147, v147, s58, -v30
  v_fma_f32 v148, v148, s58, -v30
  v_fma_f32 v149, v149, s58, -v30
  s_waitcnt lgkmcnt(4)
  v_mfma_f32_32x32x16_bf16 v[208:223], v[40:43], v[128:131], v[208:223]
  v_fma_f32 v150, v150, s58, -v30
  v_fma_f32 v151, v151, s58, -v30
  v_fma_f32 v152, v152, s58, -v30
  v_fma_f32 v153, v153, s58, -v30
  v_fma_f32 v154, v154, s58, -v30
  v_fma_f32 v155, v155, s58, -v30
  v_fma_f32 v156, v156, s58, -v30
  v_fma_f32 v157, v157, s58, -v30
  v_fma_f32 v158, v158, s58, -v30
  v_fma_f32 v159, v159, s58, -v30
  v_exp_f32 v144, v144
  v_exp_f32 v145, v145
  v_exp_f32 v146, v146
  v_exp_f32 v147, v147
  v_mfma_f32_32x32x16_bf16 v[208:223], v[44:47], v[132:135], v[208:223]
  v_exp_f32 v148, v148
  v_exp_f32 v149, v149
  v_exp_f32 v150, v150
  v_exp_f32 v151, v151
  v_exp_f32 v152, v152
  v_exp_f32 v153, v153
  v_exp_f32 v154, v154
  v_exp_f32 v155, v155
  v_exp_f32 v156, v156
  v_exp_f32 v157, v157
  v_exp_f32 v158, v158
  v_exp_f32 v159, v159
  v_cvt_pk_bf16_f32 v144, v144, v145
  v_cvt_pk_bf16_f32 v145, v146, v147
  v_cvt_pk_bf16_f32 v146, v148, v149
  v_cvt_pk_bf16_f32 v147, v150, v151
  v_cvt_pk_bf16_f32 v148, v152, v153
  v_cvt_pk_bf16_f32 v149, v154, v155
  v_cvt_pk_bf16_f32 v150, v156, v157
  v_cvt_pk_bf16_f32 v151, v158, v159
  ds_read_b64_tr_b16 v[40:41], v7 offset:12288
  ds_read_b64_tr_b16 v[42:43], v13 offset:12288
  ds_read_b64_tr_b16 v[44:45], v7 offset:13312
  ds_read_b64_tr_b16 v[46:47], v13 offset:13312
  v_fma_f32 v160, v160, s58, -v30
  v_fma_f32 v161, v161, s58, -v30
  v_fma_f32 v162, v162, s58, -v30
  v_fma_f32 v163, v163, s58, -v30
  v_fma_f32 v164, v164, s58, -v30
  v_fma_f32 v165, v165, s58, -v30
  s_waitcnt lgkmcnt(4)
  v_mfma_f32_32x32x16_bf16 v[208:223], v[32:35], v[144:147], v[208:223]
  v_fma_f32 v166, v166, s58, -v30
  v_fma_f32 v167, v167, s58, -v30
  v_fma_f32 v168, v168, s58, -v30
  v_fma_f32 v169, v169, s58, -v30
  v_fma_f32 v170, v170, s58, -v30
  v_fma_f32 v171, v171, s58, -v30
  v_fma_f32 v172, v172, s58, -v30
  v_fma_f32 v173, v173, s58, -v30
  v_fma_f32 v174, v174, s58, -v30
  v_fma_f32 v175, v175, s58, -v30
  v_exp_f32 v160, v160
  v_exp_f32 v161, v161
  v_exp_f32 v162, v162
  v_exp_f32 v163, v163
  v_mfma_f32_32x32x16_bf16 v[208:223], v[36:39], v[148:151], v[208:223]
  v_exp_f32 v164, v164
  v_exp_f32 v165, v165
  v_exp_f32 v166, v166
  v_exp_f32 v167, v167
  v_exp_f32 v168, v168
  v_exp_f32 v169, v169
  v_exp_f32 v170, v170
  v_exp_f32 v171, v171
  v_exp_f32 v172, v172
  v_exp_f32 v173, v173
  v_exp_f32 v174, v174
  v_exp_f32 v175, v175
  v_cvt_pk_bf16_f32 v160, v160, v161
  v_cvt_pk_bf16_f32 v161, v162, v163
  v_cvt_pk_bf16_f32 v162, v164, v165
  v_cvt_pk_bf16_f32 v163, v166, v167
  v_cvt_pk_bf16_f32 v164, v168, v169
  v_cvt_pk_bf16_f32 v165, v170, v171
  v_cvt_pk_bf16_f32 v166, v172, v173
  v_cvt_pk_bf16_f32 v167, v174, v175
  ds_read_b64_tr_b16 v[32:33], v7 offset:14336
  ds_read_b64_tr_b16 v[34:35], v13 offset:14336
  ds_read_b64_tr_b16 v[36:37], v7 offset:15360
  ds_read_b64_tr_b16 v[38:39], v13 offset:15360
  v_fma_f32 v176, v176, s58, -v30
  v_fma_f32 v177, v177, s58, -v30
  v_fma_f32 v178, v178, s58, -v30
  v_fma_f32 v179, v179, s58, -v30
  v_fma_f32 v180, v180, s58, -v30
  v_fma_f32 v181, v181, s58, -v30
  s_waitcnt lgkmcnt(4)
  v_mfma_f32_32x32x16_bf16 v[208:223], v[40:43], v[160:163], v[208:223]
  v_fma_f32 v182, v182, s58, -v30
  v_fma_f32 v183, v183, s58, -v30
  v_fma_f32 v184, v184, s58, -v30
  v_fma_f32 v185, v185, s58, -v30
  v_fma_f32 v186, v186, s58, -v30
  v_fma_f32 v187, v187, s58, -v30
  v_fma_f32 v188, v188, s58, -v30
  v_fma_f32 v189, v189, s58, -v30
  v_fma_f32 v190, v190, s58, -v30
  v_fma_f32 v191, v191, s58, -v30
  v_exp_f32 v176, v176
  v_exp_f32 v177, v177
  v_exp_f32 v178, v178
  v_exp_f32 v179, v179
  v_mfma_f32_32x32x16_bf16 v[208:223], v[44:47], v[164:167], v[208:223]
  v_exp_f32 v180, v180
  v_exp_f32 v181, v181
  v_exp_f32 v182, v182
  v_exp_f32 v183, v183
  v_exp_f32 v184, v184
  v_exp_f32 v185, v185
  v_exp_f32 v186, v186
  v_exp_f32 v187, v187
  v_exp_f32 v188, v188
  v_exp_f32 v189, v189
  v_exp_f32 v190, v190
  v_exp_f32 v191, v191
  v_cvt_pk_bf16_f32 v176, v176, v177
  v_cvt_pk_bf16_f32 v177, v178, v179
  v_cvt_pk_bf16_f32 v178, v180, v181
  v_cvt_pk_bf16_f32 v179, v182, v183
  v_cvt_pk_bf16_f32 v180, v184, v185
  v_cvt_pk_bf16_f32 v181, v186, v187
  v_cvt_pk_bf16_f32 v182, v188, v189
  v_cvt_pk_bf16_f32 v183, v190, v191
  ds_read_b64_tr_b16 v[40:41], v7 offset:16384
  ds_read_b64_tr_b16 v[42:43], v13 offset:16384
  ds_read_b64_tr_b16 v[44:45], v7 offset:17408
  ds_read_b64_tr_b16 v[46:47], v13 offset:17408
  ds_read_b64_tr_b16 v[48:49], v7 offset:0
  ds_read_b64_tr_b16 v[50:51], v13 offset:0
  ds_read_b64_tr_b16 v[52:53], v7 offset:1024
  ds_read_b64_tr_b16 v[54:55], v13 offset:1024
  v_fma_f32 v64, v64, s58, -v30
  v_fma_f32 v65, v65, s58, -v30
  v_fma_f32 v66, v66, s58, -v30
  v_fma_f32 v67, v67, s58, -v30
  v_fma_f32 v68, v68, s58, -v30
  v_fma_f32 v69, v69, s58, -v30
  s_waitcnt lgkmcnt(8)
  v_mfma_f32_32x32x16_bf16 v[208:223], v[32:35], v[176:179], v[208:223]
  v_fma_f32 v70, v70, s58, -v30
  v_fma_f32 v71, v71, s58, -v30
  v_fma_f32 v72, v72, s58, -v30
  v_fma_f32 v73, v73, s58, -v30
  v_fma_f32 v74, v74, s58, -v30
  v_fma_f32 v75, v75, s58, -v30
  v_fma_f32 v76, v76, s58, -v30
  v_fma_f32 v77, v77, s58, -v30
  v_fma_f32 v78, v78, s58, -v30
  v_fma_f32 v79, v79, s58, -v30
  v_exp_f32 v64, v64
  v_exp_f32 v65, v65
  v_exp_f32 v66, v66
  v_exp_f32 v67, v67
  v_mfma_f32_32x32x16_bf16 v[208:223], v[36:39], v[180:183], v[208:223]
  v_exp_f32 v68, v68
  v_exp_f32 v69, v69
  v_exp_f32 v70, v70
  v_exp_f32 v71, v71
  v_exp_f32 v72, v72
  v_exp_f32 v73, v73
  v_exp_f32 v74, v74
  v_exp_f32 v75, v75
  v_exp_f32 v76, v76
  v_exp_f32 v77, v77
  v_exp_f32 v78, v78
  v_exp_f32 v79, v79
  v_cvt_pk_bf16_f32 v64, v64, v65
  v_cvt_pk_bf16_f32 v65, v66, v67
  v_cvt_pk_bf16_f32 v66, v68, v69
  v_cvt_pk_bf16_f32 v67, v70, v71
  v_cvt_pk_bf16_f32 v68, v72, v73
  v_cvt_pk_bf16_f32 v69, v74, v75
  v_cvt_pk_bf16_f32 v70, v76, v77
  v_cvt_pk_bf16_f32 v71, v78, v79
  v_and_b32 v72, v64, v230
  v_and_b32 v73, v65, v231
  v_and_b32 v74, v66, v232
  v_and_b32 v75, v67, v233
  v_and_b32 v76, v68, v234
  v_and_b32 v77, v69, v235
  v_and_b32 v78, v70, v236
  v_and_b32 v79, v71, v237
  v_xor_b32 v64, v64, v72
  v_xor_b32 v65, v65, v73
  v_xor_b32 v66, v66, v74
  v_xor_b32 v67, v67, v75
  v_xor_b32 v68, v68, v76
  v_xor_b32 v69, v69, v77
  v_xor_b32 v70, v70, v78
  v_xor_b32 v71, v71, v79
  s_waitcnt lgkmcnt(0)
  s_nop 0
  v_mfma_f32_32x32x16_bf16 v[208:223], v[40:43], v[72:75], v[208:223]
  v_mfma_f32_32x32x16_bf16 v[208:223], v[44:47], v[76:79], v[208:223]
  v_mfma_f32_32x32x16_bf16 v[208:223], v[48:51], v[64:67], v[208:223]
  v_mfma_f32_32x32x16_bf16 v[208:223], v[52:55], v[68:71], v[208:223]
  s_nop 15
  s_branch L_p_attdone_17
L_p_fasth_18:
  s_setprio 1
  v_mov_b32 v31, 0xf149f2ca
  v_mov_b32 v208, 0
  v_mov_b32 v209, 0
  v_mov_b32 v210, 0
  v_mov_b32 v211, 0
  v_mov_b32 v212, 0
  v_mov_b32 v213, 0
  v_mov_b32 v214, 0
  v_mov_b32 v215, 0
  v_mov_b32 v216, 0
  v_mov_b32 v217, 0
  v_mov_b32 v218, 0
  v_mov_b32 v219, 0
  v_mov_b32 v220, 0
  v_mov_b32 v221, 0
  v_mov_b32 v222, 0
  v_mov_b32 v223, 0
  ds_read_b128 v[16:19], v14 offset:8192
  ds_read_b64 v[20:21], v15 offset:4096
  ds_read_b128 v[22:25], v14 offset:0
  ds_read_b64 v[26:27], v15 offset:0
  s_waitcnt lgkmcnt(2)
  v_mfma_f32_32x32x16_bf16 v[192:207], v[16:19], v[224:227], 0
  v_mfma_f32_32x32x8_bf16 v[192:207], v[20:21], v[228:229], v[192:207]
  ds_read_b128 v[16:19], v14 offset:1024
  ds_read_b64 v[20:21], v15 offset:512
  s_waitcnt lgkmcnt(2)
  v_mfma_f32_32x32x16_bf16 v[64:79], v[22:25], v[224:227], 0
  v_mfma_f32_32x32x8_bf16 v[64:79], v[26:27], v[228:229], v[64:79]
  ds_read_b128 v[22:25], v14 offset:2048
  ds_read_b64 v[26:27], v15 offset:1024
  s_waitcnt lgkmcnt(2)
  v_mfma_f32_32x32x16_bf16 v[80:95], v[16:19], v[224:227], 0
  v_mfma_f32_32x32x8_bf16 v[80:95], v[20:21], v[228:229], v[80:95]
  ds_read_b128 v[16:19], v14 offset:3072
  ds_read_b64 v[20:21], v15 offset:1536
  s_waitcnt lgkmcnt(2)
  v_mfma_f32_32x32x16_bf16 v[96:111], v[22:25], v[224:227], 0
  v_mfma_f32_32x32x8_bf16 v[96:111], v[26:27], v[228:229], v[96:111]
  ds_read_b128 v[22:25], v14 offset:4096
  ds_read_b64 v[26:27], v15 offset:2048
  s_waitcnt lgkmcnt(2)
  v_mfma_f32_32x32x16_bf16 v[112:127], v[16:19], v[224:227], 0
  v_cndmask_b32 v64, v64, v192, s[64:65]
  v_cndmask_b32 v65, v65, v193, s[66:67]
  v_cndmask_b32 v66, v66, v194, s[68:69]
  v_cndmask_b32 v67, v67, v195, s[70:71]
  v_cndmask_b32 v68, v68, v196, s[72:73]
  v_cndmask_b32 v69, v69, v197, s[74:75]
  v_cndmask_b32 v70, v70, v198, s[76:77]
  v_cndmask_b32 v71, v71, v199, s[78:79]
  v_mfma_f32_32x32x8_bf16 v[112:127], v[20:21], v[228:229], v[112:127]
  v_cndmask_b32 v72, v72, v200, s[80:81]
  v_cndmask_b32 v73, v73, v201, s[82:83]
  v_cndmask_b32 v74, v74, v202, s[84:85]
  v_cndmask_b32 v75, v75, v203, s[86:87]
  v_cndmask_b32 v76, v76, v204, s[88:89]
  v_cndmask_b32 v77, v77, v205, s[90:91]
  v_cndmask_b32 v78, v78, v206, s[92:93]
  v_cndmask_b32 v79, v79, v207, s[94:95]
  ds_read_b128 v[16:19], v14 offset:5120
  ds_read_b64 v[20:21], v15 offset:2560
  s_waitcnt lgkmcnt(2)
  v_mfma_f32_32x32x16_bf16 v[128:143], v[22:25], v[224:227], 0
  v_max3_f32 v28, v64, v65, v66
  v_max3_f32 v29, v67, v68, v69
  v_max3_f32 v28, v28, v70, v71
  v_max3_f32 v29, v29, v72, v73
  v_max3_f32 v28, v28, v74, v75
  v_max3_f32 v29, v29, v76, v77
  v_max3_f32 v28, v28, v78, v79
  v_max3_f32 v28, v28, v80, v81
  v_mfma_f32_32x32x8_bf16 v[128:143], v[26:27], v[228:229], v[128:143]
  v_max3_f32 v29, v29, v82, v83
  v_max3_f32 v28, v28, v84, v85
  v_max3_f32 v29, v29, v86, v87
  v_max3_f32 v28, v28, v88, v89
  v_max3_f32 v29, v29, v90, v91
  v_max3_f32 v28, v28, v92, v93
  v_max3_f32 v29, v29, v94, v95
  ds_read_b128 v[22:25], v14 offset:6144
  ds_read_b64 v[26:27], v15 offset:3072
  s_waitcnt lgkmcnt(2)
  v_mfma_f32_32x32x16_bf16 v[144:159], v[16:19], v[224:227], 0
  v_max3_f32 v28, v28, v96, v97
  v_max3_f32 v29, v29, v98, v99
  v_max3_f32 v28, v28, v100, v101
  v_max3_f32 v29, v29, v102, v103
  v_mfma_f32_32x32x8_bf16 v[144:159], v[20:21], v[228:229], v[144:159]
  v_max3_f32 v28, v28, v104, v105
  v_max3_f32 v29, v29, v106, v107
  v_max3_f32 v28, v28, v108, v109
  v_max3_f32 v29, v29, v110, v111
  ds_read_b128 v[16:19], v14 offset:7168
  ds_read_b64 v[20:21], v15 offset:3584
  s_waitcnt lgkmcnt(2)
  v_mfma_f32_32x32x16_bf16 v[160:175], v[22:25], v[224:227], 0
  v_max3_f32 v28, v28, v112, v113
  v_max3_f32 v29, v29, v114, v115
  v_max3_f32 v28, v28, v116, v117
  v_max3_f32 v29, v29, v118, v119
  v_mfma_f32_32x32x8_bf16 v[160:175], v[26:27], v[228:229], v[160:175]
  v_max3_f32 v28, v28, v120, v121
  v_max3_f32 v29, v29, v122, v123
  v_max3_f32 v28, v28, v124, v125
  v_max3_f32 v29, v29, v126, v127
  s_waitcnt lgkmcnt(0)
  v_mfma_f32_32x32x16_bf16 v[176:191], v[16:19], v[224:227], 0
  v_max3_f32 v28, v28, v128, v129
  v_max3_f32 v29, v29, v130, v131
  v_max3_f32 v28, v28, v132, v133
  v_max3_f32 v29, v29, v134, v135
  v_mfma_f32_32x32x8_bf16 v[176:191], v[20:21], v[228:229], v[176:191]
  v_max3_f32 v28, v28, v136, v137
  v_max3_f32 v29, v29, v138, v139
  v_max3_f32 v28, v28, v140, v141
  v_max3_f32 v29, v29, v142, v143
  v_max3_f32 v28, v28, v144, v145
  v_max3_f32 v29, v29, v146, v147
  v_max3_f32 v28, v28, v148, v149
  v_max3_f32 v29, v29, v150, v151
  v_max3_f32 v28, v28, v152, v153
  v_max3_f32 v29, v29, v154, v155
  v_max3_f32 v28, v28, v156, v157
  v_max3_f32 v29, v29, v158, v159
  s_nop 7
  v_max3_f32 v28, v28, v160, v161
  v_max3_f32 v29, v29, v162, v163
  v_max3_f32 v28, v28, v164, v165
  v_max3_f32 v29, v29, v166, v167
  v_max3_f32 v28, v28, v168, v169
  v_max3_f32 v29, v29, v170, v171
  v_max3_f32 v28, v28, v172, v173
  v_max3_f32 v29, v29, v174, v175
  s_nop 3
  v_max3_f32 v28, v28, v176, v177
  v_max3_f32 v29, v29, v178, v179
  v_max3_f32 v28, v28, v180, v181
  v_max3_f32 v29, v29, v182, v183
  v_max3_f32 v28, v28, v184, v185
  v_max3_f32 v29, v29, v186, v187
  v_max3_f32 v28, v28, v188, v189
  v_max3_f32 v29, v29, v190, v191
  v_max_f32 v28, v28, v29
  v_mov_b32 v29, v28
  s_nop 1
  v_permlane32_swap_b32 v28, v29
  s_nop 1
  v_max_f32 v28, v28, v29
  v_mul_f32 v30, s58, v28
  ds_read_b64_tr_b16 v[32:33], v7 offset:2048
  ds_read_b64_tr_b16 v[34:35], v13 offset:2048
  ds_read_b64_tr_b16 v[36:37], v7 offset:3072
  ds_read_b64_tr_b16 v[38:39], v13 offset:3072
  v_fma_f32 v80, v80, s58, -v30
  v_fma_f32 v81, v81, s58, -v30
  v_fma_f32 v82, v82, s58, -v30
  s_add_u32 s12, s4, 0x8cc000
  v_fma_f32 v83, v83, s58, -v30
  v_fma_f32 v84, v84, s58, -v30
  v_fma_f32 v85, v85, s58, -v30
  s_addc_u32 s13, s5, 0
  v_fma_f32 v86, v86, s58, -v30
  v_fma_f32 v87, v87, s58, -v30
  v_fma_f32 v88, v88, s58, -v30
  s_and_b32 s13, s13, 0xffff
  v_fma_f32 v89, v89, s58, -v30
  v_fma_f32 v90, v90, s58, -v30
  v_fma_f32 v91, v91, s58, -v30
  s_mov_b32 s14, 0xc8000
  v_fma_f32 v92, v92, s58, -v30
  v_fma_f32 v93, v93, s58, -v30
  v_fma_f32 v94, v94, s58, -v30
  s_mov_b32 s15, 0x20000
  v_fma_f32 v95, v95, s58, -v30
  v_exp_f32 v80, v80
  v_exp_f32 v81, v81
  s_mov_b32 s24, s6
  v_exp_f32 v82, v82
  v_exp_f32 v83, v83
  v_exp_f32 v84, v84
  s_mov_b32 s25, s7
  v_exp_f32 v85, v85
  v_exp_f32 v86, v86
  v_exp_f32 v87, v87
  s_and_b32 s25, s25, 0xffff
  v_exp_f32 v88, v88
  v_exp_f32 v89, v89
  v_exp_f32 v90, v90
  s_mov_b32 s26, 0x280000
  v_exp_f32 v91, v91
  v_exp_f32 v92, v92
  v_exp_f32 v93, v93
  s_mov_b32 s27, 0x20000
  v_exp_f32 v94, v94
  v_exp_f32 v95, v95
  s_lshl_b32 s63, s37, 6
  s_mul_i32 s63, s63, 1280
  s_mul_i32 s59, s38, 160
  s_add_u32 s63, s63, s59
  s_mul_i32 s34, s38, 100*1024
  s_mul_i32 s62, s29, 5120
  s_mov_b32 s28, s34
  v_cvt_pk_bf16_f32 v80, v80, v81
  v_cvt_pk_bf16_f32 v81, v82, v83
  v_cvt_pk_bf16_f32 v82, v84, v85
  v_cvt_pk_bf16_f32 v83, v86, v87
  v_cvt_pk_bf16_f32 v84, v88, v89
  v_cvt_pk_bf16_f32 v85, v90, v91
  v_cvt_pk_bf16_f32 v86, v92, v93
  v_cvt_pk_bf16_f32 v87, v94, v95
  ds_read_b64_tr_b16 v[40:41], v7 offset:4096
  ds_read_b64_tr_b16 v[42:43], v13 offset:4096
  ds_read_b64_tr_b16 v[44:45], v7 offset:5120
  ds_read_b64_tr_b16 v[46:47], v13 offset:5120
  v_fma_f32 v96, v96, s58, -v30
  v_fma_f32 v97, v97, s58, -v30
  v_fma_f32 v98, v98, s58, -v30
  s_mul_i32 s61, s29, 3
  s_add_u32 s61, s61, 0
  s_cmp_ge_u32 s61, 10
  s_cbranch_scc1 L_p_xt_19
  s_lshl_b32 s59, s61, 10
  s_add_u32 m0, s59, 147456
  s_nop 0
  buffer_load_dwordx4 v59, s[24:27], s63 offen lds
L_p_xt_19:
  v_fma_f32 v99, v99, s58, -v30
  v_fma_f32 v100, v100, s58, -v30
  v_fma_f32 v101, v101, s58, -v30
  s_mul_i32 s61, s29, 3
  s_add_u32 s61, s61, 1
  s_cmp_ge_u32 s61, 10
  s_cbranch_scc1 L_p_xt_20
  s_lshl_b32 s59, s61, 10
  s_add_u32 m0, s59, 147456
  s_nop 0
  buffer_load_dwordx4 v60, s[24:27], s63 offen lds
L_p_xt_20:
  s_waitcnt lgkmcnt(4)
  v_mfma_f32_32x32x16_bf16 v[208:223], v[32:35], v[80:83], v[208:223]
  v_fma_f32 v102, v102, s58, -v30
  v_fma_f32 v103, v103, s58, -v30
  v_fma_f32 v104, v104, s58, -v30
  s_mul_i32 s61, s29, 3
  s_add_u32 s61, s61, 2
  s_cmp_ge_u32 s61, 10
  s_cbranch_scc1 L_p_xt_21
  s_lshl_b32 s59, s61, 10
  s_add_u32 m0, s59, 147456
  s_nop 0
  buffer_load_dwordx4 v61, s[24:27], s63 offen lds
L_p_xt_21:
  v_fma_f32 v105, v105, s58, -v30
  v_fma_f32 v106, v106, s58, -v30
  v_fma_f32 v107, v107, s58, -v30
  v_fma_f32 v108, v108, s58, -v30
  v_fma_f32 v109, v109, s58, -v30
  v_fma_f32 v110, v110, s58, -v30
  v_fma_f32 v111, v111, s58, -v30
  v_exp_f32 v96, v96
  v_exp_f32 v97, v97
  v_exp_f32 v98, v98
  v_exp_f32 v99, v99
  v_mfma_f32_32x32x16_bf16 v[208:223], v[36:39], v[84:87], v[208:223]
  v_exp_f32 v100, v100
  v_exp_f32 v101, v101
  v_exp_f32 v102, v102
  v_exp_f32 v103, v103
  v_exp_f32 v104, v104
  v_exp_f32 v105, v105
  v_exp_f32 v106, v106
  v_exp_f32 v107, v107
  v_exp_f32 v108, v108
  v_exp_f32 v109, v109
  v_exp_f32 v110, v110
  v_exp_f32 v111, v111
  v_cvt_pk_bf16_f32 v96, v96, v97
  v_cvt_pk_bf16_f32 v97, v98, v99
  v_cvt_pk_bf16_f32 v98, v100, v101
  v_cvt_pk_bf16_f32 v99, v102, v103
  v_cvt_pk_bf16_f32 v100, v104, v105
  v_cvt_pk_bf16_f32 v101, v106, v107
  v_cvt_pk_bf16_f32 v102, v108, v109
  v_cvt_pk_bf16_f32 v103, v110, v111
  ds_read_b64_tr_b16 v[32:33], v7 offset:6144
  ds_read_b64_tr_b16 v[34:35], v13 offset:6144
  ds_read_b64_tr_b16 v[36:37], v7 offset:7168
  ds_read_b64_tr_b16 v[38:39], v13 offset:7168
  v_fma_f32 v112, v112, s58, -v30
  v_fma_f32 v113, v113, s58, -v30
  v_fma_f32 v114, v114, s58, -v30
  s_add_u32 m0, s62, 126976
  v_fma_f32 v115, v115, s58, -v30
  v_fma_f32 v116, v116, s58, -v30
  v_fma_f32 v117, v117, s58, -v30
  s_add_u32 s61, s28, s62
  s_waitcnt lgkmcnt(4)
  v_mfma_f32_32x32x16_bf16 v[208:223], v[40:43], v[96:99], v[208:223]
  v_fma_f32 v118, v118, s58, -v30
  v_fma_f32 v119, v119, s58, -v30
  v_fma_f32 v120, v120, s58, -v30
  s_add_u32 s28, s28, 20480
  v_fma_f32 v121, v121, s58, -v30
  v_fma_f32 v122, v122, s58, -v30
  v_fma_f32 v123, v123, s58, -v30
  buffer_load_dwordx4 v3, s[12:15], s61 offen offset:0  lds
  v_fma_f32 v124, v124, s58, -v30
  v_fma_f32 v125, v125, s58, -v30
  v_fma_f32 v126, v126, s58, -v30
  buffer_load_dwordx4 v3, s[12:15], s61 offen offset:1024  lds
  v_fma_f32 v127, v127, s58, -v30
  v_exp_f32 v112, v112
  v_exp_f32 v113, v113
  buffer_load_dwordx4 v3, s[12:15], s61 offen offset:2048  lds
  v_exp_f32 v114, v114
  v_exp_f32 v115, v115
  v_mfma_f32_32x32x16_bf16 v[208:223], v[44:47], v[100:103], v[208:223]
  v_exp_f32 v116, v116
  buffer_load_dwordx4 v3, s[12:15], s61 offen offset:3072  lds
  v_exp_f32 v117, v117
  v_exp_f32 v118, v118
  v_exp_f32 v119, v119
  v_exp_f32 v120, v120
  v_exp_f32 v121, v121
  v_exp_f32 v122, v122
  v_exp_f32 v123, v123
  v_exp_f32 v124, v124
  v_exp_f32 v125, v125
  v_exp_f32 v126, v126
  v_exp_f32 v127, v127
  v_cvt_pk_bf16_f32 v112, v112, v113
  v_cvt_pk_bf16_f32 v113, v114, v115
  v_cvt_pk_bf16_f32 v114, v116, v117
  v_cvt_pk_bf16_f32 v115, v118, v119
  v_cvt_pk_bf16_f32 v116, v120, v121
  v_cvt_pk_bf16_f32 v117, v122, v123
  v_cvt_pk_bf16_f32 v118, v124, v125
  v_cvt_pk_bf16_f32 v119, v126, v127
  ds_read_b64_tr_b16 v[40:41], v7 offset:8192
  ds_read_b64_tr_b16 v[42:43], v13 offset:8192
  ds_read_b64_tr_b16 v[44:45], v7 offset:9216
  ds_read_b64_tr_b16 v[46:47], v13 offset:9216
  v_fma_f32 v128, v128, s58, -v30
  v_fma_f32 v129, v129, s58, -v30
  v_fma_f32 v130, v130, s58, -v30
  s_add_u32 s61, s61, 4096
  v_fma_f32 v131, v131, s58, -v30
  v_fma_f32 v132, v132, s58, -v30
  v_fma_f32 v133, v133, s58, -v30
  s_add_u32 m0, m0, 4096
  s_waitcnt lgkmcnt(4)
  v_mfma_f32_32x32x16_bf16 v[208:223], v[32:35], v[112:115], v[208:223]
  v_fma_f32 v134, v134, s58, -v30
  v_fma_f32 v135, v135, s58, -v30
  v_fma_f32 v136, v136, s58, -v30
  s_nop 0
  v_fma_f32 v137, v137, s58, -v30
  v_fma_f32 v138, v138, s58, -v30
  v_fma_f32 v139, v139, s58, -v30
  buffer_load_dwordx4 v3, s[12:15], s61 offen offset:0  lds
  v_fma_f32 v140, v140, s58, -v30
  v_fma_f32 v141, v141, s58, -v30
  v_fma_f32 v142, v142, s58, -v30
  v_fma_f32 v143, v143, s58, -v30
  v_exp_f32 v128, v128
  v_exp_f32 v129, v129
  v_exp_f32 v130, v130
  v_exp_f32 v131, v131
  v_mfma_f32_32x32x16_bf16 v[208:223], v[36:39], v[116:119], v[208:223]
  v_exp_f32 v132, v132
  v_exp_f32 v133, v133
  v_exp_f32 v134, v134
  v_exp_f32 v135, v135
  v_exp_f32 v136, v136
  v_exp_f32 v137, v137
  v_exp_f32 v138, v138
  v_exp_f32 v139, v139
  v_exp_f32 v140, v140
  v_exp_f32 v141, v141
  v_exp_f32 v142, v142
  v_exp_f32 v143, v143
  v_cvt_pk_bf16_f32 v128, v128, v129
  v_cvt_pk_bf16_f32 v129, v130, v131
  v_cvt_pk_bf16_f32 v130, v132, v133
  v_cvt_pk_bf16_f32 v131, v134, v135
  v_cvt_pk_bf16_f32 v132, v136, v137
  v_cvt_pk_bf16_f32 v133, v138, v139
  v_cvt_pk_bf16_f32 v134, v140, v141
  v_cvt_pk_bf16_f32 v135, v142, v143
  ds_read_b64_tr_b16 v[32:33], v7 offset:10240
  ds_read_b64_tr_b16 v[34:35], v13 offset:10240
  ds_read_b64_tr_b16 v[36:37], v7 offset:11264
  ds_read_b64_tr_b16 v[38:39], v13 offset:11264
  v_fma_f32 v144, v144, s58, -v30
  v_fma_f32 v145, v145, s58, -v30
  v_fma_f32 v146, v146, s58, -v30
  s_add_u32 m0, s62, 86016
  v_fma_f32 v147, v147, s58, -v30
  v_fma_f32 v148, v148, s58, -v30
  v_fma_f32 v149, v149, s58, -v30
  s_add_u32 s61, s28, s62
  s_waitcnt lgkmcnt(4)
  v_mfma_f32_32x32x16_bf16 v[208:223], v[40:43], v[128:131], v[208:223]
  v_fma_f32 v150, v150, s58, -v30
  v_fma_f32 v151, v151, s58, -v30
  v_fma_f32 v152, v152, s58, -v30
  s_add_u32 s28, s28, 20480
  v_fma_f32 v153, v153, s58, -v30
  v_fma_f32 v154, v154, s58, -v30
  v_fma_f32 v155, v155, s58, -v30
  buffer_load_dwordx4 v3, s[12:15], s61 offen offset:0  lds
  v_fma_f32 v156, v156, s58, -v30
  v_fma_f32 v157, v157, s58, -v30
  v_fma_f32 v158, v158, s58, -v30
  buffer_load_dwordx4 v3, s[12:15], s61 offen offset:1024  lds
  v_fma_f32 v159, v159, s58, -v30
  v_exp_f32 v144, v144
  v_exp_f32 v145, v145
  buffer_load_dwordx4 v3, s[12:15], s61 offen offset:2048  lds
  v_exp_f32 v146, v146
  v_exp_f32 v147, v147
  v_mfma_f32_32x32x16_bf16 v[208:223], v[44:47], v[132:135], v[208:223]
  v_exp_f32 v148, v148
  buffer_load_dwordx4 v3, s[12:15], s61 offen offset:3072  lds
  v_exp_f32 v149, v149
  v_exp_f32 v150, v150
  v_exp_f32 v151, v151
  v_exp_f32 v152, v152
  v_exp_f32 v153, v153
  v_exp_f32 v154, v154
  v_exp_f32 v155, v155
  v_exp_f32 v156, v156
  v_exp_f32 v157, v157
  v_exp_f32 v158, v158
  v_exp_f32 v159, v159
  v_cvt_pk_bf16_f32 v144, v144, v145
  v_cvt_pk_bf16_f32 v145, v146, v147
  v_cvt_pk_bf16_f32 v146, v148, v149
  v_cvt_pk_bf16_f32 v147, v150, v151
  v_cvt_pk_bf16_f32 v148, v152, v153
  v_cvt_pk_bf16_f32 v149, v154, v155
  v_cvt_pk_bf16_f32 v150, v156, v157
  v_cvt_pk_bf16_f32 v151, v158, v159
  ds_read_b64_tr_b16 v[40:41], v7 offset:12288
  ds_read_b64_tr_b16 v[42:43], v13 offset:12288
  ds_read_b64_tr_b16 v[44:45], v7 offset:13312
  ds_read_b64_tr_b16 v[46:47], v13 offset:13312
  v_fma_f32 v160, v160, s58, -v30
  v_fma_f32 v161, v161, s58, -v30
  v_fma_f32 v162, v162, s58, -v30
  s_add_u32 s61, s61, 4096
  v_fma_f32 v163, v163, s58, -v30
  v_fma_f32 v164, v164, s58, -v30
  v_fma_f32 v165, v165, s58, -v30
  s_add_u32 m0, m0, 4096
  s_waitcnt lgkmcnt(4)
  v_mfma_f32_32x32x16_bf16 v[208:223], v[32:35], v[144:147], v[208:223]
  v_fma_f32 v166, v166, s58, -v30
  v_fma_f32 v167, v167, s58, -v30
  v_fma_f32 v168, v168, s58, -v30
  s_nop 0
  v_fma_f32 v169, v169, s58, -v30
  v_fma_f32 v170, v170, s58, -v30
  v_fma_f32 v171, v171, s58, -v30
  buffer_load_dwordx4 v3, s[12:15], s61 offen offset:0  lds
  v_fma_f32 v172, v172, s58, -v30
  v_fma_f32 v173, v173, s58, -v30
  v_fma_f32 v174, v174, s58, -v30
  v_fma_f32 v175, v175, s58, -v30
  v_exp_f32 v160, v160
  v_exp_f32 v161, v161
  v_exp_f32 v162, v162
  v_exp_f32 v163, v163
  v_mfma_f32_32x32x16_bf16 v[208:223], v[36:39], v[148:151], v[208:223]
  v_exp_f32 v164, v164
  v_exp_f32 v165, v165
  v_exp_f32 v166, v166
  v_exp_f32 v167, v167
  v_exp_f32 v168, v168
  v_exp_f32 v169, v169
  v_exp_f32 v170, v170
  v_exp_f32 v171, v171
  v_exp_f32 v172, v172
  v_exp_f32 v173, v173
  v_exp_f32 v174, v174
  v_exp_f32 v175, v175
  v_cvt_pk_bf16_f32 v160, v160, v161
  v_cvt_pk_bf16_f32 v161, v162, v163
  v_cvt_pk_bf16_f32 v162, v164, v165
  v_cvt_pk_bf16_f32 v163, v166, v167
  v_cvt_pk_bf16_f32 v164, v168, v169
  v_cvt_pk_bf16_f32 v165, v170, v171
  v_cvt_pk_bf16_f32 v166, v172, v173
  v_cvt_pk_bf16_f32 v167, v174, v175
  ds_read_b64_tr_b16 v[32:33], v7 offset:14336
  ds_read_b64_tr_b16 v[34:35], v13 offset:14336
  ds_read_b64_tr_b16 v[36:37], v7 offset:15360
  ds_read_b64_tr_b16 v[38:39], v13 offset:15360
  v_fma_f32 v176, v176, s58, -v30
  v_fma_f32 v177, v177, s58, -v30
  v_fma_f32 v178, v178, s58, -v30
  s_add_u32 m0, s62, 106496
  v_fma_f32 v179, v179, s58, -v30
  v_fma_f32 v180, v180, s58, -v30
  v_fma_f32 v181, v181, s58, -v30
  s_add_u32 s61, s28, s62
  s_waitcnt lgkmcnt(4)
  v_mfma_f32_32x32x16_bf16 v[208:223], v[40:43], v[160:163], v[208:223]
  v_fma_f32 v182, v182, s58, -v30
  v_fma_f32 v183, v183, s58, -v30
  v_fma_f32 v184, v184, s58, -v30
  s_add_u32 s28, s28, 20480
  v_fma_f32 v185, v185, s58, -v30
  v_fma_f32 v186, v186, s58, -v30
  v_fma_f32 v187, v187, s58, -v30
  buffer_load_dwordx4 v3, s[12:15], s61 offen offset:0  lds
  v_fma_f32 v188, v188, s58, -v30
  v_fma_f32 v189, v189, s58, -v30
  v_fma_f32 v190, v190, s58, -v30
  buffer_load_dwordx4 v3, s[12:15], s61 offen offset:1024  lds
  v_fma_f32 v191, v191, s58, -v30
  v_exp_f32 v176, v176
  v_exp_f32 v177, v177
  buffer_load_dwordx4 v3, s[12:15], s61 offen offset:2048  lds
  v_exp_f32 v178, v178
  v_exp_f32 v179, v179
  v_mfma_f32_32x32x16_bf16 v[208:223], v[44:47], v[164:167], v[208:223]
  v_exp_f32 v180, v180
  buffer_load_dwordx4 v3, s[12:15], s61 offen offset:3072  lds
  v_exp_f32 v181, v181
  v_exp_f32 v182, v182
  v_exp_f32 v183, v183
  v_exp_f32 v184, v184
  v_exp_f32 v185, v185
  v_exp_f32 v186, v186
  v_exp_f32 v187, v187
  v_exp_f32 v188, v188
  v_exp_f32 v189, v189
  v_exp_f32 v190, v190
  v_exp_f32 v191, v191
  v_cvt_pk_bf16_f32 v176, v176, v177
  v_cvt_pk_bf16_f32 v177, v178, v179
  v_cvt_pk_bf16_f32 v178, v180, v181
  v_cvt_pk_bf16_f32 v179, v182, v183
  v_cvt_pk_bf16_f32 v180, v184, v185
  v_cvt_pk_bf16_f32 v181, v186, v187
  v_cvt_pk_bf16_f32 v182, v188, v189
  v_cvt_pk_bf16_f32 v183, v190, v191
  ds_read_b64_tr_b16 v[40:41], v7 offset:16384
  ds_read_b64_tr_b16 v[42:43], v13 offset:16384
  ds_read_b64_tr_b16 v[44:45], v7 offset:17408
  ds_read_b64_tr_b16 v[46:47], v13 offset:17408
  ds_read_b64_tr_b16 v[48:49], v7 offset:0
  ds_read_b64_tr_b16 v[50:51], v13 offset:0
  ds_read_b64_tr_b16 v[52:53], v7 offset:1024
  ds_read_b64_tr_b16 v[54:55], v13 offset:1024
  v_fma_f32 v64, v64, s58, -v30
  v_fma_f32 v65, v65, s58, -v30
  v_fma_f32 v66, v66, s58, -v30
  s_add_u32 s61, s61, 4096
  v_fma_f32 v67, v67, s58, -v30
  v_fma_f32 v68, v68, s58, -v30
  v_fma_f32 v69, v69, s58, -v30
  s_add_u32 m0, m0, 4096
  s_waitcnt lgkmcnt(8)
  v_mfma_f32_32x32x16_bf16 v[208:223], v[32:35], v[176:179], v[208:223]
  v_fma_f32 v70, v70, s58, -v30
  v_fma_f32 v71, v71, s58, -v30
  v_fma_f32 v72, v72, s58, -v30
  s_nop 0
  v_fma_f32 v73, v73, s58, -v30
  v_fma_f32 v74, v74, s58, -v30
  v_fma_f32 v75, v75, s58, -v30
  buffer_load_dwordx4 v3, s[12:15], s61 offen offset:0  lds
  v_fma_f32 v76, v76, s58, -v30
  v_fma_f32 v77, v77, s58, -v30
  v_fma_f32 v78, v78, s58, -v30
  v_fma_f32 v79, v79, s58, -v30
  v_exp_f32 v64, v64
  v_exp_f32 v65, v65
  v_exp_f32 v66, v66
  v_exp_f32 v67, v67
  v_mfma_f32_32x32x16_bf16 v[208:223], v[36:39], v[180:183], v[208:223]
  v_exp_f32 v68, v68
  v_exp_f32 v69, v69
  v_exp_f32 v70, v70
  v_exp_f32 v71, v71
  v_exp_f32 v72, v72
  v_exp_f32 v73, v73
  v_exp_f32 v74, v74
  v_exp_f32 v75, v75
  v_exp_f32 v76, v76
  v_exp_f32 v77, v77
  v_exp_f32 v78, v78
  v_exp_f32 v79, v79
  v_cvt_pk_bf16_f32 v64, v64, v65
  v_cvt_pk_bf16_f32 v65, v66, v67
  v_cvt_pk_bf16_f32 v66, v68, v69
  v_cvt_pk_bf16_f32 v67, v70, v71
  v_cvt_pk_bf16_f32 v68, v72, v73
  v_cvt_pk_bf16_f32 v69, v74, v75
  v_cvt_pk_bf16_f32 v70, v76, v77
  v_cvt_pk_bf16_f32 v71, v78, v79
  v_and_b32 v72, v64, v230
  v_and_b32 v73, v65, v231
  v_and_b32 v74, v66, v232
  v_and_b32 v75, v67, v233
  v_and_b32 v76, v68, v234
  v_and_b32 v77, v69, v235
  v_and_b32 v78, v70, v236
  v_and_b32 v79, v71, v237
  v_xor_b32 v64, v64, v72
  v_xor_b32 v65, v65, v73
  v_xor_b32 v66, v66, v74
  v_xor_b32 v67, v67, v75
  v_xor_b32 v68, v68, v76
  v_xor_b32 v69, v69, v77
  v_xor_b32 v70, v70, v78
  v_xor_b32 v71, v71, v79
  s_waitcnt lgkmcnt(0)
  s_nop 0
  v_mfma_f32_32x32x16_bf16 v[208:223], v[40:43], v[72:75], v[208:223]
  v_mfma_f32_32x32x16_bf16 v[208:223], v[44:47], v[76:79], v[208:223]
  v_mfma_f32_32x32x16_bf16 v[208:223], v[48:51], v[64:67], v[208:223]
  v_mfma_f32_32x32x16_bf16 v[208:223], v[52:55], v[68:71], v[208:223]
  s_setprio 0
  s_nop 15
  s_branch L_p_attdone_17
L_p_slow_16:
  s_cmp_lt_u32 s3, 4
  s_cbranch_scc1 L_p_slowc_22
  s_add_u32 s12, s4, 0x8cc000
  s_addc_u32 s13, s5, 0
  s_and_b32 s13, s13, 0xffff
  s_mov_b32 s14, 0xc8000
  s_mov_b32 s15, 0x20000
  s_mov_b32 s24, s6
  s_mov_b32 s25, s7
  s_and_b32 s25, s25, 0xffff
  s_mov_b32 s26, 0x280000
  s_mov_b32 s27, 0x20000
  s_lshl_b32 s63, s37, 6
  s_mul_i32 s63, s63, 1280
  s_mul_i32 s59, s38, 160
  s_add_u32 s63, s63, s59
  s_mul_i32 s34, s38, 100*1024
  s_mul_i32 s62, s29, 5120
  s_mov_b32 s28, s34
  s_mul_i32 s61, s29, 3
  s_add_u32 s61, s61, 0
  s_cmp_ge_u32 s61, 10
  s_cbranch_scc1 L_p_xt_23
  s_lshl_b32 s59, s61, 10
  s_add_u32 m0, s59, 147456
  s_nop 0
  buffer_load_dwordx4 v59, s[24:27], s63 offen lds
L_p_xt_23:
  s_mul_i32 s61, s29, 3
  s_add_u32 s61, s61, 1
  s_cmp_ge_u32 s61, 10
  s_cbranch_scc1 L_p_xt_24
  s_lshl_b32 s59, s61, 10
  s_add_u32 m0, s59, 147456
  s_nop 0
  buffer_load_dwordx4 v60, s[24:27], s63 offen lds
L_p_xt_24:
  s_mul_i32 s61, s29, 3
  s_add_u32 s61, s61, 2
  s_cmp_ge_u32 s61, 10
  s_cbranch_scc1 L_p_xt_25
  s_lshl_b32 s59, s61, 10
  s_add_u32 m0, s59, 147456
  s_nop 0
  buffer_load_dwordx4 v61, s[24:27], s63 offen lds
L_p_xt_25:
  s_add_u32 m0, s62, 126976
  s_add_u32 s61, s28, s62
  s_add_u32 s28, s28, 20480
  buffer_load_dwordx4 v3, s[12:15], s61 offen offset:0  lds
  buffer_load_dwordx4 v3, s[12:15], s61 offen offset:1024  lds
  buffer_load_dwordx4 v3, s[12:15], s61 offen offset:2048  lds
  buffer_load_dwordx4 v3, s[12:15], s61 offen offset:3072  lds
  s_add_u32 s61, s61, 4096
  s_add_u32 m0, m0, 4096
  s_nop 0
  buffer_load_dwordx4 v3, s[12:15], s61 offen offset:0  lds
  s_add_u32 m0, s62, 86016
  s_add_u32 s61, s28, s62
  s_add_u32 s28, s28, 20480
  buffer_load_dwordx4 v3, s[12:15], s61 offen offset:0  lds
  buffer_load_dwordx4 v3, s[12:15], s61 offen offset:1024  lds
  buffer_load_dwordx4 v3, s[12:15], s61 offen offset:2048  lds
  buffer_load_dwordx4 v3, s[12:15], s61 offen offset:3072  lds
  s_add_u32 s61, s61, 4096
  s_add_u32 m0, m0, 4096
  s_nop 0
  buffer_load_dwordx4 v3, s[12:15], s61 offen offset:0  lds
  s_add_u32 m0, s62, 106496
  s_add_u32 s61, s28, s62
  s_add_u32 s28, s28, 20480
  buffer_load_dwordx4 v3, s[12:15], s61 offen offset:0  lds
  buffer_load_dwordx4 v3, s[12:15], s61 offen offset:1024  lds
  buffer_load_dwordx4 v3, s[12:15], s61 offen offset:2048  lds
  buffer_load_dwordx4 v3, s[12:15], s61 offen offset:3072  lds
  s_add_u32 s61, s61, 4096
  s_add_u32 m0, m0, 4096
  s_nop 0
  buffer_load_dwordx4 v3, s[12:15], s61 offen offset:0  lds
L_p_slowc_22:
  v_mov_b32 v208, 0
  v_mov_b32 v209, 0
  v_mov_b32 v210, 0
  v_mov_b32 v211, 0
  v_mov_b32 v212, 0
  v_mov_b32 v213, 0
  v_mov_b32 v214, 0
  v_mov_b32 v215, 0
  v_mov_b32 v216, 0
  v_mov_b32 v217, 0
  v_mov_b32 v218, 0
  v_mov_b32 v219, 0
  v_mov_b32 v220, 0
  v_mov_b32 v221, 0
  v_mov_b32 v222, 0
  v_mov_b32 v223, 0
  s_cmp_gt_u32 s49, 0
  s_cbranch_scc1 L_p_skipqk_26
  ds_read_b128 v[16:19], v14 offset:0
  ds_read_b64 v[20:21], v15 offset:0
  s_waitcnt lgkmcnt(0)
  v_mfma_f32_32x32x16_bf16 v[64:79], v[16:19], v[224:227], 0
  v_mfma_f32_32x32x8_bf16 v[64:79], v[20:21], v[228:229], v[64:79]
  s_branch L_p_doneqk_27
L_p_skipqk_26:
  v_mov_b32 v64, 0xf149f2ca
  v_mov_b32 v65, 0xf149f2ca
  v_mov_b32 v66, 0xf149f2ca
  v_mov_b32 v67, 0xf149f2ca
  v_mov_b32 v68, 0xf149f2ca
  v_mov_b32 v69, 0xf149f2ca
  v_mov_b32 v70, 0xf149f2ca
  v_mov_b32 v71, 0xf149f2ca
  v_mov_b32 v72, 0xf149f2ca
  v_mov_b32 v73, 0xf149f2ca
  v_mov_b32 v74, 0xf149f2ca
  v_mov_b32 v75, 0xf149f2ca
  v_mov_b32 v76, 0xf149f2ca
  v_mov_b32 v77, 0xf149f2ca
  v_mov_b32 v78, 0xf149f2ca
  v_mov_b32 v79, 0xf149f2ca
L_p_doneqk_27:
  s_cmp_gt_u32 s49, 1
  s_cbranch_scc1 L_p_skipqk_28
  ds_read_b128 v[22:25], v14 offset:1024
  ds_read_b64 v[26:27], v15 offset:512
  s_waitcnt lgkmcnt(0)
  v_mfma_f32_32x32x16_bf16 v[80:95], v[22:25], v[224:227], 0
  v_mfma_f32_32x32x8_bf16 v[80:95], v[26:27], v[228:229], v[80:95]
  s_branch L_p_doneqk_29
L_p_skipqk_28:
  v_mov_b32 v80, 0xf149f2ca
  v_mov_b32 v81, 0xf149f2ca
  v_mov_b32 v82, 0xf149f2ca
  v_mov_b32 v83, 0xf149f2ca
  v_mov_b32 v84, 0xf149f2ca
  v_mov_b32 v85, 0xf149f2ca
  v_mov_b32 v86, 0xf149f2ca
  v_mov_b32 v87, 0xf149f2ca
  v_mov_b32 v88, 0xf149f2ca
  v_mov_b32 v89, 0xf149f2ca
  v_mov_b32 v90, 0xf149f2ca
  v_mov_b32 v91, 0xf149f2ca
  v_mov_b32 v92, 0xf149f2ca
  v_mov_b32 v93, 0xf149f2ca
  v_mov_b32 v94, 0xf149f2ca
  v_mov_b32 v95, 0xf149f2ca
L_p_doneqk_29:
  s_cmp_gt_u32 s49, 2
  s_cbranch_scc1 L_p_skipqk_30
  ds_read_b128 v[16:19], v14 offset:2048
  ds_read_b64 v[20:21], v15 offset:1024
  s_waitcnt lgkmcnt(0)
  v_mfma_f32_32x32x16_bf16 v[96:111], v[16:19], v[224:227], 0
  v_mfma_f32_32x32x8_bf16 v[96:111], v[20:21], v[228:229], v[96:111]
  s_branch L_p_doneqk_31
L_p_skipqk_30:
  v_mov_b32 v96, 0xf149f2ca
  v_mov_b32 v97, 0xf149f2ca
  v_mov_b32 v98, 0xf149f2ca
  v_mov_b32 v99, 0xf149f2ca
  v_mov_b32 v100, 0xf149f2ca
  v_mov_b32 v101, 0xf149f2ca
  v_mov_b32 v102, 0xf149f2ca
  v_mov_b32 v103, 0xf149f2ca
  v_mov_b32 v104, 0xf149f2ca
  v_mov_b32 v105, 0xf149f2ca
  v_mov_b32 v106, 0xf149f2ca
  v_mov_b32 v107, 0xf149f2ca
  v_mov_b32 v108, 0xf149f2ca
  v_mov_b32 v109, 0xf149f2ca
  v_mov_b32 v110, 0xf149f2ca
  v_mov_b32 v111, 0xf149f2ca
L_p_doneqk_31:
  s_cmp_gt_u32 s49, 3
  s_cbranch_scc1 L_p_skipqk_32
  ds_read_b128 v[22:25], v14 offset:3072
  ds_read_b64 v[26:27], v15 offset:1536
  s_waitcnt lgkmcnt(0)
  v_mfma_f32_32x32x16_bf16 v[112:127], v[22:25], v[224:227], 0
  v_mfma_f32_32x32x8_bf16 v[112:127], v[26:27], v[228:229], v[112:127]
  s_branch L_p_doneqk_33
L_p_skipqk_32:
  v_mov_b32 v112, 0xf149f2ca
  v_mov_b32 v113, 0xf149f2ca
  v_mov_b32 v114, 0xf149f2ca
  v_mov_b32 v115, 0xf149f2ca
  v_mov_b32 v116, 0xf149f2ca
  v_mov_b32 v117, 0xf149f2ca
  v_mov_b32 v118, 0xf149f2ca
  v_mov_b32 v119, 0xf149f2ca
  v_mov_b32 v120, 0xf149f2ca
  v_mov_b32 v121, 0xf149f2ca
  v_mov_b32 v122, 0xf149f2ca
  v_mov_b32 v123, 0xf149f2ca
  v_mov_b32 v124, 0xf149f2ca
  v_mov_b32 v125, 0xf149f2ca
  v_mov_b32 v126, 0xf149f2ca
  v_mov_b32 v127, 0xf149f2ca
L_p_doneqk_33:
  s_cmp_gt_u32 s49, 4
  s_cbranch_scc1 L_p_skipqk_34
  ds_read_b128 v[16:19], v14 offset:4096
  ds_read_b64 v[20:21], v15 offset:2048
  s_waitcnt lgkmcnt(0)
  v_mfma_f32_32x32x16_bf16 v[128:143], v[16:19], v[224:227], 0
  v_mfma_f32_32x32x8_bf16 v[128:143], v[20:21], v[228:229], v[128:143]
  s_branch L_p_doneqk_35
L_p_skipqk_34:
  v_mov_b32 v128, 0xf149f2ca
  v_mov_b32 v129, 0xf149f2ca
  v_mov_b32 v130, 0xf149f2ca
  v_mov_b32 v131, 0xf149f2ca
  v_mov_b32 v132, 0xf149f2ca
  v_mov_b32 v133, 0xf149f2ca
  v_mov_b32 v134, 0xf149f2ca
  v_mov_b32 v135, 0xf149f2ca
  v_mov_b32 v136, 0xf149f2ca
  v_mov_b32 v137, 0xf149f2ca
  v_mov_b32 v138, 0xf149f2ca
  v_mov_b32 v139, 0xf149f2ca
  v_mov_b32 v140, 0xf149f2ca
  v_mov_b32 v141, 0xf149f2ca
  v_mov_b32 v142, 0xf149f2ca
  v_mov_b32 v143, 0xf149f2ca
L_p_doneqk_35:
  s_cmp_gt_u32 s49, 5
  s_cbranch_scc1 L_p_skipqk_36
  ds_read_b128 v[22:25], v14 offset:5120
  ds_read_b64 v[26:27], v15 offset:2560
  s_waitcnt lgkmcnt(0)
  v_mfma_f32_32x32x16_bf16 v[144:159], v[22:25], v[224:227], 0
  v_mfma_f32_32x32x8_bf16 v[144:159], v[26:27], v[228:229], v[144:159]
  s_branch L_p_doneqk_37
L_p_skipqk_36:
  v_mov_b32 v144, 0xf149f2ca
  v_mov_b32 v145, 0xf149f2ca
  v_mov_b32 v146, 0xf149f2ca
  v_mov_b32 v147, 0xf149f2ca
  v_mov_b32 v148, 0xf149f2ca
  v_mov_b32 v149, 0xf149f2ca
  v_mov_b32 v150, 0xf149f2ca
  v_mov_b32 v151, 0xf149f2ca
  v_mov_b32 v152, 0xf149f2ca
  v_mov_b32 v153, 0xf149f2ca
  v_mov_b32 v154, 0xf149f2ca
  v_mov_b32 v155, 0xf149f2ca
  v_mov_b32 v156, 0xf149f2ca
  v_mov_b32 v157, 0xf149f2ca
  v_mov_b32 v158, 0xf149f2ca
  v_mov_b32 v159, 0xf149f2ca
L_p_doneqk_37:
  s_cmp_gt_u32 s49, 6
  s_cbranch_scc1 L_p_skipqk_38
  ds_read_b128 v[16:19], v14 offset:6144
  ds_read_b64 v[20:21], v15 offset:3072
  s_waitcnt lgkmcnt(0)
  v_mfma_f32_32x32x16_bf16 v[160:175], v[16:19], v[224:227], 0
  v_mfma_f32_32x32x8_bf16 v[160:175], v[20:21], v[228:229], v[160:175]
  s_branch L_p_doneqk_39
L_p_skipqk_38:
  v_mov_b32 v160, 0xf149f2ca
  v_mov_b32 v161, 0xf149f2ca
  v_mov_b32 v162, 0xf149f2ca
  v_mov_b32 v163, 0xf149f2ca
  v_mov_b32 v164, 0xf149f2ca
  v_mov_b32 v165, 0xf149f2ca
  v_mov_b32 v166, 0xf149f2ca
  v_mov_b32 v167, 0xf149f2ca
  v_mov_b32 v168, 0xf149f2ca
  v_mov_b32 v169, 0xf149f2ca
  v_mov_b32 v170, 0xf149f2ca
  v_mov_b32 v171, 0xf149f2ca
  v_mov_b32 v172, 0xf149f2ca
  v_mov_b32 v173, 0xf149f2ca
  v_mov_b32 v174, 0xf149f2ca
  v_mov_b32 v175, 0xf149f2ca
L_p_doneqk_39:
  s_cmp_gt_u32 s49, 7
  s_cbranch_scc1 L_p_skipqk_40
  ds_read_b128 v[22:25], v14 offset:7168
  ds_read_b64 v[26:27], v15 offset:3584
  s_waitcnt lgkmcnt(0)
  v_mfma_f32_32x32x16_bf16 v[176:191], v[22:25], v[224:227], 0
  v_mfma_f32_32x32x8_bf16 v[176:191], v[26:27], v[228:229], v[176:191]
  s_branch L_p_doneqk_41
L_p_skipqk_40:
  v_mov_b32 v176, 0xf149f2ca
  v_mov_b32 v177, 0xf149f2ca
  v_mov_b32 v178, 0xf149f2ca
  v_mov_b32 v179, 0xf149f2ca
  v_mov_b32 v180, 0xf149f2ca
  v_mov_b32 v181, 0xf149f2ca
  v_mov_b32 v182, 0xf149f2ca
  v_mov_b32 v183, 0xf149f2ca
  v_mov_b32 v184, 0xf149f2ca
  v_mov_b32 v185, 0xf149f2ca
  v_mov_b32 v186, 0xf149f2ca
  v_mov_b32 v187, 0xf149f2ca
  v_mov_b32 v188, 0xf149f2ca
  v_mov_b32 v189, 0xf149f2ca
  v_mov_b32 v190, 0xf149f2ca
  v_mov_b32 v191, 0xf149f2ca
L_p_doneqk_41:
  ds_read_b128 v[16:19], v14 offset:8192
  ds_read_b64 v[20:21], v15 offset:4096
  s_waitcnt lgkmcnt(0)
  v_mfma_f32_32x32x16_bf16 v[192:207], v[16:19], v[224:227], 0
  v_mfma_f32_32x32x8_bf16 v[192:207], v[20:21], v[228:229], v[192:207]
  s_nop 15
  v_mov_b32 v16, 0xf149f2ca
  v_cndmask_b32 v192, v16, v192, s[64:65]
  v_cndmask_b32 v64, v64, v16, s[64:65]
  v_cndmask_b32 v193, v16, v193, s[66:67]
  v_cndmask_b32 v65, v65, v16, s[66:67]
  v_cndmask_b32 v194, v16, v194, s[68:69]
  v_cndmask_b32 v66, v66, v16, s[68:69]
  v_cndmask_b32 v195, v16, v195, s[70:71]
  v_cndmask_b32 v67, v67, v16, s[70:71]
  v_cndmask_b32 v196, v16, v196, s[72:73]
  v_cndmask_b32 v68, v68, v16, s[72:73]
  v_cndmask_b32 v197, v16, v197, s[74:75]
  v_cndmask_b32 v69, v69, v16, s[74:75]
  v_cndmask_b32 v198, v16, v198, s[76:77]
  v_cndmask_b32 v70, v70, v16, s[76:77]
  v_cndmask_b32 v199, v16, v199, s[78:79]
  v_cndmask_b32 v71, v71, v16, s[78:79]
  v_cndmask_b32 v200, v16, v200, s[80:81]
  v_cndmask_b32 v72, v72, v16, s[80:81]
  v_cndmask_b32 v201, v16, v201, s[82:83]
  v_cndmask_b32 v73, v73, v16, s[82:83]
  v_cndmask_b32 v202, v16, v202, s[84:85]
  v_cndmask_b32 v74, v74, v16, s[84:85]
  v_cndmask_b32 v203, v16, v203, s[86:87]
  v_cndmask_b32 v75, v75, v16, s[86:87]
  v_cndmask_b32 v204, v16, v204, s[88:89]
  v_cndmask_b32 v76, v76, v16, s[88:89]
  v_cndmask_b32 v205, v16, v205, s[90:91]
  v_cndmask_b32 v77, v77, v16, s[90:91]
  v_cndmask_b32 v206, v16, v206, s[92:93]
  v_cndmask_b32 v78, v78, v16, s[92:93]
  v_cndmask_b32 v207, v16, v207, s[94:95]
  v_cndmask_b32 v79, v79, v16, s[94:95]
  v_max3_f32 v17, v64, v65, v66
  v_max3_f32 v18, v67, v68, v69
  v_max3_f32 v17, v17, v70, v71
  v_max3_f32 v18, v18, v72, v73
  v_max3_f32 v17, v17, v74, v75
  v_max3_f32 v18, v18, v76, v77
  v_max3_f32 v17, v17, v78, v79
  v_max3_f32 v18, v18, v80, v81
  v_max3_f32 v17, v17, v82, v83
  v_max3_f32 v18, v18, v84, v85
  v_max3_f32 v17, v17, v86, v87
  v_max3_f32 v18, v18, v88, v89
  v_max3_f32 v17, v17, v90, v91
  v_max3_f32 v18, v18, v92, v93
  v_max3_f32 v17, v17, v94, v95
  v_max3_f32 v18, v18, v96, v97
  v_max3_f32 v17, v17, v98, v99
  v_max3_f32 v18, v18, v100, v101
  v_max3_f32 v17, v17, v102, v103
  v_max3_f32 v18, v18, v104, v105
  v_max3_f32 v17, v17, v106, v107
  v_max3_f32 v18, v18, v108, v109
  v_max3_f32 v17, v17, v110, v111
  v_max3_f32 v18, v18, v112, v113
  v_max3_f32 v17, v17, v114, v115
  v_max3_f32 v18, v18, v116, v117
  v_max3_f32 v17, v17, v118, v119
  v_max3_f32 v18, v18, v120, v121
  v_max3_f32 v17, v17, v122, v123
  v_max3_f32 v18, v18, v124, v125
  v_max3_f32 v17, v17, v126, v127
  v_max3_f32 v18, v18, v128, v129
  v_max3_f32 v17, v17, v130, v131
  v_max3_f32 v18, v18, v132, v133
  v_max3_f32 v17, v17, v134, v135
  v_max3_f32 v18, v18, v136, v137
  v_max3_f32 v17, v17, v138, v139
  v_max3_f32 v18, v18, v140, v141
  v_max3_f32 v17, v17, v142, v143
  v_max3_f32 v18, v18, v144, v145
  v_max3_f32 v17, v17, v146, v147
  v_max3_f32 v18, v18, v148, v149
  v_max3_f32 v17, v17, v150, v151
  v_max3_f32 v18, v18, v152, v153
  v_max3_f32 v17, v17, v154, v155
  v_max3_f32 v18, v18, v156, v157
  v_max3_f32 v17, v17, v158, v159
  v_max3_f32 v18, v18, v160, v161
  v_max3_f32 v17, v17, v162, v163
  v_max3_f32 v18, v18, v164, v165
  v_max3_f32 v17, v17, v166, v167
  v_max3_f32 v18, v18, v168, v169
  v_max3_f32 v17, v17, v170, v171
  v_max3_f32 v18, v18, v172, v173
  v_max3_f32 v17, v17, v174, v175
  v_max3_f32 v18, v18, v176, v177
  v_max3_f32 v17, v17, v178, v179
  v_max3_f32 v18, v18, v180, v181
  v_max3_f32 v17, v17, v182, v183
  v_max3_f32 v18, v18, v184, v185
  v_max3_f32 v17, v17, v186, v187
  v_max3_f32 v18, v18, v188, v189
  v_max3_f32 v17, v17, v190, v191
  v_max3_f32 v18, v18, v192, v193
  v_max3_f32 v17, v17, v194, v195
  v_max3_f32 v18, v18, v196, v197
  v_max3_f32 v17, v17, v198, v199
  v_max3_f32 v18, v18, v200, v201
  v_max3_f32 v17, v17, v202, v203
  v_max3_f32 v18, v18, v204, v205
  v_max3_f32 v17, v17, v206, v207
  v_max_f32 v17, v17, v18
  v_mov_b32 v18, v17
  s_nop 1
  v_permlane32_swap_b32 v17, v18
  s_nop 1
  v_max_f32 v17, v17, v18
  s_mov_b32 s58, 0x3ea52b5c
  v_mul_f32 v17, s58, v17
  s_cmp_gt_u32 s49, 0
  s_cbranch_scc1 L_p_skippv_44
  ds_read_b64_tr_b16 v[20:21], v7 offset:0
  ds_read_b64_tr_b16 v[22:23], v13 offset:0
  ds_read_b64_tr_b16 v[24:25], v7 offset:1024
  ds_read_b64_tr_b16 v[26:27], v13 offset:1024
  v_fma_f32 v64, v64, s58, -v17
  v_fma_f32 v65, v65, s58, -v17
  v_fma_f32 v66, v66, s58, -v17
  v_fma_f32 v67, v67, s58, -v17
  v_fma_f32 v68, v68, s58, -v17
  v_fma_f32 v69, v69, s58, -v17
  v_fma_f32 v70, v70, s58, -v17
  v_fma_f32 v71, v71, s58, -v17
  v_fma_f32 v72, v72, s58, -v17
  v_fma_f32 v73, v73, s58, -v17
  v_fma_f32 v74, v74, s58, -v17
  v_fma_f32 v75, v75, s58, -v17
  v_fma_f32 v76, v76, s58, -v17
  v_fma_f32 v77, v77, s58, -v17
  v_fma_f32 v78, v78, s58, -v17
  v_fma_f32 v79, v79, s58, -v17
  v_exp_f32 v64, v64
  v_exp_f32 v65, v65
  v_exp_f32 v66, v66
  v_exp_f32 v67, v67
  v_exp_f32 v68, v68
  v_exp_f32 v69, v69
  v_exp_f32 v70, v70
  v_exp_f32 v71, v71
  v_exp_f32 v72, v72
  v_exp_f32 v73, v73
  v_exp_f32 v74, v74
  v_exp_f32 v75, v75
  v_exp_f32 v76, v76
  v_exp_f32 v77, v77
  v_exp_f32 v78, v78
  v_exp_f32 v79, v79
  s_nop 0
  v_cvt_pk_bf16_f32 v64, v64, v65
  v_cvt_pk_bf16_f32 v65, v66, v67
  v_cvt_pk_bf16_f32 v66, v68, v69
  v_cvt_pk_bf16_f32 v67, v70, v71
  v_cvt_pk_bf16_f32 v68, v72, v73
  v_cvt_pk_bf16_f32 v69, v74, v75
  v_cvt_pk_bf16_f32 v70, v76, v77
  v_cvt_pk_bf16_f32 v71, v78, v79
  s_waitcnt lgkmcnt(0)
  s_nop 0
  v_mfma_f32_32x32x16_bf16 v[208:223], v[20:23], v[64:67], v[208:223]
  v_mfma_f32_32x32x16_bf16 v[208:223], v[24:27], v[68:71], v[208:223]
L_p_skippv_44:
  s_cmp_gt_u32 s49, 1
  s_cbranch_scc1 L_p_skippv_45
  ds_read_b64_tr_b16 v[28:29], v7 offset:2048
  ds_read_b64_tr_b16 v[30:31], v13 offset:2048
  ds_read_b64_tr_b16 v[32:33], v7 offset:3072
  ds_read_b64_tr_b16 v[34:35], v13 offset:3072
  v_fma_f32 v80, v80, s58, -v17
  v_fma_f32 v81, v81, s58, -v17
  v_fma_f32 v82, v82, s58, -v17
  v_fma_f32 v83, v83, s58, -v17
  v_fma_f32 v84, v84, s58, -v17
  v_fma_f32 v85, v85, s58, -v17
  v_fma_f32 v86, v86, s58, -v17
  v_fma_f32 v87, v87, s58, -v17
  v_fma_f32 v88, v88, s58, -v17
  v_fma_f32 v89, v89, s58, -v17
  v_fma_f32 v90, v90, s58, -v17
  v_fma_f32 v91, v91, s58, -v17
  v_fma_f32 v92, v92, s58, -v17
  v_fma_f32 v93, v93, s58, -v17
  v_fma_f32 v94, v94, s58, -v17
  v_fma_f32 v95, v95, s58, -v17
  v_exp_f32 v80, v80
  v_exp_f32 v81, v81
  v_exp_f32 v82, v82
  v_exp_f32 v83, v83
  v_exp_f32 v84, v84
  v_exp_f32 v85, v85
  v_exp_f32 v86, v86
  v_exp_f32 v87, v87
  v_exp_f32 v88, v88
  v_exp_f32 v89, v89
  v_exp_f32 v90, v90
  v_exp_f32 v91, v91
  v_exp_f32 v92, v92
  v_exp_f32 v93, v93
  v_exp_f32 v94, v94
  v_exp_f32 v95, v95
  s_nop 0
  v_cvt_pk_bf16_f32 v80, v80, v81
  v_cvt_pk_bf16_f32 v81, v82, v83
  v_cvt_pk_bf16_f32 v82, v84, v85
  v_cvt_pk_bf16_f32 v83, v86, v87
  v_cvt_pk_bf16_f32 v84, v88, v89
  v_cvt_pk_bf16_f32 v85, v90, v91
  v_cvt_pk_bf16_f32 v86, v92, v93
  v_cvt_pk_bf16_f32 v87, v94, v95
  s_waitcnt lgkmcnt(0)
  s_nop 0
  v_mfma_f32_32x32x16_bf16 v[208:223], v[28:31], v[80:83], v[208:223]
  v_mfma_f32_32x32x16_bf16 v[208:223], v[32:35], v[84:87], v[208:223]
L_p_skippv_45:
  s_cmp_gt_u32 s49, 2
  s_cbranch_scc1 L_p_skippv_46
  ds_read_b64_tr_b16 v[20:21], v7 offset:4096
  ds_read_b64_tr_b16 v[22:23], v13 offset:4096
  ds_read_b64_tr_b16 v[24:25], v7 offset:5120
  ds_read_b64_tr_b16 v[26:27], v13 offset:5120
  v_fma_f32 v96, v96, s58, -v17
  v_fma_f32 v97, v97, s58, -v17
  v_fma_f32 v98, v98, s58, -v17
  v_fma_f32 v99, v99, s58, -v17
  v_fma_f32 v100, v100, s58, -v17
  v_fma_f32 v101, v101, s58, -v17
  v_fma_f32 v102, v102, s58, -v17
  v_fma_f32 v103, v103, s58, -v17
  v_fma_f32 v104, v104, s58, -v17
  v_fma_f32 v105, v105, s58, -v17
  v_fma_f32 v106, v106, s58, -v17
  v_fma_f32 v107, v107, s58, -v17
  v_fma_f32 v108, v108, s58, -v17
  v_fma_f32 v109, v109, s58, -v17
  v_fma_f32 v110, v110, s58, -v17
  v_fma_f32 v111, v111, s58, -v17
  v_exp_f32 v96, v96
  v_exp_f32 v97, v97
  v_exp_f32 v98, v98
  v_exp_f32 v99, v99
  v_exp_f32 v100, v100
  v_exp_f32 v101, v101
  v_exp_f32 v102, v102
  v_exp_f32 v103, v103
  v_exp_f32 v104, v104
  v_exp_f32 v105, v105
  v_exp_f32 v106, v106
  v_exp_f32 v107, v107
  v_exp_f32 v108, v108
  v_exp_f32 v109, v109
  v_exp_f32 v110, v110
  v_exp_f32 v111, v111
  s_nop 0
  v_cvt_pk_bf16_f32 v96, v96, v97
  v_cvt_pk_bf16_f32 v97, v98, v99
  v_cvt_pk_bf16_f32 v98, v100, v101
  v_cvt_pk_bf16_f32 v99, v102, v103
  v_cvt_pk_bf16_f32 v100, v104, v105
  v_cvt_pk_bf16_f32 v101, v106, v107
  v_cvt_pk_bf16_f32 v102, v108, v109
  v_cvt_pk_bf16_f32 v103, v110, v111
  s_waitcnt lgkmcnt(0)
  s_nop 0
  v_mfma_f32_32x32x16_bf16 v[208:223], v[20:23], v[96:99], v[208:223]
  v_mfma_f32_32x32x16_bf16 v[208:223], v[24:27], v[100:103], v[208:223]
L_p_skippv_46:
  s_cmp_gt_u32 s49, 3
  s_cbranch_scc1 L_p_skippv_47
  ds_read_b64_tr_b16 v[28:29], v7 offset:6144
  ds_read_b64_tr_b16 v[30:31], v13 offset:6144
  ds_read_b64_tr_b16 v[32:33], v7 offset:7168
  ds_read_b64_tr_b16 v[34:35], v13 offset:7168
  v_fma_f32 v112, v112, s58, -v17
  v_fma_f32 v113, v113, s58, -v17
  v_fma_f32 v114, v114, s58, -v17
  v_fma_f32 v115, v115, s58, -v17
  v_fma_f32 v116, v116, s58, -v17
  v_fma_f32 v117, v117, s58, -v17
  v_fma_f32 v118, v118, s58, -v17
  v_fma_f32 v119, v119, s58, -v17
  v_fma_f32 v120, v120, s58, -v17
  v_fma_f32 v121, v121, s58, -v17
  v_fma_f32 v122, v122, s58, -v17
  v_fma_f32 v123, v123, s58, -v17
  v_fma_f32 v124, v124, s58, -v17
  v_fma_f32 v125, v125, s58, -v17
  v_fma_f32 v126, v126, s58, -v17
  v_fma_f32 v127, v127, s58, -v17
  v_exp_f32 v112, v112
  v_exp_f32 v113, v113
  v_exp_f32 v114, v114
  v_exp_f32 v115, v115
  v_exp_f32 v116, v116
  v_exp_f32 v117, v117
  v_exp_f32 v118, v118
  v_exp_f32 v119, v119
  v_exp_f32 v120, v120
  v_exp_f32 v121, v121
  v_exp_f32 v122, v122
  v_exp_f32 v123, v123
  v_exp_f32 v124, v124
  v_exp_f32 v125, v125
  v_exp_f32 v126, v126
  v_exp_f32 v127, v127
  s_nop 0
  v_cvt_pk_bf16_f32 v112, v112, v113
  v_cvt_pk_bf16_f32 v113, v114, v115
  v_cvt_pk_bf16_f32 v114, v116, v117
  v_cvt_pk_bf16_f32 v115, v118, v119
  v_cvt_pk_bf16_f32 v116, v120, v121
  v_cvt_pk_bf16_f32 v117, v122, v123
  v_cvt_pk_bf16_f32 v118, v124, v125
  v_cvt_pk_bf16_f32 v119, v126, v127
  s_waitcnt lgkmcnt(0)
  s_nop 0
  v_mfma_f32_32x32x16_bf16 v[208:223], v[28:31], v[112:115], v[208:223]
  v_mfma_f32_32x32x16_bf16 v[208:223], v[32:35], v[116:119], v[208:223]
L_p_skippv_47:
  s_cmp_gt_u32 s49, 4
  s_cbranch_scc1 L_p_skippv_48
  ds_read_b64_tr_b16 v[20:21], v7 offset:8192
  ds_read_b64_tr_b16 v[22:23], v13 offset:8192
  ds_read_b64_tr_b16 v[24:25], v7 offset:9216
  ds_read_b64_tr_b16 v[26:27], v13 offset:9216
  v_fma_f32 v128, v128, s58, -v17
  v_fma_f32 v129, v129, s58, -v17
  v_fma_f32 v130, v130, s58, -v17
  v_fma_f32 v131, v131, s58, -v17
  v_fma_f32 v132, v132, s58, -v17
  v_fma_f32 v133, v133, s58, -v17
  v_fma_f32 v134, v134, s58, -v17
  v_fma_f32 v135, v135, s58, -v17
  v_fma_f32 v136, v136, s58, -v17
  v_fma_f32 v137, v137, s58, -v17
  v_fma_f32 v138, v138, s58, -v17
  v_fma_f32 v139, v139, s58, -v17
  v_fma_f32 v140, v140, s58, -v17
  v_fma_f32 v141, v141, s58, -v17
  v_fma_f32 v142, v142, s58, -v17
  v_fma_f32 v143, v143, s58, -v17
  v_exp_f32 v128, v128
  v_exp_f32 v129, v129
  v_exp_f32 v130, v130
  v_exp_f32 v131, v131
  v_exp_f32 v132, v132
  v_exp_f32 v133, v133
  v_exp_f32 v134, v134
  v_exp_f32 v135, v135
  v_exp_f32 v136, v136
  v_exp_f32 v137, v137
  v_exp_f32 v138, v138
  v_exp_f32 v139, v139
  v_exp_f32 v140, v140
  v_exp_f32 v141, v141
  v_exp_f32 v142, v142
  v_exp_f32 v143, v143
  s_nop 0
  v_cvt_pk_bf16_f32 v128, v128, v129
  v_cvt_pk_bf16_f32 v129, v130, v131
  v_cvt_pk_bf16_f32 v130, v132, v133
  v_cvt_pk_bf16_f32 v131, v134, v135
  v_cvt_pk_bf16_f32 v132, v136, v137
  v_cvt_pk_bf16_f32 v133, v138, v139
  v_cvt_pk_bf16_f32 v134, v140, v141
  v_cvt_pk_bf16_f32 v135, v142, v143
  s_waitcnt lgkmcnt(0)
  s_nop 0
  v_mfma_f32_32x32x16_bf16 v[208:223], v[20:23], v[128:131], v[208:223]
  v_mfma_f32_32x32x16_bf16 v[208:223], v[24:27], v[132:135], v[208:223]
L_p_skippv_48:
  s_cmp_gt_u32 s49, 5
  s_cbranch_scc1 L_p_skippv_49
  ds_read_b64_tr_b16 v[28:29], v7 offset:10240
  ds_read_b64_tr_b16 v[30:31], v13 offset:10240
  ds_read_b64_tr_b16 v[32:33], v7 offset:11264
  ds_read_b64_tr_b16 v[34:35], v13 offset:11264
  v_fma_f32 v144, v144, s58, -v17
  v_fma_f32 v145, v145, s58, -v17
  v_fma_f32 v146, v146, s58, -v17
  v_fma_f32 v147, v147, s58, -v17
  v_fma_f32 v148, v148, s58, -v17
  v_fma_f32 v149, v149, s58, -v17
  v_fma_f32 v150, v150, s58, -v17
  v_fma_f32 v151, v151, s58, -v17
  v_fma_f32 v152, v152, s58, -v17
  v_fma_f32 v153, v153, s58, -v17
  v_fma_f32 v154, v154, s58, -v17
  v_fma_f32 v155, v155, s58, -v17
  v_fma_f32 v156, v156, s58, -v17
  v_fma_f32 v157, v157, s58, -v17
  v_fma_f32 v158, v158, s58, -v17
  v_fma_f32 v159, v159, s58, -v17
  v_exp_f32 v144, v144
  v_exp_f32 v145, v145
  v_exp_f32 v146, v146
  v_exp_f32 v147, v147
  v_exp_f32 v148, v148
  v_exp_f32 v149, v149
  v_exp_f32 v150, v150
  v_exp_f32 v151, v151
  v_exp_f32 v152, v152
  v_exp_f32 v153, v153
  v_exp_f32 v154, v154
  v_exp_f32 v155, v155
  v_exp_f32 v156, v156
  v_exp_f32 v157, v157
  v_exp_f32 v158, v158
  v_exp_f32 v159, v159
  s_nop 0
  v_cvt_pk_bf16_f32 v144, v144, v145
  v_cvt_pk_bf16_f32 v145, v146, v147
  v_cvt_pk_bf16_f32 v146, v148, v149
  v_cvt_pk_bf16_f32 v147, v150, v151
  v_cvt_pk_bf16_f32 v148, v152, v153
  v_cvt_pk_bf16_f32 v149, v154, v155
  v_cvt_pk_bf16_f32 v150, v156, v157
  v_cvt_pk_bf16_f32 v151, v158, v159
  s_waitcnt lgkmcnt(0)
  s_nop 0
  v_mfma_f32_32x32x16_bf16 v[208:223], v[28:31], v[144:147], v[208:223]
  v_mfma_f32_32x32x16_bf16 v[208:223], v[32:35], v[148:151], v[208:223]
L_p_skippv_49:
  s_cmp_gt_u32 s49, 6
  s_cbranch_scc1 L_p_skippv_50
  ds_read_b64_tr_b16 v[20:21], v7 offset:12288
  ds_read_b64_tr_b16 v[22:23], v13 offset:12288
  ds_read_b64_tr_b16 v[24:25], v7 offset:13312
  ds_read_b64_tr_b16 v[26:27], v13 offset:13312
  v_fma_f32 v160, v160, s58, -v17
  v_fma_f32 v161, v161, s58, -v17
  v_fma_f32 v162, v162, s58, -v17
  v_fma_f32 v163, v163, s58, -v17
  v_fma_f32 v164, v164, s58, -v17
  v_fma_f32 v165, v165, s58, -v17
  v_fma_f32 v166, v166, s58, -v17
  v_fma_f32 v167, v167, s58, -v17
  v_fma_f32 v168, v168, s58, -v17
  v_fma_f32 v169, v169, s58, -v17
  v_fma_f32 v170, v170, s58, -v17
  v_fma_f32 v171, v171, s58, -v17
  v_fma_f32 v172, v172, s58, -v17
  v_fma_f32 v173, v173, s58, -v17
  v_fma_f32 v174, v174, s58, -v17
  v_fma_f32 v175, v175, s58, -v17
  v_exp_f32 v160, v160
  v_exp_f32 v161, v161
  v_exp_f32 v162, v162
  v_exp_f32 v163, v163
  v_exp_f32 v164, v164
  v_exp_f32 v165, v165
  v_exp_f32 v166, v166
  v_exp_f32 v167, v167
  v_exp_f32 v168, v168
  v_exp_f32 v169, v169
  v_exp_f32 v170, v170
  v_exp_f32 v171, v171
  v_exp_f32 v172, v172
  v_exp_f32 v173, v173
  v_exp_f32 v174, v174
  v_exp_f32 v175, v175
  s_nop 0
  v_cvt_pk_bf16_f32 v160, v160, v161
  v_cvt_pk_bf16_f32 v161, v162, v163
  v_cvt_pk_bf16_f32 v162, v164, v165
  v_cvt_pk_bf16_f32 v163, v166, v167
  v_cvt_pk_bf16_f32 v164, v168, v169
  v_cvt_pk_bf16_f32 v165, v170, v171
  v_cvt_pk_bf16_f32 v166, v172, v173
  v_cvt_pk_bf16_f32 v167, v174, v175
  s_waitcnt lgkmcnt(0)
  s_nop 0
  v_mfma_f32_32x32x16_bf16 v[208:223], v[20:23], v[160:163], v[208:223]
  v_mfma_f32_32x32x16_bf16 v[208:223], v[24:27], v[164:167], v[208:223]
L_p_skippv_50:
  s_cmp_gt_u32 s49, 7
  s_cbranch_scc1 L_p_skippv_51
  ds_read_b64_tr_b16 v[28:29], v7 offset:14336
  ds_read_b64_tr_b16 v[30:31], v13 offset:14336
  ds_read_b64_tr_b16 v[32:33], v7 offset:15360
  ds_read_b64_tr_b16 v[34:35], v13 offset:15360
  v_fma_f32 v176, v176, s58, -v17
  v_fma_f32 v177, v177, s58, -v17
  v_fma_f32 v178, v178, s58, -v17
  v_fma_f32 v179, v179, s58, -v17
  v_fma_f32 v180, v180, s58, -v17
  v_fma_f32 v181, v181, s58, -v17
  v_fma_f32 v182, v182, s58, -v17
  v_fma_f32 v183, v183, s58, -v17
  v_fma_f32 v184, v184, s58, -v17
  v_fma_f32 v185, v185, s58, -v17
  v_fma_f32 v186, v186, s58, -v17
  v_fma_f32 v187, v187, s58, -v17
  v_fma_f32 v188, v188, s58, -v17
  v_fma_f32 v189, v189, s58, -v17
  v_fma_f32 v190, v190, s58, -v17
  v_fma_f32 v191, v191, s58, -v17
  v_exp_f32 v176, v176
  v_exp_f32 v177, v177
  v_exp_f32 v178, v178
  v_exp_f32 v179, v179
  v_exp_f32 v180, v180
  v_exp_f32 v181, v181
  v_exp_f32 v182, v182
  v_exp_f32 v183, v183
  v_exp_f32 v184, v184
  v_exp_f32 v185, v185
  v_exp_f32 v186, v186
  v_exp_f32 v187, v187
  v_exp_f32 v188, v188
  v_exp_f32 v189, v189
  v_exp_f32 v190, v190
  v_exp_f32 v191, v191
  s_nop 0
  v_cvt_pk_bf16_f32 v176, v176, v177
  v_cvt_pk_bf16_f32 v177, v178, v179
  v_cvt_pk_bf16_f32 v178, v180, v181
  v_cvt_pk_bf16_f32 v179, v182, v183
  v_cvt_pk_bf16_f32 v180, v184, v185
  v_cvt_pk_bf16_f32 v181, v186, v187
  v_cvt_pk_bf16_f32 v182, v188, v189
  v_cvt_pk_bf16_f32 v183, v190, v191
  s_waitcnt lgkmcnt(0)
  s_nop 0
  v_mfma_f32_32x32x16_bf16 v[208:223], v[28:31], v[176:179], v[208:223]
  v_mfma_f32_32x32x16_bf16 v[208:223], v[32:35], v[180:183], v[208:223]
L_p_skippv_51:
  ds_read_b64_tr_b16 v[20:21], v7 offset:16384
  ds_read_b64_tr_b16 v[22:23], v13 offset:16384
  ds_read_b64_tr_b16 v[24:25], v7 offset:17408
  ds_read_b64_tr_b16 v[26:27], v13 offset:17408
  v_fma_f32 v192, v192, s58, -v17
  v_fma_f32 v193, v193, s58, -v17
  v_fma_f32 v194, v194, s58, -v17
  v_fma_f32 v195, v195, s58, -v17
  v_fma_f32 v196, v196, s58, -v17
  v_fma_f32 v197, v197, s58, -v17
  v_fma_f32 v198, v198, s58, -v17
  v_fma_f32 v199, v199, s58, -v17
  v_fma_f32 v200, v200, s58, -v17
  v_fma_f32 v201, v201, s58, -v17
  v_fma_f32 v202, v202, s58, -v17
  v_fma_f32 v203, v203, s58, -v17
  v_fma_f32 v204, v204, s58, -v17
  v_fma_f32 v205, v205, s58, -v17
  v_fma_f32 v206, v206, s58, -v17
  v_fma_f32 v207, v207, s58, -v17
  v_exp_f32 v192, v192
  v_exp_f32 v193, v193
  v_exp_f32 v194, v194
  v_exp_f32 v195, v195
  v_exp_f32 v196, v196
  v_exp_f32 v197, v197
  v_exp_f32 v198, v198
  v_exp_f32 v199, v199
  v_exp_f32 v200, v200
  v_exp_f32 v201, v201
  v_exp_f32 v202, v202
  v_exp_f32 v203, v203
  v_exp_f32 v204, v204
  v_exp_f32 v205, v205
  v_exp_f32 v206, v206
  v_exp_f32 v207, v207
  s_nop 0
  v_cvt_pk_bf16_f32 v192, v192, v193
  v_cvt_pk_bf16_f32 v193, v194, v195
  v_cvt_pk_bf16_f32 v194, v196, v197
  v_cvt_pk_bf16_f32 v195, v198, v199
  v_cvt_pk_bf16_f32 v196, v200, v201
  v_cvt_pk_bf16_f32 v197, v202, v203
  v_cvt_pk_bf16_f32 v198, v204, v205
  v_cvt_pk_bf16_f32 v199, v206, v207
  s_waitcnt lgkmcnt(0)
  s_nop 0
  v_mfma_f32_32x32x16_bf16 v[208:223], v[20:23], v[192:195], v[208:223]
  v_mfma_f32_32x32x16_bf16 v[208:223], v[24:27], v[196:199], v[208:223]
  s_nop 15
L_p_attdone_17:
  s_add_u32 s20, s4, 0x1574000
  s_addc_u32 s21, s5, 0
  s_and_b32 s21, s21, 0xffff
  s_mov_b32 s22, 0x280000
  s_mov_b32 s23, 0x20000
  v_lshrrev_b32 v9, 5, v2
  v_cmp_eq_u32 s[46:47], 0, v9
  s_lshr_b32 s33, s3, 2
  s_nop 0
  v_cndmask_b32 v12, v216, v220, s[46:47]
  v_rcp_f32 v12, v12
  v_and_b32 v10, 31, v2
  s_lshl_b32 s50, s32, 5
  v_add_u32 v10, s50, v10
  v_lshrrev_b32 v11, 4, v10
  v_mul_u32_u24 v11, 20*1024, v11
  v_and_b32 v10, 15, v10
  v_lshlrev_b32 v10, 4, v10
  v_add_u32 v11, v11, v10
  v_mul_f32 v208, v208, v12
  v_mul_f32 v209, v209, v12
  v_mul_f32 v210, v210, v12
  v_mul_f32 v211, v211, v12
  v_mul_f32 v212, v212, v12
  v_mul_f32 v213, v213, v12
  v_mul_f32 v214, v214, v12
  v_mul_f32 v215, v215, v12
  v_mul_f32 v216, v216, v12
  v_mul_f32 v217, v217, v12
  v_mul_f32 v218, v218, v12
  v_mul_f32 v219, v219, v12
  v_cvt_pk_bf16_f32 v16, v208, v209
  v_cvt_pk_bf16_f32 v17, v210, v211
  v_cvt_pk_bf16_f32 v18, v212, v213
  v_cvt_pk_bf16_f32 v19, v214, v215
  v_cvt_pk_bf16_f32 v20, v216, v217
  v_cvt_pk_bf16_f32 v21, v218, v219
  s_mul_i32 s50, s31, 5
  s_lshl_b32 s51, s33, 1
  s_add_u32 s51, s51, s50
  v_add_u32 v12, s51, v9
  v_lshrrev_b32 v13, 2, v12
  v_lshlrev_b32 v13, 10, v13
  v_and_b32 v12, 3, v12
  v_lshlrev_b32 v12, 8, v12
  v_add3_u32 v12, v11, v12, v13
  buffer_store_dwordx4 v[16:19], v12, s[20:23], 0 offen sc1
  s_add_u32 s50, s50, 4
  s_lshr_b32 s51, s50, 2
  s_lshl_b32 s51, s51, 10
  s_and_b32 s50, s50, 3
  s_lshl_b32 s50, s50, 8
  s_add_u32 s50, s50, s51
  s_lshl_b32 s51, s33, 3
  s_add_u32 s50, s50, s51
  s_mov_b64 exec, s[46:47]
  buffer_store_dwordx2 v[20:21], v11, s[20:23], s50 offen sc1
  s_mov_b64 exec, -1
  s_barrier
  s_cmp_ge_u32 s3, 4
  s_cbranch_scc1 L_H_wo
  s_waitcnt vmcnt(0)
  v_mov_b32 v12, 161800
  v_mov_b32 v13, 1
  s_mov_b64 exec, 1
  ds_add_u32 v12, v13
  s_mov_b64 exec, -1
  s_cmp_lg_u32 s3, 0
  s_cbranch_scc1 L_p_nosig_53
  v_mov_b32 v12, 161800
  s_mov_b32 s63, 320000
L_p_lw_55:
  ds_read_b32 v14, v12
  s_waitcnt lgkmcnt(0)
  v_readfirstlane_b32 s60, v14
  s_cmp_ge_u32 s60, 8
  s_cbranch_scc1 L_p_lwd_56
  s_sub_u32 s63, s63, 1
  s_cmp_lg_u32 s63, 0
  s_cbranch_scc1 L_p_lw_55
L_p_lwd_56:
  s_lshl_b32 s60, s30, 7
  s_add_u32 s60, s60, 32768
  v_mov_b32 v12, s60
  v_mov_b32 v13, 1
  s_mov_b64 exec, 1
  buffer_atomic_add v13, v12, s[16:19], 0 offen sc1
  s_mov_b64 exec, 1
  s_mov_b32 s63, 40000
L_p_poll_57:
  buffer_load_dword v14, v12, s[16:19], 0 offen sc1
  s_waitcnt vmcnt(0)
  v_cmp_le_u32 vcc, 16, v14
  s_nop 1
  s_cmp_eq_u64 vcc, exec
  s_cbranch_scc1 L_p_polled_58
  s_sub_u32 s63, s63, 1
  s_cmp_lg_u32 s63, 0
  s_cbranch_scc1 L_p_poll_57
L_p_polled_58:
  s_mov_b64 exec, -1
  v_mov_b32 v12, 161804
  v_mov_b32 v13, 1
  s_mov_b64 exec, 1
  ds_write_b32 v12, v13
  s_mov_b64 exec, -1
  s_branch L_p_hj_54
L_p_nosig_53:
  v_mov_b32 v12, 161804
  s_mov_b32 s63, 320000
L_p_lw_59:
  ds_read_b32 v14, v12
  s_waitcnt lgkmcnt(0)
  v_readfirstlane_b32 s60, v14
  s_cmp_ge_u32 s60, 1
  s_cbranch_scc1 L_p_lwd_60
  s_sub_u32 s63, s63, 1
  s_cmp_lg_u32 s63, 0
  s_cbranch_scc1 L_p_lw_59
L_p_lwd_60:
L_p_hj_54:
  s_add_u32 s8, s4, 0x1574000
  s_addc_u32 s9, s5, 0
  s_and_b32 s9, s9, 0xffff
  s_mov_b32 s10, 0x280000
  s_mov_b32 s11, 0x20000
  s_and_b32 s52, s3, 1
  s_lshr_b32 s53, s3, 1
  s_lshl_b32 s54, s37, 2
  s_lshl_b32 s55, s52, 1
  s_add_u32 s54, s54, s55
  s_mul_i32 s55, s54, 20
  s_mul_i32 s56, s53, 10
  s_add_u32 s55, s55, s56
  s_lshl_b32 s33, s55, 10
  s_add_u32 s57, s54, s53
  v_and_b32 v9, 15, v2
  v_lshrrev_b32 v10, 4, v2
  s_lshl_b32 s59, s57, 4
  v_add_u32 v11, s59, v9
  s_mul_i32 s59, s38, 80
  v_lshlrev_b32 v12, 2, v10
  v_add_u32 v12, s59, v12
  v_mul_u32_u24 v13, 1280, v11
  v_lshlrev_b32 v14, 1, v12
  v_add_u32 v250, v13, v14
  v_lshrrev_b32 v14, 5, v11
  v_mul_u32_u24 v14, 40*1024, v14
  v_and_b32 v15, 31, v11
  v_lshrrev_b32 v56, 1, v10
  v_lshlrev_b32 v56, 5, v56
  v_add_u32 v15, v15, v56
  v_lshlrev_b32 v15, 4, v15
  v_add_u32 v14, v14, v15
  v_and_b32 v15, 1, v10
  v_lshlrev_b32 v15, 3, v15
  v_add_u32 v14, v14, v15
  s_mul_i32 s59, s38, 5*1024
  v_add_u32 v14, s59, v14
  v_and_b32 v57, 1, v10
  v_mul_u32_u24 v57, 1016, v57
  v_add_u32 v57, v14, v57
  v_and_b32 v15, 63, v11
  v_mul_u32_u24 v15, 160, v15
  v_lshlrev_b32 v56, 3, v10
  v_add_u32 v15, v15, v56
  v_add_u32 v15, 147456, v15
  v_lshlrev_b32 v251, 4, v10
  v_add_u32 v251, 157696, v251
  s_mul_i32 s60, s3, 5120
  s_add_u32 s60, s60, 122880
  v_add_u32 v254, s60, v3
  s_xor_b32 s61, s3, 2
  s_mul_i32 s61, s61, 5120
  s_add_u32 s61, s61, 122880
  v_add_u32 v253, s61, v3
  s_add_u32 s20, s4, 0x17f4000
  s_addc_u32 s21, s5, 0
  s_and_b32 s21, s21, 0xffff
  s_mov_b32 s22, 0x280000
  s_mov_b32 s23, 0x20000
  s_add_u32 s40, s4, 0x1a74000
  s_addc_u32 s41, s5, 0
  s_and_b32 s41, s41, 0xffff
  s_mov_b32 s42, 0x20000
  s_mov_b32 s43, 0x20000
  s_lshr_b32 s60, s3, 1
  s_mul_i32 s60, s60, 10240
  v_add_u32 v6, s60, v3
  v_add_u32 v7, 0x10000, v6
  v_add_u32 v8, 0x20000, v6
  s_mov_b32 s39, s33
  s_mov_b32 s35, s39
  s_add_u32 s36, s39, 20480
  s_add_u32 s39, s39, 2048
  buffer_load_dwordx4 v[128:131], v3, s[8:11], s35 offen offset:0 sc1
  buffer_load_dwordx4 v[132:135], v3, s[8:11], s36 offen offset:0 sc1
  buffer_load_dwordx4 v[136:139], v3, s[8:11], s35 offen offset:1024 sc1
  buffer_load_dwordx4 v[140:143], v3, s[8:11], s36 offen offset:1024 sc1
  s_mov_b32 s35, s39
  s_add_u32 s36, s39, 20480
  s_add_u32 s39, s39, 2048
  buffer_load_dwordx4 v[144:147], v3, s[8:11], s35 offen offset:0 sc1
  buffer_load_dwordx4 v[148:151], v3, s[8:11], s36 offen offset:0 sc1
  buffer_load_dwordx4 v[152:155], v3, s[8:11], s35 offen offset:1024 sc1
  buffer_load_dwordx4 v[156:159], v3, s[8:11], s36 offen offset:1024 sc1
  s_mov_b32 s35, s39
  s_add_u32 s36, s39, 20480
  s_add_u32 s39, s39, 2048
  buffer_load_dwordx4 v[160:163], v3, s[8:11], s35 offen offset:0 sc1
  buffer_load_dwordx4 v[164:167], v3, s[8:11], s36 offen offset:0 sc1
  buffer_load_dwordx4 v[168:171], v3, s[8:11], s35 offen offset:1024 sc1
  buffer_load_dwordx4 v[172:175], v3, s[8:11], s36 offen offset:1024 sc1
  s_barrier
  ds_read_b128 v[16:19], v7 offset:61440
  ds_read_b128 v[20:23], v7 offset:62464
  ds_read_b128 v[24:27], v7 offset:63488
  ds_read_b128 v[28:31], v7 offset:64512
  ds_read_b128 v[32:35], v8 offset:0
  s_waitcnt lgkmcnt(0)
  s_waitcnt vmcnt(10)
  v_mfma_f32_16x16x32_bf16 v[64:67], v[16:19], v[128:131], 0
  ds_read_b128 v[36:39], v8 offset:1024
  v_mfma_f32_16x16x32_bf16 v[68:71], v[20:23], v[128:131], 0
  ds_read_b128 v[40:43], v8 offset:2048
  v_mfma_f32_16x16x32_bf16 v[72:75], v[24:27], v[128:131], 0
  ds_read_b128 v[44:47], v8 offset:3072
  v_mfma_f32_16x16x32_bf16 v[76:79], v[28:31], v[128:131], 0
  ds_read_b128 v[48:51], v8 offset:4096
  v_mfma_f32_16x16x32_bf16 v[80:83], v[32:35], v[128:131], 0
  ds_read_b128 v[52:55], v8 offset:5120
  v_mfma_f32_16x16x32_bf16 v[84:87], v[16:19], v[132:135], 0
  s_mov_b32 s35, s39
  s_add_u32 s36, s39, 20480
  s_add_u32 s39, s39, 2048
  buffer_load_dwordx4 v[176:179], v3, s[8:11], s35 offen offset:0 sc1
  v_mfma_f32_16x16x32_bf16 v[88:91], v[20:23], v[132:135], 0
  v_mfma_f32_16x16x32_bf16 v[92:95], v[24:27], v[132:135], 0
  buffer_load_dwordx4 v[180:183], v3, s[8:11], s36 offen offset:0 sc1
  v_mfma_f32_16x16x32_bf16 v[96:99], v[28:31], v[132:135], 0
  v_mfma_f32_16x16x32_bf16 v[100:103], v[32:35], v[132:135], 0
  ds_read_b64 v[104:105], v15 offset:0
  ds_read_b128 v[208:211], v251 offset:0
  ds_read_b128 v[228:231], v251 offset:640
  ds_read_b64 v[106:107], v15 offset:32
  ds_read_b128 v[212:215], v251 offset:64
  ds_read_b128 v[232:235], v251 offset:704
  ds_read_b64 v[108:109], v15 offset:64
  ds_read_b128 v[216:219], v251 offset:128
  ds_read_b128 v[236:239], v251 offset:768
  ds_read_b64 v[110:111], v15 offset:96
  ds_read_b128 v[220:223], v251 offset:192
  ds_read_b128 v[114:117], v251 offset:832
  ds_read_b64 v[112:113], v15 offset:128
  ds_read_b128 v[224:227], v251 offset:256
  ds_read_b128 v[118:121], v251 offset:896
  s_waitcnt lgkmcnt(0)
  s_waitcnt vmcnt(10)
  v_mfma_f32_16x16x32_bf16 v[64:67], v[36:39], v[136:139], v[64:67]
  ds_read_b128 v[16:19], v7 offset:20480
  v_mfma_f32_16x16x32_bf16 v[68:71], v[40:43], v[136:139], v[68:71]
  ds_read_b128 v[20:23], v7 offset:21504
  v_mfma_f32_16x16x32_bf16 v[72:75], v[44:47], v[136:139], v[72:75]
  ds_read_b128 v[24:27], v7 offset:22528
  v_mfma_f32_16x16x32_bf16 v[76:79], v[48:51], v[136:139], v[76:79]
  ds_read_b128 v[28:31], v7 offset:23552
  v_mfma_f32_16x16x32_bf16 v[80:83], v[52:55], v[136:139], v[80:83]
  ds_read_b128 v[32:35], v7 offset:24576
  v_mfma_f32_16x16x32_bf16 v[84:87], v[36:39], v[140:143], v[84:87]
  buffer_load_dwordx4 v[184:187], v3, s[8:11], s35 offen offset:1024 sc1
  v_mfma_f32_16x16x32_bf16 v[88:91], v[40:43], v[140:143], v[88:91]
  v_mfma_f32_16x16x32_bf16 v[92:95], v[44:47], v[140:143], v[92:95]
  buffer_load_dwordx4 v[188:191], v3, s[8:11], s36 offen offset:1024 sc1
  v_mfma_f32_16x16x32_bf16 v[96:99], v[48:51], v[140:143], v[96:99]
  v_mfma_f32_16x16x32_bf16 v[100:103], v[52:55], v[140:143], v[100:103]
  s_waitcnt lgkmcnt(0)
  s_waitcnt vmcnt(10)
  v_mfma_f32_16x16x32_bf16 v[64:67], v[16:19], v[144:147], v[64:67]
  ds_read_b128 v[36:39], v7 offset:25600
  v_mfma_f32_16x16x32_bf16 v[68:71], v[20:23], v[144:147], v[68:71]
  ds_read_b128 v[40:43], v7 offset:26624
  v_mfma_f32_16x16x32_bf16 v[72:75], v[24:27], v[144:147], v[72:75]
  ds_read_b128 v[44:47], v7 offset:27648
  v_mfma_f32_16x16x32_bf16 v[76:79], v[28:31], v[144:147], v[76:79]
  ds_read_b128 v[48:51], v7 offset:28672
  v_mfma_f32_16x16x32_bf16 v[80:83], v[32:35], v[144:147], v[80:83]
  ds_read_b128 v[52:55], v7 offset:29696
  v_mfma_f32_16x16x32_bf16 v[84:87], v[16:19], v[148:151], v[84:87]
  s_mov_b32 s35, s39
  s_add_u32 s36, s39, 20480
  s_add_u32 s39, s39, 2048
  buffer_load_dwordx4 v[192:195], v3, s[8:11], s35 offen offset:0 sc1
  v_mfma_f32_16x16x32_bf16 v[88:91], v[20:23], v[148:151], v[88:91]
  v_mfma_f32_16x16x32_bf16 v[92:95], v[24:27], v[148:151], v[92:95]
  buffer_load_dwordx4 v[196:199], v3, s[8:11], s36 offen offset:0 sc1
  v_mfma_f32_16x16x32_bf16 v[96:99], v[28:31], v[148:151], v[96:99]
  v_mfma_f32_16x16x32_bf16 v[100:103], v[32:35], v[148:151], v[100:103]
  s_waitcnt lgkmcnt(0)
  s_waitcnt vmcnt(10)
  v_mfma_f32_16x16x32_bf16 v[64:67], v[36:39], v[152:155], v[64:67]
  ds_read_b128 v[16:19], v7 offset:40960
  v_mfma_f32_16x16x32_bf16 v[68:71], v[40:43], v[152:155], v[68:71]
  ds_read_b128 v[20:23], v7 offset:41984
  v_mfma_f32_16x16x32_bf16 v[72:75], v[44:47], v[152:155], v[72:75]
  ds_read_b128 v[24:27], v7 offset:43008
  v_mfma_f32_16x16x32_bf16 v[76:79], v[48:51], v[152:155], v[76:79]
  ds_read_b128 v[28:31], v7 offset:44032
  v_mfma_f32_16x16x32_bf16 v[80:83], v[52:55], v[152:155], v[80:83]
  ds_read_b128 v[32:35], v7 offset:45056
  v_mfma_f32_16x16x32_bf16 v[84:87], v[36:39], v[156:159], v[84:87]
  buffer_load_dwordx4 v[200:203], v3, s[8:11], s35 offen offset:1024 sc1
  v_mfma_f32_16x16x32_bf16 v[88:91], v[40:43], v[156:159], v[88:91]
  v_mfma_f32_16x16x32_bf16 v[92:95], v[44:47], v[156:159], v[92:95]
  buffer_load_dwordx4 v[204:207], v3, s[8:11], s36 offen offset:1024 sc1
  v_mfma_f32_16x16x32_bf16 v[96:99], v[48:51], v[156:159], v[96:99]
  v_mfma_f32_16x16x32_bf16 v[100:103], v[52:55], v[156:159], v[100:103]
  s_waitcnt lgkmcnt(0)
  s_waitcnt vmcnt(10)
  v_mfma_f32_16x16x32_bf16 v[64:67], v[16:19], v[160:163], v[64:67]
  ds_read_b128 v[36:39], v7 offset:46080
  v_mfma_f32_16x16x32_bf16 v[68:71], v[20:23], v[160:163], v[68:71]
  ds_read_b128 v[40:43], v7 offset:47104
  v_mfma_f32_16x16x32_bf16 v[72:75], v[24:27], v[160:163], v[72:75]
  ds_read_b128 v[44:47], v7 offset:48128
  v_mfma_f32_16x16x32_bf16 v[76:79], v[28:31], v[160:163], v[76:79]
  ds_read_b128 v[48:51], v7 offset:49152
  v_mfma_f32_16x16x32_bf16 v[80:83], v[32:35], v[160:163], v[80:83]
  ds_read_b128 v[52:55], v7 offset:50176
  v_mfma_f32_16x16x32_bf16 v[84:87], v[16:19], v[164:167], v[84:87]
  v_mfma_f32_16x16x32_bf16 v[88:91], v[20:23], v[164:167], v[88:91]
  v_mfma_f32_16x16x32_bf16 v[92:95], v[24:27], v[164:167], v[92:95]
  v_mfma_f32_16x16x32_bf16 v[96:99], v[28:31], v[164:167], v[96:99]
  v_mfma_f32_16x16x32_bf16 v[100:103], v[32:35], v[164:167], v[100:103]
  s_waitcnt lgkmcnt(0)
  s_waitcnt vmcnt(8)
  v_mfma_f32_16x16x32_bf16 v[64:67], v[36:39], v[168:171], v[64:67]
  ds_read_b128 v[16:19], v6 offset:0
  v_mfma_f32_16x16x32_bf16 v[68:71], v[40:43], v[168:171], v[68:71]
  ds_read_b128 v[20:23], v6 offset:1024
  v_mfma_f32_16x16x32_bf16 v[72:75], v[44:47], v[168:171], v[72:75]
  ds_read_b128 v[24:27], v6 offset:2048
  v_mfma_f32_16x16x32_bf16 v[76:79], v[48:51], v[168:171], v[76:79]
  ds_read_b128 v[28:31], v6 offset:3072
  v_mfma_f32_16x16x32_bf16 v[80:83], v[52:55], v[168:171], v[80:83]
  ds_read_b128 v[32:35], v6 offset:4096
  v_mfma_f32_16x16x32_bf16 v[84:87], v[36:39], v[172:175], v[84:87]
  v_mfma_f32_16x16x32_bf16 v[88:91], v[40:43], v[172:175], v[88:91]
  v_mfma_f32_16x16x32_bf16 v[92:95], v[44:47], v[172:175], v[92:95]
  v_mfma_f32_16x16x32_bf16 v[96:99], v[48:51], v[172:175], v[96:99]
  v_mfma_f32_16x16x32_bf16 v[100:103], v[52:55], v[172:175], v[100:103]
  s_waitcnt lgkmcnt(0)
  s_waitcnt vmcnt(6)
  v_mfma_f32_16x16x32_bf16 v[64:67], v[16:19], v[176:179], v[64:67]
  ds_read_b128 v[36:39], v6 offset:5120
  v_mfma_f32_16x16x32_bf16 v[68:71], v[20:23], v[176:179], v[68:71]
  ds_read_b128 v[40:43], v6 offset:6144
  v_mfma_f32_16x16x32_bf16 v[72:75], v[24:27], v[176:179], v[72:75]
  ds_read_b128 v[44:47], v6 offset:7168
  v_mfma_f32_16x16x32_bf16 v[76:79], v[28:31], v[176:179], v[76:79]
  ds_read_b128 v[48:51], v6 offset:8192
  v_mfma_f32_16x16x32_bf16 v[80:83], v[32:35], v[176:179], v[80:83]
  ds_read_b128 v[52:55], v6 offset:9216
  v_mfma_f32_16x16x32_bf16 v[84:87], v[16:19], v[180:183], v[84:87]
  v_mfma_f32_16x16x32_bf16 v[88:91], v[20:23], v[180:183], v[88:91]
  v_mfma_f32_16x16x32_bf16 v[92:95], v[24:27], v[180:183], v[92:95]
  v_mfma_f32_16x16x32_bf16 v[96:99], v[28:31], v[180:183], v[96:99]
  v_mfma_f32_16x16x32_bf16 v[100:103], v[32:35], v[180:183], v[100:103]
  s_waitcnt lgkmcnt(0)
  s_waitcnt vmcnt(4)
  v_mfma_f32_16x16x32_bf16 v[64:67], v[36:39], v[184:187], v[64:67]
  ds_read_b128 v[16:19], v6 offset:20480
  v_mfma_f32_16x16x32_bf16 v[68:71], v[40:43], v[184:187], v[68:71]
  ds_read_b128 v[20:23], v6 offset:21504
  v_mfma_f32_16x16x32_bf16 v[72:75], v[44:47], v[184:187], v[72:75]
  ds_read_b128 v[24:27], v6 offset:22528
  v_mfma_f32_16x16x32_bf16 v[76:79], v[48:51], v[184:187], v[76:79]
  ds_read_b128 v[28:31], v6 offset:23552
  v_mfma_f32_16x16x32_bf16 v[80:83], v[52:55], v[184:187], v[80:83]
  ds_read_b128 v[32:35], v6 offset:24576
  v_mfma_f32_16x16x32_bf16 v[84:87], v[36:39], v[188:191], v[84:87]
  v_mfma_f32_16x16x32_bf16 v[88:91], v[40:43], v[188:191], v[88:91]
  v_mfma_f32_16x16x32_bf16 v[92:95], v[44:47], v[188:191], v[92:95]
  v_mfma_f32_16x16x32_bf16 v[96:99], v[48:51], v[188:191], v[96:99]
  v_mfma_f32_16x16x32_bf16 v[100:103], v[52:55], v[188:191], v[100:103]
  s_waitcnt lgkmcnt(0)
  s_waitcnt vmcnt(2)
  v_mfma_f32_16x16x32_bf16 v[64:67], v[16:19], v[192:195], v[64:67]
  ds_read_b128 v[36:39], v6 offset:25600
  v_mfma_f32_16x16x32_bf16 v[68:71], v[20:23], v[192:195], v[68:71]
  ds_read_b128 v[40:43], v6 offset:26624
  v_mfma_f32_16x16x32_bf16 v[72:75], v[24:27], v[192:195], v[72:75]
  ds_read_b128 v[44:47], v6 offset:27648
  v_mfma_f32_16x16x32_bf16 v[76:79], v[28:31], v[192:195], v[76:79]
  ds_read_b128 v[48:51], v6 offset:28672
  v_mfma_f32_16x16x32_bf16 v[80:83], v[32:35], v[192:195], v[80:83]
  ds_read_b128 v[52:55], v6 offset:29696
  v_mfma_f32_16x16x32_bf16 v[84:87], v[16:19], v[196:199], v[84:87]
  v_mfma_f32_16x16x32_bf16 v[88:91], v[20:23], v[196:199], v[88:91]
  v_mfma_f32_16x16x32_bf16 v[92:95], v[24:27], v[196:199], v[92:95]
  v_mfma_f32_16x16x32_bf16 v[96:99], v[28:31], v[196:199], v[96:99]
  v_mfma_f32_16x16x32_bf16 v[100:103], v[32:35], v[196:199], v[100:103]
  s_waitcnt lgkmcnt(0)
  s_waitcnt vmcnt(0)
  v_mfma_f32_16x16x32_bf16 v[64:67], v[36:39], v[200:203], v[64:67]
  v_mfma_f32_16x16x32_bf16 v[68:71], v[40:43], v[200:203], v[68:71]
  v_mfma_f32_16x16x32_bf16 v[72:75], v[44:47], v[200:203], v[72:75]
  v_mfma_f32_16x16x32_bf16 v[76:79], v[48:51], v[200:203], v[76:79]
  v_mfma_f32_16x16x32_bf16 v[80:83], v[52:55], v[200:203], v[80:83]
  v_mfma_f32_16x16x32_bf16 v[84:87], v[36:39], v[204:207], v[84:87]
  v_mfma_f32_16x16x32_bf16 v[88:91], v[40:43], v[204:207], v[88:91]
  v_mfma_f32_16x16x32_bf16 v[92:95], v[44:47], v[204:207], v[92:95]
  v_mfma_f32_16x16x32_bf16 v[96:99], v[48:51], v[204:207], v[96:99]
  v_mfma_f32_16x16x32_bf16 v[100:103], v[52:55], v[204:207], v[100:103]
  s_nop 7
  s_barrier
  s_lshr_b32 s61, s3, 1
  s_cmp_eq_u32 s61, 1
  s_cbranch_scc1 L_p_xk1_61
  ds_write_b128 v254, v[84:87] offset:0
  ds_write_b128 v254, v[88:91] offset:1024
  ds_write_b128 v254, v[92:95] offset:2048
  ds_write_b128 v254, v[96:99] offset:3072
  ds_write_b128 v254, v[100:103] offset:4096
  s_branch L_p_xdone_62
L_p_xk1_61:
  ds_write_b128 v254, v[64:67] offset:0
  ds_write_b128 v254, v[68:71] offset:1024
  ds_write_b128 v254, v[72:75] offset:2048
  ds_write_b128 v254, v[76:79] offset:3072
  ds_write_b128 v254, v[80:83] offset:4096
L_p_xdone_62:
  s_waitcnt lgkmcnt(0)
  s_barrier
  ds_read_b128 v[16:19], v253 offset:0
  ds_read_b128 v[20:23], v253 offset:1024
  ds_read_b128 v[24:27], v253 offset:2048
  ds_read_b128 v[28:31], v253 offset:3072
  ds_read_b128 v[32:35], v253 offset:4096
  s_cbranch_scc1 L_p_xk1b_63
  s_waitcnt lgkmcnt(4)
  v_pk_add_f32 v[64:65], v[64:65], v[16:17]
  v_pk_add_f32 v[66:67], v[66:67], v[18:19]
  s_waitcnt lgkmcnt(3)
  v_pk_add_f32 v[68:69], v[68:69], v[20:21]
  v_pk_add_f32 v[70:71], v[70:71], v[22:23]
  s_waitcnt lgkmcnt(2)
  v_pk_add_f32 v[72:73], v[72:73], v[24:25]
  v_pk_add_f32 v[74:75], v[74:75], v[26:27]
  s_waitcnt lgkmcnt(1)
  v_pk_add_f32 v[76:77], v[76:77], v[28:29]
  v_pk_add_f32 v[78:79], v[78:79], v[30:31]
  s_waitcnt lgkmcnt(0)
  v_pk_add_f32 v[80:81], v[80:81], v[32:33]
  v_pk_add_f32 v[82:83], v[82:83], v[34:35]
  s_branch L_p_xdoneb_64
L_p_xk1b_63:
  s_waitcnt lgkmcnt(4)
  v_pk_add_f32 v[64:65], v[84:85], v[16:17]
  v_pk_add_f32 v[66:67], v[86:87], v[18:19]
  s_waitcnt lgkmcnt(3)
  v_pk_add_f32 v[68:69], v[88:89], v[20:21]
  v_pk_add_f32 v[70:71], v[90:91], v[22:23]
  s_waitcnt lgkmcnt(2)
  v_pk_add_f32 v[72:73], v[92:93], v[24:25]
  v_pk_add_f32 v[74:75], v[94:95], v[26:27]
  s_waitcnt lgkmcnt(1)
  v_pk_add_f32 v[76:77], v[96:97], v[28:29]
  v_pk_add_f32 v[78:79], v[98:99], v[30:31]
  s_waitcnt lgkmcnt(0)
  v_pk_add_f32 v[80:81], v[100:101], v[32:33]
  v_pk_add_f32 v[82:83], v[102:103], v[34:35]
L_p_xdoneb_64:
  v_lshlrev_b32 v36, 16, v104
  v_and_b32 v37, 0xffff0000, v104
  v_lshlrev_b32 v38, 16, v105
  v_and_b32 v39, 0xffff0000, v105
  v_lshlrev_b32 v40, 16, v106
  v_and_b32 v41, 0xffff0000, v106
  v_lshlrev_b32 v42, 16, v107
  v_and_b32 v43, 0xffff0000, v107
  v_lshlrev_b32 v44, 16, v108
  v_and_b32 v45, 0xffff0000, v108
  v_lshlrev_b32 v46, 16, v109
  v_and_b32 v47, 0xffff0000, v109
  v_lshlrev_b32 v48, 16, v110
  v_and_b32 v49, 0xffff0000, v110
  v_lshlrev_b32 v50, 16, v111
  v_and_b32 v51, 0xffff0000, v111
  v_lshlrev_b32 v52, 16, v112
  v_and_b32 v53, 0xffff0000, v112
  v_lshlrev_b32 v54, 16, v113
  v_and_b32 v55, 0xffff0000, v113
  v_pk_fma_f32 v[64:65], v[64:65], v[208:209], v[36:37]
  v_pk_fma_f32 v[66:67], v[66:67], v[210:211], v[38:39]
  v_pk_fma_f32 v[68:69], v[68:69], v[212:213], v[40:41]
  v_pk_fma_f32 v[70:71], v[70:71], v[214:215], v[42:43]
  v_pk_fma_f32 v[72:73], v[72:73], v[216:217], v[44:45]
  v_pk_fma_f32 v[74:75], v[74:75], v[218:219], v[46:47]
  v_pk_fma_f32 v[76:77], v[76:77], v[220:221], v[48:49]
  v_pk_fma_f32 v[78:79], v[78:79], v[222:223], v[50:51]
  v_pk_fma_f32 v[80:81], v[80:81], v[224:225], v[52:53]
  v_pk_fma_f32 v[82:83], v[82:83], v[226:227], v[54:55]
  v_cvt_pk_bf16_f32 v240, v64, v65
  v_cvt_pk_bf16_f32 v241, v66, v67
  v_cvt_pk_bf16_f32 v242, v68, v69
  v_cvt_pk_bf16_f32 v243, v70, v71
  v_cvt_pk_bf16_f32 v244, v72, v73
  v_cvt_pk_bf16_f32 v245, v74, v75
  v_cvt_pk_bf16_f32 v246, v76, v77
  v_cvt_pk_bf16_f32 v247, v78, v79
  v_cvt_pk_bf16_f32 v248, v80, v81
  v_cvt_pk_bf16_f32 v249, v82, v83
  v_lshlrev_b32 v36, 16, v240
  v_and_b32 v37, 0xffff0000, v240
  v_lshlrev_b32 v38, 16, v241
  v_and_b32 v39, 0xffff0000, v241
  v_lshlrev_b32 v40, 16, v242
  v_and_b32 v41, 0xffff0000, v242
  v_lshlrev_b32 v42, 16, v243
  v_and_b32 v43, 0xffff0000, v243
  v_lshlrev_b32 v44, 16, v244
  v_and_b32 v45, 0xffff0000, v244
  v_lshlrev_b32 v46, 16, v245
  v_and_b32 v47, 0xffff0000, v245
  v_lshlrev_b32 v48, 16, v246
  v_and_b32 v49, 0xffff0000, v246
  v_lshlrev_b32 v50, 16, v247
  v_and_b32 v51, 0xffff0000, v247
  v_lshlrev_b32 v52, 16, v248
  v_and_b32 v53, 0xffff0000, v248
  v_lshlrev_b32 v54, 16, v249
  v_and_b32 v55, 0xffff0000, v249
  v_pk_mul_f32 v[64:65], v[36:37], v[228:229]
  v_pk_mul_f32 v[66:67], v[38:39], v[230:231]
  v_pk_mul_f32 v[68:69], v[40:41], v[232:233]
  v_pk_mul_f32 v[70:71], v[42:43], v[234:235]
  v_pk_mul_f32 v[72:73], v[44:45], v[236:237]
  v_pk_mul_f32 v[74:75], v[46:47], v[238:239]
  v_pk_mul_f32 v[76:77], v[48:49], v[114:115]
  v_pk_mul_f32 v[78:79], v[50:51], v[116:117]
  v_pk_mul_f32 v[80:81], v[52:53], v[118:119]
  v_pk_mul_f32 v[82:83], v[54:55], v[120:121]
  v_cvt_pk_bf16_f32 v104, v64, v65
  v_cvt_pk_bf16_f32 v105, v66, v67
  v_cvt_pk_bf16_f32 v106, v68, v69
  v_cvt_pk_bf16_f32 v107, v70, v71
  v_cvt_pk_bf16_f32 v108, v72, v73
  v_cvt_pk_bf16_f32 v109, v74, v75
  v_cvt_pk_bf16_f32 v110, v76, v77
  v_cvt_pk_bf16_f32 v111, v78, v79
  v_cvt_pk_bf16_f32 v112, v80, v81
  v_cvt_pk_bf16_f32 v113, v82, v83
  s_nop 0
  v_permlane16_swap_b32 v104, v106
  v_permlane16_swap_b32 v105, v107
  v_permlane16_swap_b32 v108, v110
  v_permlane16_swap_b32 v109, v111
  s_mov_b32 s59, 0
  buffer_store_dwordx4 v[104:107], v57, s[20:23], s59 offen sc1
  buffer_store_dwordx4 v[108:111], v57, s[20:23], s59 offen offset:2048 sc1
  s_movk_i32 s59, 4096
  buffer_store_dwordx2 v[112:113], v14, s[20:23], s59 offen sc1
  v_pk_add_f32 v[16:17], v[36:37], v[38:39]
  v_pk_mul_f32 v[18:19], v[36:37], v[36:37]
  v_pk_fma_f32 v[18:19], v[38:39], v[38:39], v[18:19]
  v_pk_add_f32 v[16:17], v[16:17], v[40:41]
  v_pk_fma_f32 v[18:19], v[40:41], v[40:41], v[18:19]
  v_pk_add_f32 v[16:17], v[16:17], v[42:43]
  v_pk_fma_f32 v[18:19], v[42:43], v[42:43], v[18:19]
  v_pk_add_f32 v[16:17], v[16:17], v[44:45]
  v_pk_fma_f32 v[18:19], v[44:45], v[44:45], v[18:19]
  v_pk_add_f32 v[16:17], v[16:17], v[46:47]
  v_pk_fma_f32 v[18:19], v[46:47], v[46:47], v[18:19]
  v_pk_add_f32 v[16:17], v[16:17], v[48:49]
  v_pk_fma_f32 v[18:19], v[48:49], v[48:49], v[18:19]
  v_pk_add_f32 v[16:17], v[16:17], v[50:51]
  v_pk_fma_f32 v[18:19], v[50:51], v[50:51], v[18:19]
  v_pk_add_f32 v[16:17], v[16:17], v[52:53]
  v_pk_fma_f32 v[18:19], v[52:53], v[52:53], v[18:19]
  v_pk_add_f32 v[16:17], v[16:17], v[54:55]
  v_pk_fma_f32 v[18:19], v[54:55], v[54:55], v[18:19]
  v_add_f32 v16, v16, v17
  v_add_f32 v17, v18, v19
  v_mov_b32 v18, v16
  v_mov_b32 v19, v17
  s_nop 1
  v_permlane16_swap_b32 v16, v18
  v_permlane16_swap_b32 v17, v19
  s_nop 1
  v_add_f32 v16, v16, v18
  v_add_f32 v17, v17, v19
  v_mov_b32 v18, v16
  v_mov_b32 v19, v17
  s_nop 1
  v_permlane32_swap_b32 v16, v18
  v_permlane32_swap_b32 v17, v19
  s_nop 1
  v_add_f32 v16, v16, v18
  v_add_f32 v17, v17, v19
  v_lshlrev_b32 v18, 6, v11
  s_lshl_b32 s59, s38, 3
  s_mov_b64 exec, 0xffff
  buffer_store_dwordx2 v[16:17], v18, s[40:43], s59 offen sc1
  s_mov_b64 exec, -1
  s_waitcnt vmcnt(0)
  v_mov_b32 v12, 161808
  v_mov_b32 v13, 1
  s_mov_b64 exec, 1
  ds_add_u32 v12, v13
  s_mov_b64 exec, -1
  s_cmp_lg_u32 s3, 0
  s_cbranch_scc1 L_p_nosig_65
  v_mov_b32 v12, 161808
  s_mov_b32 s63, 320000
L_p_lw_67:
  ds_read_b32 v14, v12
  s_waitcnt lgkmcnt(0)
  v_readfirstlane_b32 s60, v14
  s_cmp_ge_u32 s60, 4
  s_cbranch_scc1 L_p_lwd_68
  s_sub_u32 s63, s63, 1
  s_cmp_lg_u32 s63, 0
  s_cbranch_scc1 L_p_lw_67
L_p_lwd_68:
  s_lshl_b32 s60, s30, 7
  s_add_u32 s60, s60, 34816
  v_mov_b32 v12, s60
  v_mov_b32 v13, 1
  s_mov_b64 exec, 1
  buffer_atomic_add v13, v12, s[16:19], 0 offen sc1
  s_mov_b64 exec, 1
  s_mov_b32 s63, 40000
L_p_poll_69:
  buffer_load_dword v14, v12, s[16:19], 0 offen sc1
  s_waitcnt vmcnt(0)
  v_cmp_le_u32 vcc, 16, v14
  s_nop 1
  s_cmp_eq_u64 vcc, exec
  s_cbranch_scc1 L_p_polled_70
  s_sub_u32 s63, s63, 1
  s_cmp_lg_u32 s63, 0
  s_cbranch_scc1 L_p_poll_69
L_p_polled_70:
  s_mov_b64 exec, -1
  v_mov_b32 v12, 161812
  v_mov_b32 v13, 1
  s_mov_b64 exec, 1
  ds_write_b32 v12, v13
  s_mov_b64 exec, -1
  s_branch L_p_hj_66
L_p_nosig_65:
  v_mov_b32 v12, 161812
  s_mov_b32 s63, 320000
L_p_lw_71:
  ds_read_b32 v14, v12
  s_waitcnt lgkmcnt(0)
  v_readfirstlane_b32 s60, v14
  s_cmp_ge_u32 s60, 1
  s_cbranch_scc1 L_p_lwd_72
  s_sub_u32 s63, s63, 1
  s_cmp_lg_u32 s63, 0
  s_cbranch_scc1 L_p_lw_71
L_p_lwd_72:
L_p_hj_66:
  s_add_u32 s8, s4, 0x17f4000
  s_addc_u32 s9, s5, 0
  s_and_b32 s9, s9, 0xffff
  s_mov_b32 s10, 0x280000
  s_mov_b32 s11, 0x20000
  s_add_u32 s24, s4, 0x1a74000
  s_addc_u32 s25, s5, 0
  s_and_b32 s25, s25, 0xffff
  s_mov_b32 s26, 0x20000
  s_mov_b32 s27, 0x20000
  s_add_u32 s40, s4, 0x1a94000
  s_addc_u32 s41, s5, 0
  s_and_b32 s41, s41, 0xffff
  s_mov_b32 s42, 0x600000
  s_mov_b32 s43, 0x20000
  s_mul_i32 s33, s32, 40*1024
  v_and_b32 v8, 31, v2
  s_lshl_b32 s59, s32, 5
  v_add_u32 v8, s59, v8
  v_lshlrev_b32 v9, 6, v8
  s_mov_b32 s39, s33
  s_mov_b32 s35, s39
  s_add_u32 s39, s39, 4096
  buffer_load_dwordx4 v[160:163], v3, s[8:11], s35 offen offset:0 sc1
  buffer_load_dwordx4 v[164:167], v3, s[8:11], s35 offen offset:1024 sc1
  buffer_load_dwordx4 v[168:171], v3, s[8:11], s35 offen offset:2048 sc1
  buffer_load_dwordx4 v[172:175], v3, s[8:11], s35 offen offset:3072 sc1
  s_mov_b32 s36, s39
  s_add_u32 s39, s39, 4096
  buffer_load_dwordx4 v[176:179], v3, s[8:11], s36 offen offset:0 sc1
  buffer_load_dwordx4 v[180:183], v3, s[8:11], s36 offen offset:1024 sc1
  buffer_load_dwordx4 v[184:187], v3, s[8:11], s36 offen offset:2048 sc1
  buffer_load_dwordx4 v[188:191], v3, s[8:11], s36 offen offset:3072 sc1
  s_mov_b32 s35, s39
  s_add_u32 s39, s39, 4096
  buffer_load_dwordx4 v[192:195], v3, s[8:11], s35 offen offset:0 sc1
  buffer_load_dwordx4 v[196:199], v3, s[8:11], s35 offen offset:1024 sc1
  buffer_load_dwordx4 v[200:203], v3, s[8:11], s35 offen offset:2048 sc1
  buffer_load_dwordx4 v[204:207], v3, s[8:11], s35 offen offset:3072 sc1
  s_barrier
  ds_read_b128 v[16:19], v3 offset:0
  ds_read_b128 v[20:23], v3 offset:1024
  ds_read_b128 v[24:27], v3 offset:2048
  ds_read_b128 v[28:31], v3 offset:3072
  ds_read_b128 v[32:35], v3 offset:4096
  ds_read_b128 v[36:39], v3 offset:5120
  s_waitcnt lgkmcnt(0)
  s_waitcnt vmcnt(11)
  v_mfma_f32_32x32x16_bf16 v[64:79], v[16:19], v[160:163], 0
  ds_read_b128 v[40:43], v3 offset:6144
  ds_read_b128 v[44:47], v3 offset:7168
  v_mfma_f32_32x32x16_bf16 v[80:95], v[20:23], v[160:163], 0
  ds_read_b128 v[48:51], v3 offset:8192
  ds_read_b128 v[52:55], v3 offset:9216
  v_mfma_f32_32x32x16_bf16 v[96:111], v[24:27], v[160:163], 0
  ds_read_b128 v[56:59], v3 offset:10240
  ds_read_b128 v[60:63], v3 offset:11264
  s_mov_b32 s36, s39
  s_add_u32 s39, s39, 4096
  buffer_load_dwordx4 v[208:211], v3, s[8:11], s36 offen offset:0 sc1
  v_mfma_f32_32x32x16_bf16 v[112:127], v[28:31], v[160:163], 0
  v_mfma_f32_32x32x16_bf16 v[128:143], v[32:35], v[160:163], 0
  v_mfma_f32_32x32x16_bf16 v[144:159], v[36:39], v[160:163], 0
  s_waitcnt lgkmcnt(0)
  s_waitcnt vmcnt(11)
  v_mfma_f32_32x32x16_bf16 v[64:79], v[40:43], v[164:167], v[64:79]
  ds_read_b128 v[16:19], v3 offset:12288
  ds_read_b128 v[20:23], v3 offset:13312
  v_mfma_f32_32x32x16_bf16 v[80:95], v[44:47], v[164:167], v[80:95]
  ds_read_b128 v[24:27], v3 offset:14336
  ds_read_b128 v[28:31], v3 offset:15360
  v_mfma_f32_32x32x16_bf16 v[96:111], v[48:51], v[164:167], v[96:111]
  ds_read_b128 v[32:35], v3 offset:16384
  ds_read_b128 v[36:39], v3 offset:17408
  buffer_load_dwordx4 v[212:215], v3, s[8:11], s36 offen offset:1024 sc1
  v_mfma_f32_32x32x16_bf16 v[112:127], v[52:55], v[164:167], v[112:127]
  v_mfma_f32_32x32x16_bf16 v[128:143], v[56:59], v[164:167], v[128:143]
  v_mfma_f32_32x32x16_bf16 v[144:159], v[60:63], v[164:167], v[144:159]
  s_waitcnt lgkmcnt(0)
  s_waitcnt vmcnt(11)
  v_mfma_f32_32x32x16_bf16 v[64:79], v[16:19], v[168:171], v[64:79]
  ds_read_b128 v[40:43], v3 offset:18432
  ds_read_b128 v[44:47], v3 offset:19456
  v_mfma_f32_32x32x16_bf16 v[80:95], v[20:23], v[168:171], v[80:95]
  ds_read_b128 v[48:51], v3 offset:20480
  ds_read_b128 v[52:55], v3 offset:21504
  v_mfma_f32_32x32x16_bf16 v[96:111], v[24:27], v[168:171], v[96:111]
  ds_read_b128 v[56:59], v3 offset:22528
  ds_read_b128 v[60:63], v3 offset:23552
  buffer_load_dwordx4 v[216:219], v3, s[8:11], s36 offen offset:2048 sc1
  v_mfma_f32_32x32x16_bf16 v[112:127], v[28:31], v[168:171], v[112:127]
  v_mfma_f32_32x32x16_bf16 v[128:143], v[32:35], v[168:171], v[128:143]
  v_mfma_f32_32x32x16_bf16 v[144:159], v[36:39], v[168:171], v[144:159]
  s_waitcnt lgkmcnt(0)
  s_waitcnt vmcnt(11)
  v_mfma_f32_32x32x16_bf16 v[64:79], v[40:43], v[172:175], v[64:79]
  ds_read_b128 v[16:19], v3 offset:24576
  ds_read_b128 v[20:23], v3 offset:25600
  v_mfma_f32_32x32x16_bf16 v[80:95], v[44:47], v[172:175], v[80:95]
  ds_read_b128 v[24:27], v3 offset:26624
  ds_read_b128 v[28:31], v3 offset:27648
  v_mfma_f32_32x32x16_bf16 v[96:111], v[48:51], v[172:175], v[96:111]
  ds_read_b128 v[32:35], v3 offset:28672
  ds_read_b128 v[36:39], v3 offset:29696
  buffer_load_dwordx4 v[220:223], v3, s[8:11], s36 offen offset:3072 sc1
  v_mfma_f32_32x32x16_bf16 v[112:127], v[52:55], v[172:175], v[112:127]
  v_mfma_f32_32x32x16_bf16 v[128:143], v[56:59], v[172:175], v[128:143]
  v_mfma_f32_32x32x16_bf16 v[144:159], v[60:63], v[172:175], v[144:159]
  s_waitcnt lgkmcnt(0)
  s_waitcnt vmcnt(11)
  v_mfma_f32_32x32x16_bf16 v[64:79], v[16:19], v[176:179], v[64:79]
  ds_read_b128 v[40:43], v3 offset:30720
  ds_read_b128 v[44:47], v3 offset:31744
  v_mfma_f32_32x32x16_bf16 v[80:95], v[20:23], v[176:179], v[80:95]
  ds_read_b128 v[48:51], v3 offset:32768
  ds_read_b128 v[52:55], v3 offset:33792
  v_mfma_f32_32x32x16_bf16 v[96:111], v[24:27], v[176:179], v[96:111]
  ds_read_b128 v[56:59], v3 offset:34816
  ds_read_b128 v[60:63], v3 offset:35840
  s_mov_b32 s35, s39
  s_add_u32 s39, s39, 4096
  buffer_load_dwordx4 v[160:163], v3, s[8:11], s35 offen offset:0 sc1
  v_mfma_f32_32x32x16_bf16 v[112:127], v[28:31], v[176:179], v[112:127]
  v_mfma_f32_32x32x16_bf16 v[128:143], v[32:35], v[176:179], v[128:143]
  v_mfma_f32_32x32x16_bf16 v[144:159], v[36:39], v[176:179], v[144:159]
  s_waitcnt lgkmcnt(0)
  s_waitcnt vmcnt(11)
  v_mfma_f32_32x32x16_bf16 v[64:79], v[40:43], v[180:183], v[64:79]
  ds_read_b128 v[16:19], v3 offset:36864
  ds_read_b128 v[20:23], v3 offset:37888
  v_mfma_f32_32x32x16_bf16 v[80:95], v[44:47], v[180:183], v[80:95]
  ds_read_b128 v[24:27], v3 offset:38912
  ds_read_b128 v[28:31], v3 offset:39936
  v_mfma_f32_32x32x16_bf16 v[96:111], v[48:51], v[180:183], v[96:111]
  ds_read_b128 v[32:35], v3 offset:40960
  ds_read_b128 v[36:39], v3 offset:41984
  buffer_load_dwordx4 v[164:167], v3, s[8:11], s35 offen offset:1024 sc1
  v_mfma_f32_32x32x16_bf16 v[112:127], v[52:55], v[180:183], v[112:127]
  v_mfma_f32_32x32x16_bf16 v[128:143], v[56:59], v[180:183], v[128:143]
  v_mfma_f32_32x32x16_bf16 v[144:159], v[60:63], v[180:183], v[144:159]
  s_waitcnt lgkmcnt(0)
  s_waitcnt vmcnt(11)
  v_mfma_f32_32x32x16_bf16 v[64:79], v[16:19], v[184:187], v[64:79]
  ds_read_b128 v[40:43], v3 offset:43008
  ds_read_b128 v[44:47], v3 offset:44032
  v_mfma_f32_32x32x16_bf16 v[80:95], v[20:23], v[184:187], v[80:95]
  ds_read_b128 v[48:51], v3 offset:45056
  ds_read_b128 v[52:55], v3 offset:46080
  v_mfma_f32_32x32x16_bf16 v[96:111], v[24:27], v[184:187], v[96:111]
  ds_read_b128 v[56:59], v3 offset:47104
  ds_read_b128 v[60:63], v3 offset:48128
  buffer_load_dwordx4 v[168:171], v3, s[8:11], s35 offen offset:2048 sc1
  v_mfma_f32_32x32x16_bf16 v[112:127], v[28:31], v[184:187], v[112:127]
  v_mfma_f32_32x32x16_bf16 v[128:143], v[32:35], v[184:187], v[128:143]
  v_mfma_f32_32x32x16_bf16 v[144:159], v[36:39], v[184:187], v[144:159]
  s_waitcnt lgkmcnt(0)
  s_barrier
  s_waitcnt vmcnt(11)
  v_mfma_f32_32x32x16_bf16 v[64:79], v[40:43], v[188:191], v[64:79]
  ds_read_b128 v[16:19], v3 offset:49152
  ds_read_b128 v[20:23], v3 offset:50176
  v_mfma_f32_32x32x16_bf16 v[80:95], v[44:47], v[188:191], v[80:95]
  ds_read_b128 v[24:27], v3 offset:51200
  ds_read_b128 v[28:31], v3 offset:52224
  v_mfma_f32_32x32x16_bf16 v[96:111], v[48:51], v[188:191], v[96:111]
  ds_read_b128 v[32:35], v3 offset:53248
  ds_read_b128 v[36:39], v3 offset:54272
  buffer_load_dwordx4 v[172:175], v3, s[8:11], s35 offen offset:3072 sc1
  v_mfma_f32_32x32x16_bf16 v[112:127], v[52:55], v[188:191], v[112:127]
  v_mfma_f32_32x32x16_bf16 v[128:143], v[56:59], v[188:191], v[128:143]
  v_mfma_f32_32x32x16_bf16 v[144:159], v[60:63], v[188:191], v[144:159]
  s_waitcnt lgkmcnt(0)
  s_waitcnt vmcnt(11)
  v_mfma_f32_32x32x16_bf16 v[64:79], v[16:19], v[192:195], v[64:79]
  ds_read_b128 v[40:43], v3 offset:55296
  ds_read_b128 v[44:47], v3 offset:56320
  v_mfma_f32_32x32x16_bf16 v[80:95], v[20:23], v[192:195], v[80:95]
  ds_read_b128 v[48:51], v3 offset:57344
  ds_read_b128 v[52:55], v3 offset:58368
  v_mfma_f32_32x32x16_bf16 v[96:111], v[24:27], v[192:195], v[96:111]
  ds_read_b128 v[56:59], v3 offset:59392
  ds_read_b128 v[60:63], v3 offset:60416
  s_mov_b32 s36, s39
  s_add_u32 s39, s39, 4096
  buffer_load_dwordx4 v[176:179], v3, s[8:11], s36 offen offset:0 sc1
  v_mfma_f32_32x32x16_bf16 v[112:127], v[28:31], v[192:195], v[112:127]
  v_mfma_f32_32x32x16_bf16 v[128:143], v[32:35], v[192:195], v[128:143]
  v_mfma_f32_32x32x16_bf16 v[144:159], v[36:39], v[192:195], v[144:159]
  s_waitcnt lgkmcnt(0)
  s_waitcnt vmcnt(11)
  v_mfma_f32_32x32x16_bf16 v[64:79], v[40:43], v[196:199], v[64:79]
  ds_read_b128 v[16:19], v3 offset:61440
  ds_read_b128 v[20:23], v3 offset:62464
  v_mfma_f32_32x32x16_bf16 v[80:95], v[44:47], v[196:199], v[80:95]
  ds_read_b128 v[24:27], v3 offset:63488
  ds_read_b128 v[28:31], v3 offset:64512
  v_mfma_f32_32x32x16_bf16 v[96:111], v[48:51], v[196:199], v[96:111]
  ds_read_b128 v[32:35], v4 offset:0
  ds_read_b128 v[36:39], v4 offset:1024
  buffer_load_dwordx4 v[180:183], v3, s[8:11], s36 offen offset:1024 sc1
  v_mfma_f32_32x32x16_bf16 v[112:127], v[52:55], v[196:199], v[112:127]
  v_mfma_f32_32x32x16_bf16 v[128:143], v[56:59], v[196:199], v[128:143]
  v_mfma_f32_32x32x16_bf16 v[144:159], v[60:63], v[196:199], v[144:159]
  s_waitcnt lgkmcnt(0)
  s_waitcnt vmcnt(11)
  v_mfma_f32_32x32x16_bf16 v[64:79], v[16:19], v[200:203], v[64:79]
  ds_read_b128 v[40:43], v4 offset:2048
  ds_read_b128 v[44:47], v4 offset:3072
  v_mfma_f32_32x32x16_bf16 v[80:95], v[20:23], v[200:203], v[80:95]
  ds_read_b128 v[48:51], v4 offset:4096
  ds_read_b128 v[52:55], v4 offset:5120
  v_mfma_f32_32x32x16_bf16 v[96:111], v[24:27], v[200:203], v[96:111]
  ds_read_b128 v[56:59], v4 offset:6144
  ds_read_b128 v[60:63], v4 offset:7168
  buffer_load_dwordx4 v[184:187], v3, s[8:11], s36 offen offset:2048 sc1
  v_mfma_f32_32x32x16_bf16 v[112:127], v[28:31], v[200:203], v[112:127]
  v_mfma_f32_32x32x16_bf16 v[128:143], v[32:35], v[200:203], v[128:143]
  v_mfma_f32_32x32x16_bf16 v[144:159], v[36:39], v[200:203], v[144:159]
  s_waitcnt lgkmcnt(0)
  s_waitcnt vmcnt(11)
  v_mfma_f32_32x32x16_bf16 v[64:79], v[40:43], v[204:207], v[64:79]
  ds_read_b128 v[16:19], v4 offset:8192
  ds_read_b128 v[20:23], v4 offset:9216
  v_mfma_f32_32x32x16_bf16 v[80:95], v[44:47], v[204:207], v[80:95]
  ds_read_b128 v[24:27], v4 offset:10240
  ds_read_b128 v[28:31], v4 offset:11264
  v_mfma_f32_32x32x16_bf16 v[96:111], v[48:51], v[204:207], v[96:111]
  ds_read_b128 v[32:35], v4 offset:12288
  ds_read_b128 v[36:39], v4 offset:13312
  buffer_load_dwordx4 v[188:191], v3, s[8:11], s36 offen offset:3072 sc1
  v_mfma_f32_32x32x16_bf16 v[112:127], v[52:55], v[204:207], v[112:127]
  v_mfma_f32_32x32x16_bf16 v[128:143], v[56:59], v[204:207], v[128:143]
  v_mfma_f32_32x32x16_bf16 v[144:159], v[60:63], v[204:207], v[144:159]
  s_waitcnt lgkmcnt(0)
  s_waitcnt vmcnt(11)
  v_mfma_f32_32x32x16_bf16 v[64:79], v[16:19], v[208:211], v[64:79]
  ds_read_b128 v[40:43], v4 offset:14336
  ds_read_b128 v[44:47], v4 offset:15360
  v_mfma_f32_32x32x16_bf16 v[80:95], v[20:23], v[208:211], v[80:95]
  ds_read_b128 v[48:51], v4 offset:16384
  ds_read_b128 v[52:55], v4 offset:17408
  v_mfma_f32_32x32x16_bf16 v[96:111], v[24:27], v[208:211], v[96:111]
  ds_read_b128 v[56:59], v4 offset:18432
  ds_read_b128 v[60:63], v4 offset:19456
  s_mov_b32 s35, s39
  s_add_u32 s39, s39, 4096
  buffer_load_dwordx4 v[192:195], v3, s[8:11], s35 offen offset:0 sc1
  v_mfma_f32_32x32x16_bf16 v[112:127], v[28:31], v[208:211], v[112:127]
  v_mfma_f32_32x32x16_bf16 v[128:143], v[32:35], v[208:211], v[128:143]
  v_mfma_f32_32x32x16_bf16 v[144:159], v[36:39], v[208:211], v[144:159]
  s_waitcnt lgkmcnt(0)
  s_waitcnt vmcnt(11)
  v_mfma_f32_32x32x16_bf16 v[64:79], v[40:43], v[212:215], v[64:79]
  ds_read_b128 v[16:19], v4 offset:20480
  ds_read_b128 v[20:23], v4 offset:21504
  v_mfma_f32_32x32x16_bf16 v[80:95], v[44:47], v[212:215], v[80:95]
  ds_read_b128 v[24:27], v4 offset:22528
  ds_read_b128 v[28:31], v4 offset:23552
  v_mfma_f32_32x32x16_bf16 v[96:111], v[48:51], v[212:215], v[96:111]
  ds_read_b128 v[32:35], v4 offset:24576
  ds_read_b128 v[36:39], v4 offset:25600
  buffer_load_dwordx4 v[196:199], v3, s[8:11], s35 offen offset:1024 sc1
  v_mfma_f32_32x32x16_bf16 v[112:127], v[52:55], v[212:215], v[112:127]
  v_mfma_f32_32x32x16_bf16 v[128:143], v[56:59], v[212:215], v[128:143]
  v_mfma_f32_32x32x16_bf16 v[144:159], v[60:63], v[212:215], v[144:159]
  s_waitcnt lgkmcnt(0)
  s_waitcnt vmcnt(11)
  v_mfma_f32_32x32x16_bf16 v[64:79], v[16:19], v[216:219], v[64:79]
  ds_read_b128 v[40:43], v4 offset:26624
  ds_read_b128 v[44:47], v4 offset:27648
  v_mfma_f32_32x32x16_bf16 v[80:95], v[20:23], v[216:219], v[80:95]
  ds_read_b128 v[48:51], v4 offset:28672
  ds_read_b128 v[52:55], v4 offset:29696
  v_mfma_f32_32x32x16_bf16 v[96:111], v[24:27], v[216:219], v[96:111]
  ds_read_b128 v[56:59], v4 offset:30720
  ds_read_b128 v[60:63], v4 offset:31744
  buffer_load_dwordx4 v[200:203], v3, s[8:11], s35 offen offset:2048 sc1
  v_mfma_f32_32x32x16_bf16 v[112:127], v[28:31], v[216:219], v[112:127]
  v_mfma_f32_32x32x16_bf16 v[128:143], v[32:35], v[216:219], v[128:143]
  v_mfma_f32_32x32x16_bf16 v[144:159], v[36:39], v[216:219], v[144:159]
  s_waitcnt lgkmcnt(0)
  s_barrier
  s_waitcnt vmcnt(11)
  v_mfma_f32_32x32x16_bf16 v[64:79], v[40:43], v[220:223], v[64:79]
  ds_read_b128 v[16:19], v4 offset:32768
  ds_read_b128 v[20:23], v4 offset:33792
  v_mfma_f32_32x32x16_bf16 v[80:95], v[44:47], v[220:223], v[80:95]
  ds_read_b128 v[24:27], v4 offset:34816
  ds_read_b128 v[28:31], v4 offset:35840
  v_mfma_f32_32x32x16_bf16 v[96:111], v[48:51], v[220:223], v[96:111]
  ds_read_b128 v[32:35], v4 offset:36864
  ds_read_b128 v[36:39], v4 offset:37888
  buffer_load_dwordx4 v[204:207], v3, s[8:11], s35 offen offset:3072 sc1
  v_mfma_f32_32x32x16_bf16 v[112:127], v[52:55], v[220:223], v[112:127]
  v_mfma_f32_32x32x16_bf16 v[128:143], v[56:59], v[220:223], v[128:143]
  v_mfma_f32_32x32x16_bf16 v[144:159], v[60:63], v[220:223], v[144:159]
  s_waitcnt lgkmcnt(0)
  s_waitcnt vmcnt(11)
  v_mfma_f32_32x32x16_bf16 v[64:79], v[16:19], v[160:163], v[64:79]
  ds_read_b128 v[40:43], v4 offset:38912
  ds_read_b128 v[44:47], v4 offset:39936
  v_mfma_f32_32x32x16_bf16 v[80:95], v[20:23], v[160:163], v[80:95]
  ds_read_b128 v[48:51], v4 offset:40960
  ds_read_b128 v[52:55], v4 offset:41984
  v_mfma_f32_32x32x16_bf16 v[96:111], v[24:27], v[160:163], v[96:111]
  ds_read_b128 v[56:59], v4 offset:43008
  ds_read_b128 v[60:63], v4 offset:44032
  s_mov_b32 s36, s39
  s_add_u32 s39, s39, 4096
  buffer_load_dwordx4 v[208:211], v3, s[8:11], s36 offen offset:0 sc1
  v_mfma_f32_32x32x16_bf16 v[112:127], v[28:31], v[160:163], v[112:127]
  v_mfma_f32_32x32x16_bf16 v[128:143], v[32:35], v[160:163], v[128:143]
  v_mfma_f32_32x32x16_bf16 v[144:159], v[36:39], v[160:163], v[144:159]
  s_waitcnt lgkmcnt(0)
  s_waitcnt vmcnt(11)
  v_mfma_f32_32x32x16_bf16 v[64:79], v[40:43], v[164:167], v[64:79]
  ds_read_b128 v[16:19], v4 offset:45056
  ds_read_b128 v[20:23], v4 offset:46080
  v_mfma_f32_32x32x16_bf16 v[80:95], v[44:47], v[164:167], v[80:95]
  ds_read_b128 v[24:27], v4 offset:47104
  ds_read_b128 v[28:31], v4 offset:48128
  v_mfma_f32_32x32x16_bf16 v[96:111], v[48:51], v[164:167], v[96:111]
  ds_read_b128 v[32:35], v4 offset:49152
  ds_read_b128 v[36:39], v4 offset:50176
  buffer_load_dwordx4 v[212:215], v3, s[8:11], s36 offen offset:1024 sc1
  v_mfma_f32_32x32x16_bf16 v[112:127], v[52:55], v[164:167], v[112:127]
  v_mfma_f32_32x32x16_bf16 v[128:143], v[56:59], v[164:167], v[128:143]
  v_mfma_f32_32x32x16_bf16 v[144:159], v[60:63], v[164:167], v[144:159]
  s_waitcnt lgkmcnt(0)
  s_waitcnt vmcnt(11)
  v_mfma_f32_32x32x16_bf16 v[64:79], v[16:19], v[168:171], v[64:79]
  ds_read_b128 v[40:43], v4 offset:51200
  ds_read_b128 v[44:47], v4 offset:52224
  v_mfma_f32_32x32x16_bf16 v[80:95], v[20:23], v[168:171], v[80:95]
  ds_read_b128 v[48:51], v4 offset:53248
  ds_read_b128 v[52:55], v4 offset:54272
  v_mfma_f32_32x32x16_bf16 v[96:111], v[24:27], v[168:171], v[96:111]
  ds_read_b128 v[56:59], v4 offset:55296
  ds_read_b128 v[60:63], v4 offset:56320
  buffer_load_dwordx4 v[216:219], v3, s[8:11], s36 offen offset:2048 sc1
  v_mfma_f32_32x32x16_bf16 v[112:127], v[28:31], v[168:171], v[112:127]
  v_mfma_f32_32x32x16_bf16 v[128:143], v[32:35], v[168:171], v[128:143]
  v_mfma_f32_32x32x16_bf16 v[144:159], v[36:39], v[168:171], v[144:159]
  s_waitcnt lgkmcnt(0)
  s_waitcnt vmcnt(11)
  v_mfma_f32_32x32x16_bf16 v[64:79], v[40:43], v[172:175], v[64:79]
  ds_read_b128 v[16:19], v4 offset:57344
  ds_read_b128 v[20:23], v4 offset:58368
  v_mfma_f32_32x32x16_bf16 v[80:95], v[44:47], v[172:175], v[80:95]
  ds_read_b128 v[24:27], v4 offset:59392
  ds_read_b128 v[28:31], v4 offset:60416
  v_mfma_f32_32x32x16_bf16 v[96:111], v[48:51], v[172:175], v[96:111]
  ds_read_b128 v[32:35], v4 offset:61440
  ds_read_b128 v[36:39], v4 offset:62464
  buffer_load_dwordx4 v[220:223], v3, s[8:11], s36 offen offset:3072 sc1
  v_mfma_f32_32x32x16_bf16 v[112:127], v[52:55], v[172:175], v[112:127]
  v_mfma_f32_32x32x16_bf16 v[128:143], v[56:59], v[172:175], v[128:143]
  v_mfma_f32_32x32x16_bf16 v[144:159], v[60:63], v[172:175], v[144:159]
  s_waitcnt lgkmcnt(0)
  s_waitcnt vmcnt(11)
  v_mfma_f32_32x32x16_bf16 v[64:79], v[16:19], v[176:179], v[64:79]
  ds_read_b128 v[40:43], v4 offset:63488
  ds_read_b128 v[44:47], v4 offset:64512
  v_mfma_f32_32x32x16_bf16 v[80:95], v[20:23], v[176:179], v[80:95]
  ds_read_b128 v[48:51], v5 offset:0
  ds_read_b128 v[52:55], v5 offset:1024
  v_mfma_f32_32x32x16_bf16 v[96:111], v[24:27], v[176:179], v[96:111]
  ds_read_b128 v[56:59], v5 offset:2048
  ds_read_b128 v[60:63], v5 offset:3072
  s_mov_b32 s35, s39
  s_add_u32 s39, s39, 4096
  buffer_load_dwordx4 v[160:163], v3, s[8:11], s35 offen offset:0 sc1
  v_mfma_f32_32x32x16_bf16 v[112:127], v[28:31], v[176:179], v[112:127]
  v_mfma_f32_32x32x16_bf16 v[128:143], v[32:35], v[176:179], v[128:143]
  v_mfma_f32_32x32x16_bf16 v[144:159], v[36:39], v[176:179], v[144:159]
  s_waitcnt lgkmcnt(0)
  s_waitcnt vmcnt(11)
  v_mfma_f32_32x32x16_bf16 v[64:79], v[40:43], v[180:183], v[64:79]
  ds_read_b128 v[16:19], v5 offset:4096
  ds_read_b128 v[20:23], v5 offset:5120
  v_mfma_f32_32x32x16_bf16 v[80:95], v[44:47], v[180:183], v[80:95]
  ds_read_b128 v[24:27], v5 offset:6144
  ds_read_b128 v[28:31], v5 offset:7168
  v_mfma_f32_32x32x16_bf16 v[96:111], v[48:51], v[180:183], v[96:111]
  ds_read_b128 v[32:35], v5 offset:8192
  ds_read_b128 v[36:39], v5 offset:9216
  buffer_load_dwordx4 v[164:167], v3, s[8:11], s35 offen offset:1024 sc1
  v_mfma_f32_32x32x16_bf16 v[112:127], v[52:55], v[180:183], v[112:127]
  v_mfma_f32_32x32x16_bf16 v[128:143], v[56:59], v[180:183], v[128:143]
  v_mfma_f32_32x32x16_bf16 v[144:159], v[60:63], v[180:183], v[144:159]
  s_waitcnt lgkmcnt(0)
  s_waitcnt vmcnt(11)
  v_mfma_f32_32x32x16_bf16 v[64:79], v[16:19], v[184:187], v[64:79]
  ds_read_b128 v[40:43], v5 offset:10240
  ds_read_b128 v[44:47], v5 offset:11264
  v_mfma_f32_32x32x16_bf16 v[80:95], v[20:23], v[184:187], v[80:95]
  ds_read_b128 v[48:51], v5 offset:12288
  ds_read_b128 v[52:55], v5 offset:13312
  v_mfma_f32_32x32x16_bf16 v[96:111], v[24:27], v[184:187], v[96:111]
  ds_read_b128 v[56:59], v5 offset:14336
  ds_read_b128 v[60:63], v5 offset:15360
  buffer_load_dwordx4 v[168:171], v3, s[8:11], s35 offen offset:2048 sc1
  v_mfma_f32_32x32x16_bf16 v[112:127], v[28:31], v[184:187], v[112:127]
  v_mfma_f32_32x32x16_bf16 v[128:143], v[32:35], v[184:187], v[128:143]
  v_mfma_f32_32x32x16_bf16 v[144:159], v[36:39], v[184:187], v[144:159]
  s_waitcnt lgkmcnt(0)
  s_barrier
  s_waitcnt vmcnt(11)
  v_mfma_f32_32x32x16_bf16 v[64:79], v[40:43], v[188:191], v[64:79]
  ds_read_b128 v[16:19], v3 offset:0
  ds_read_b128 v[20:23], v3 offset:1024
  v_mfma_f32_32x32x16_bf16 v[80:95], v[44:47], v[188:191], v[80:95]
  ds_read_b128 v[24:27], v3 offset:2048
  ds_read_b128 v[28:31], v3 offset:3072
  v_mfma_f32_32x32x16_bf16 v[96:111], v[48:51], v[188:191], v[96:111]
  ds_read_b128 v[32:35], v3 offset:4096
  ds_read_b128 v[36:39], v3 offset:5120
  buffer_load_dwordx4 v[172:175], v3, s[8:11], s35 offen offset:3072 sc1
  v_mfma_f32_32x32x16_bf16 v[112:127], v[52:55], v[188:191], v[112:127]
  v_mfma_f32_32x32x16_bf16 v[128:143], v[56:59], v[188:191], v[128:143]
  v_mfma_f32_32x32x16_bf16 v[144:159], v[60:63], v[188:191], v[144:159]
  s_waitcnt lgkmcnt(0)
  s_waitcnt vmcnt(11)
  v_mfma_f32_32x32x16_bf16 v[64:79], v[16:19], v[192:195], v[64:79]
  ds_read_b128 v[40:43], v3 offset:6144
  ds_read_b128 v[44:47], v3 offset:7168
  v_mfma_f32_32x32x16_bf16 v[80:95], v[20:23], v[192:195], v[80:95]
  ds_read_b128 v[48:51], v3 offset:8192
  ds_read_b128 v[52:55], v3 offset:9216
  v_mfma_f32_32x32x16_bf16 v[96:111], v[24:27], v[192:195], v[96:111]
  ds_read_b128 v[56:59], v3 offset:10240
  ds_read_b128 v[60:63], v3 offset:11264
  s_mov_b32 s36, s39
  s_add_u32 s39, s39, 4096
  buffer_load_dwordx4 v[176:179], v3, s[8:11], s36 offen offset:0 sc1
  v_mfma_f32_32x32x16_bf16 v[112:127], v[28:31], v[192:195], v[112:127]
  v_mfma_f32_32x32x16_bf16 v[128:143], v[32:35], v[192:195], v[128:143]
  v_mfma_f32_32x32x16_bf16 v[144:159], v[36:39], v[192:195], v[144:159]
  s_waitcnt lgkmcnt(0)
  s_waitcnt vmcnt(11)
  v_mfma_f32_32x32x16_bf16 v[64:79], v[40:43], v[196:199], v[64:79]
  ds_read_b128 v[16:19], v3 offset:12288
  ds_read_b128 v[20:23], v3 offset:13312
  v_mfma_f32_32x32x16_bf16 v[80:95], v[44:47], v[196:199], v[80:95]
  ds_read_b128 v[24:27], v3 offset:14336
  ds_read_b128 v[28:31], v3 offset:15360
  v_mfma_f32_32x32x16_bf16 v[96:111], v[48:51], v[196:199], v[96:111]
  ds_read_b128 v[32:35], v3 offset:16384
  ds_read_b128 v[36:39], v3 offset:17408
  buffer_load_dwordx4 v[180:183], v3, s[8:11], s36 offen offset:1024 sc1
  v_mfma_f32_32x32x16_bf16 v[112:127], v[52:55], v[196:199], v[112:127]
  v_mfma_f32_32x32x16_bf16 v[128:143], v[56:59], v[196:199], v[128:143]
  v_mfma_f32_32x32x16_bf16 v[144:159], v[60:63], v[196:199], v[144:159]
  s_waitcnt lgkmcnt(0)
  s_waitcnt vmcnt(11)
  v_mfma_f32_32x32x16_bf16 v[64:79], v[16:19], v[200:203], v[64:79]
  ds_read_b128 v[40:43], v3 offset:18432
  ds_read_b128 v[44:47], v3 offset:19456
  v_mfma_f32_32x32x16_bf16 v[80:95], v[20:23], v[200:203], v[80:95]
  ds_read_b128 v[48:51], v3 offset:20480
  ds_read_b128 v[52:55], v3 offset:21504
  v_mfma_f32_32x32x16_bf16 v[96:111], v[24:27], v[200:203], v[96:111]
  ds_read_b128 v[56:59], v3 offset:22528
  ds_read_b128 v[60:63], v3 offset:23552
  buffer_load_dwordx4 v[184:187], v3, s[8:11], s36 offen offset:2048 sc1
  v_mfma_f32_32x32x16_bf16 v[112:127], v[28:31], v[200:203], v[112:127]
  v_mfma_f32_32x32x16_bf16 v[128:143], v[32:35], v[200:203], v[128:143]
  v_mfma_f32_32x32x16_bf16 v[144:159], v[36:39], v[200:203], v[144:159]
  s_waitcnt lgkmcnt(0)
  s_waitcnt vmcnt(11)
  v_mfma_f32_32x32x16_bf16 v[64:79], v[40:43], v[204:207], v[64:79]
  ds_read_b128 v[16:19], v3 offset:24576
  ds_read_b128 v[20:23], v3 offset:25600
  v_mfma_f32_32x32x16_bf16 v[80:95], v[44:47], v[204:207], v[80:95]
  ds_read_b128 v[24:27], v3 offset:26624
  ds_read_b128 v[28:31], v3 offset:27648
  v_mfma_f32_32x32x16_bf16 v[96:111], v[48:51], v[204:207], v[96:111]
  ds_read_b128 v[32:35], v3 offset:28672
  ds_read_b128 v[36:39], v3 offset:29696
  buffer_load_dwordx4 v[188:191], v3, s[8:11], s36 offen offset:3072 sc1
  v_mfma_f32_32x32x16_bf16 v[112:127], v[52:55], v[204:207], v[112:127]
  v_mfma_f32_32x32x16_bf16 v[128:143], v[56:59], v[204:207], v[128:143]
  v_mfma_f32_32x32x16_bf16 v[144:159], v[60:63], v[204:207], v[144:159]
  s_waitcnt lgkmcnt(0)
  s_waitcnt vmcnt(11)
  v_mfma_f32_32x32x16_bf16 v[64:79], v[16:19], v[208:211], v[64:79]
  ds_read_b128 v[40:43], v3 offset:30720
  ds_read_b128 v[44:47], v3 offset:31744
  v_mfma_f32_32x32x16_bf16 v[80:95], v[20:23], v[208:211], v[80:95]
  ds_read_b128 v[48:51], v3 offset:32768
  ds_read_b128 v[52:55], v3 offset:33792
  v_mfma_f32_32x32x16_bf16 v[96:111], v[24:27], v[208:211], v[96:111]
  ds_read_b128 v[56:59], v3 offset:34816
  ds_read_b128 v[60:63], v3 offset:35840
  v_mfma_f32_32x32x16_bf16 v[112:127], v[28:31], v[208:211], v[112:127]
  v_mfma_f32_32x32x16_bf16 v[128:143], v[32:35], v[208:211], v[128:143]
  v_mfma_f32_32x32x16_bf16 v[144:159], v[36:39], v[208:211], v[144:159]
  s_waitcnt lgkmcnt(0)
  s_waitcnt vmcnt(10)
  v_mfma_f32_32x32x16_bf16 v[64:79], v[40:43], v[212:215], v[64:79]
  ds_read_b128 v[16:19], v3 offset:36864
  ds_read_b128 v[20:23], v3 offset:37888
  v_mfma_f32_32x32x16_bf16 v[80:95], v[44:47], v[212:215], v[80:95]
  ds_read_b128 v[24:27], v3 offset:38912
  ds_read_b128 v[28:31], v3 offset:39936
  v_mfma_f32_32x32x16_bf16 v[96:111], v[48:51], v[212:215], v[96:111]
  ds_read_b128 v[32:35], v3 offset:40960
  ds_read_b128 v[36:39], v3 offset:41984
  v_mfma_f32_32x32x16_bf16 v[112:127], v[52:55], v[212:215], v[112:127]
  v_mfma_f32_32x32x16_bf16 v[128:143], v[56:59], v[212:215], v[128:143]
  v_mfma_f32_32x32x16_bf16 v[144:159], v[60:63], v[212:215], v[144:159]
  s_waitcnt lgkmcnt(0)
  s_waitcnt vmcnt(9)
  v_mfma_f32_32x32x16_bf16 v[64:79], v[16:19], v[216:219], v[64:79]
  ds_read_b128 v[40:43], v3 offset:43008
  ds_read_b128 v[44:47], v3 offset:44032
  v_mfma_f32_32x32x16_bf16 v[80:95], v[20:23], v[216:219], v[80:95]
  ds_read_b128 v[48:51], v3 offset:45056
  ds_read_b128 v[52:55], v3 offset:46080
  v_mfma_f32_32x32x16_bf16 v[96:111], v[24:27], v[216:219], v[96:111]
  ds_read_b128 v[56:59], v3 offset:47104
  ds_read_b128 v[60:63], v3 offset:48128
  v_mfma_f32_32x32x16_bf16 v[112:127], v[28:31], v[216:219], v[112:127]
  v_mfma_f32_32x32x16_bf16 v[128:143], v[32:35], v[216:219], v[128:143]
  v_mfma_f32_32x32x16_bf16 v[144:159], v[36:39], v[216:219], v[144:159]
  s_waitcnt lgkmcnt(0)
  s_barrier
  s_waitcnt vmcnt(8)
  v_mfma_f32_32x32x16_bf16 v[64:79], v[40:43], v[220:223], v[64:79]
  ds_read_b128 v[16:19], v3 offset:49152
  ds_read_b128 v[20:23], v3 offset:50176
  v_mfma_f32_32x32x16_bf16 v[80:95], v[44:47], v[220:223], v[80:95]
  ds_read_b128 v[24:27], v3 offset:51200
  ds_read_b128 v[28:31], v3 offset:52224
  v_mfma_f32_32x32x16_bf16 v[96:111], v[48:51], v[220:223], v[96:111]
  ds_read_b128 v[32:35], v3 offset:53248
  ds_read_b128 v[36:39], v3 offset:54272
  v_mfma_f32_32x32x16_bf16 v[112:127], v[52:55], v[220:223], v[112:127]
  v_mfma_f32_32x32x16_bf16 v[128:143], v[56:59], v[220:223], v[128:143]
  v_mfma_f32_32x32x16_bf16 v[144:159], v[60:63], v[220:223], v[144:159]
  s_waitcnt lgkmcnt(0)
  s_waitcnt vmcnt(7)
  v_mfma_f32_32x32x16_bf16 v[64:79], v[16:19], v[160:163], v[64:79]
  ds_read_b128 v[40:43], v3 offset:55296
  ds_read_b128 v[44:47], v3 offset:56320
  v_mfma_f32_32x32x16_bf16 v[80:95], v[20:23], v[160:163], v[80:95]
  ds_read_b128 v[48:51], v3 offset:57344
  ds_read_b128 v[52:55], v3 offset:58368
  v_mfma_f32_32x32x16_bf16 v[96:111], v[24:27], v[160:163], v[96:111]
  ds_read_b128 v[56:59], v3 offset:59392
  ds_read_b128 v[60:63], v3 offset:60416
  v_mfma_f32_32x32x16_bf16 v[112:127], v[28:31], v[160:163], v[112:127]
  v_mfma_f32_32x32x16_bf16 v[128:143], v[32:35], v[160:163], v[128:143]
  v_mfma_f32_32x32x16_bf16 v[144:159], v[36:39], v[160:163], v[144:159]
  s_waitcnt lgkmcnt(0)
  s_waitcnt vmcnt(6)
  v_mfma_f32_32x32x16_bf16 v[64:79], v[40:43], v[164:167], v[64:79]
  ds_read_b128 v[16:19], v3 offset:61440
  ds_read_b128 v[20:23], v3 offset:62464
  v_mfma_f32_32x32x16_bf16 v[80:95], v[44:47], v[164:167], v[80:95]
  ds_read_b128 v[24:27], v3 offset:63488
  ds_read_b128 v[28:31], v3 offset:64512
  v_mfma_f32_32x32x16_bf16 v[96:111], v[48:51], v[164:167], v[96:111]
  ds_read_b128 v[32:35], v4 offset:0
  ds_read_b128 v[36:39], v4 offset:1024
  buffer_load_dwordx4 v[224:227], v9, s[24:27], 0 offen offset:0 sc1
  v_mfma_f32_32x32x16_bf16 v[112:127], v[52:55], v[164:167], v[112:127]
  v_mfma_f32_32x32x16_bf16 v[128:143], v[56:59], v[164:167], v[128:143]
  v_mfma_f32_32x32x16_bf16 v[144:159], v[60:63], v[164:167], v[144:159]
  s_waitcnt lgkmcnt(0)
  s_waitcnt vmcnt(6)
  v_mfma_f32_32x32x16_bf16 v[64:79], v[16:19], v[168:171], v[64:79]
  ds_read_b128 v[40:43], v4 offset:2048
  ds_read_b128 v[44:47], v4 offset:3072
  v_mfma_f32_32x32x16_bf16 v[80:95], v[20:23], v[168:171], v[80:95]
  ds_read_b128 v[48:51], v4 offset:4096
  ds_read_b128 v[52:55], v4 offset:5120
  v_mfma_f32_32x32x16_bf16 v[96:111], v[24:27], v[168:171], v[96:111]
  ds_read_b128 v[56:59], v4 offset:6144
  ds_read_b128 v[60:63], v4 offset:7168
  buffer_load_dwordx4 v[228:231], v9, s[24:27], 0 offen offset:16 sc1
  v_mfma_f32_32x32x16_bf16 v[112:127], v[28:31], v[168:171], v[112:127]
  v_mfma_f32_32x32x16_bf16 v[128:143], v[32:35], v[168:171], v[128:143]
  v_mfma_f32_32x32x16_bf16 v[144:159], v[36:39], v[168:171], v[144:159]
  s_waitcnt lgkmcnt(0)
  s_waitcnt vmcnt(6)
  v_mfma_f32_32x32x16_bf16 v[64:79], v[40:43], v[172:175], v[64:79]
  ds_read_b128 v[16:19], v4 offset:8192
  ds_read_b128 v[20:23], v4 offset:9216
  v_mfma_f32_32x32x16_bf16 v[80:95], v[44:47], v[172:175], v[80:95]
  ds_read_b128 v[24:27], v4 offset:10240
  ds_read_b128 v[28:31], v4 offset:11264
  v_mfma_f32_32x32x16_bf16 v[96:111], v[48:51], v[172:175], v[96:111]
  ds_read_b128 v[32:35], v4 offset:12288
  ds_read_b128 v[36:39], v4 offset:13312
  buffer_load_dwordx4 v[232:235], v9, s[24:27], 0 offen offset:32 sc1
  v_mfma_f32_32x32x16_bf16 v[112:127], v[52:55], v[172:175], v[112:127]
  v_mfma_f32_32x32x16_bf16 v[128:143], v[56:59], v[172:175], v[128:143]
  v_mfma_f32_32x32x16_bf16 v[144:159], v[60:63], v[172:175], v[144:159]
  s_waitcnt lgkmcnt(0)
  s_waitcnt vmcnt(6)
  v_mfma_f32_32x32x16_bf16 v[64:79], v[16:19], v[176:179], v[64:79]
  ds_read_b128 v[40:43], v4 offset:14336
  ds_read_b128 v[44:47], v4 offset:15360
  v_mfma_f32_32x32x16_bf16 v[80:95], v[20:23], v[176:179], v[80:95]
  ds_read_b128 v[48:51], v4 offset:16384
  ds_read_b128 v[52:55], v4 offset:17408
  v_mfma_f32_32x32x16_bf16 v[96:111], v[24:27], v[176:179], v[96:111]
  ds_read_b128 v[56:59], v4 offset:18432
  ds_read_b128 v[60:63], v4 offset:19456
  buffer_load_dwordx4 v[236:239], v9, s[24:27], 0 offen offset:48 sc1
  v_mfma_f32_32x32x16_bf16 v[112:127], v[28:31], v[176:179], v[112:127]
  v_mfma_f32_32x32x16_bf16 v[128:143], v[32:35], v[176:179], v[128:143]
  v_mfma_f32_32x32x16_bf16 v[144:159], v[36:39], v[176:179], v[144:159]
  s_waitcnt lgkmcnt(0)
  s_waitcnt vmcnt(6)
  v_mfma_f32_32x32x16_bf16 v[64:79], v[40:43], v[180:183], v[64:79]
  ds_read_b128 v[16:19], v4 offset:20480
  ds_read_b128 v[20:23], v4 offset:21504
  v_mfma_f32_32x32x16_bf16 v[80:95], v[44:47], v[180:183], v[80:95]
  ds_read_b128 v[24:27], v4 offset:22528
  ds_read_b128 v[28:31], v4 offset:23552
  v_mfma_f32_32x32x16_bf16 v[96:111], v[48:51], v[180:183], v[96:111]
  ds_read_b128 v[32:35], v4 offset:24576
  ds_read_b128 v[36:39], v4 offset:25600
  v_mfma_f32_32x32x16_bf16 v[112:127], v[52:55], v[180:183], v[112:127]
  v_mfma_f32_32x32x16_bf16 v[128:143], v[56:59], v[180:183], v[128:143]
  v_mfma_f32_32x32x16_bf16 v[144:159], v[60:63], v[180:183], v[144:159]
  s_waitcnt lgkmcnt(0)
  s_waitcnt vmcnt(5)
  v_mfma_f32_32x32x16_bf16 v[64:79], v[16:19], v[184:187], v[64:79]
  ds_read_b128 v[40:43], v4 offset:26624
  ds_read_b128 v[44:47], v4 offset:27648
  v_mfma_f32_32x32x16_bf16 v[80:95], v[20:23], v[184:187], v[80:95]
  ds_read_b128 v[48:51], v4 offset:28672
  ds_read_b128 v[52:55], v4 offset:29696
  v_mfma_f32_32x32x16_bf16 v[96:111], v[24:27], v[184:187], v[96:111]
  ds_read_b128 v[56:59], v4 offset:30720
  ds_read_b128 v[60:63], v4 offset:31744
  v_mfma_f32_32x32x16_bf16 v[112:127], v[28:31], v[184:187], v[112:127]
  v_mfma_f32_32x32x16_bf16 v[128:143], v[32:35], v[184:187], v[128:143]
  v_mfma_f32_32x32x16_bf16 v[144:159], v[36:39], v[184:187], v[144:159]
  s_waitcnt lgkmcnt(0)
  s_waitcnt vmcnt(4)
  v_mfma_f32_32x32x16_bf16 v[64:79], v[40:43], v[188:191], v[64:79]
  v_mfma_f32_32x32x16_bf16 v[80:95], v[44:47], v[188:191], v[80:95]
  v_mfma_f32_32x32x16_bf16 v[96:111], v[48:51], v[188:191], v[96:111]
  v_mfma_f32_32x32x16_bf16 v[112:127], v[52:55], v[188:191], v[112:127]
  v_mfma_f32_32x32x16_bf16 v[128:143], v[56:59], v[188:191], v[128:143]
  v_mfma_f32_32x32x16_bf16 v[144:159], v[60:63], v[188:191], v[144:159]
  s_barrier
  s_waitcnt vmcnt(0)
  v_add_f32 v224, v224, v226
  v_add_f32 v225, v225, v227
  v_add_f32 v228, v228, v230
  v_add_f32 v229, v229, v231
  v_add_f32 v232, v232, v234
  v_add_f32 v233, v233, v235
  v_add_f32 v236, v236, v238
  v_add_f32 v237, v237, v239
  v_add_f32 v224, v224, v228
  v_add_f32 v225, v225, v229
  v_add_f32 v232, v232, v236
  v_add_f32 v233, v233, v237
  v_add_f32 v224, v224, v232
  v_add_f32 v225, v225, v233
  v_mul_f32 v224, 0x3acccccd, v224
  v_mul_f32 v225, 0x3acccccd, v225
  v_fma_f32 v225, -v224, v224, v225
  v_max_f32 v225, 0, v225
  v_add_f32 v225, 0x3727c5ac, v225
  v_rsq_f32 v226, v225
  v_lshrrev_b32 v7, 5, v2
  v_mov_b32 v227, v226
  v_mul_f32 v228, v224, v226
  v_sub_f32 v228, 0, v228
  v_mov_b32 v229, v228
  v_lshlrev_b32 v6, 5, v7
  v_add_u32 v6, 160256, v6
  v_lshrrev_b32 v9, 4, v8
  v_mul_u32_u24 v9, 48*1024, v9
  v_and_b32 v10, 15, v8
  v_lshlrev_b32 v10, 4, v10
  v_add_u32 v9, v9, v10
  v_lshlrev_b32 v10, 8, v7
  v_add_u32 v9, v9, v10
  s_mul_i32 s59, s31, 6
  ds_read_b128 v[160:163], v6 offset:0
  ds_read_b128 v[164:167], v6 offset:16
  ds_read_b128 v[168:171], v6 offset:64
  ds_read_b128 v[172:175], v6 offset:80
  ds_read_b128 v[176:179], v6 offset:128
  ds_read_b128 v[180:183], v6 offset:144
  ds_read_b128 v[184:187], v6 offset:192
  ds_read_b128 v[188:191], v6 offset:208
  ds_read_b128 v[192:195], v6 offset:256
  ds_read_b128 v[196:199], v6 offset:272
  ds_read_b128 v[200:203], v6 offset:320
  ds_read_b128 v[204:207], v6 offset:336
  ds_read_b128 v[208:211], v6 offset:384
  ds_read_b128 v[212:215], v6 offset:400
  ds_read_b128 v[216:219], v6 offset:448
  ds_read_b128 v[220:223], v6 offset:464
  s_waitcnt lgkmcnt(8)
  v_pk_fma_f32 v[164:165], v[160:161], v[228:229], v[164:165]
  v_pk_fma_f32 v[64:65], v[64:65], v[226:227], v[164:165]
  v_pk_fma_f32 v[166:167], v[162:163], v[228:229], v[166:167]
  v_pk_fma_f32 v[66:67], v[66:67], v[226:227], v[166:167]
  v_pk_fma_f32 v[172:173], v[168:169], v[228:229], v[172:173]
  v_pk_fma_f32 v[68:69], v[68:69], v[226:227], v[172:173]
  v_pk_fma_f32 v[174:175], v[170:171], v[228:229], v[174:175]
  v_pk_fma_f32 v[70:71], v[70:71], v[226:227], v[174:175]
  v_pk_fma_f32 v[180:181], v[176:177], v[228:229], v[180:181]
  v_pk_fma_f32 v[72:73], v[72:73], v[226:227], v[180:181]
  v_pk_fma_f32 v[182:183], v[178:179], v[228:229], v[182:183]
  v_pk_fma_f32 v[74:75], v[74:75], v[226:227], v[182:183]
  v_pk_fma_f32 v[188:189], v[184:185], v[228:229], v[188:189]
  v_pk_fma_f32 v[76:77], v[76:77], v[226:227], v[188:189]
  v_pk_fma_f32 v[190:191], v[186:187], v[228:229], v[190:191]
  v_pk_fma_f32 v[78:79], v[78:79], v[226:227], v[190:191]
  v_pk_mul_f32 v[64:65], v[64:65], v[68:69]
  v_pk_mul_f32 v[72:73], v[72:73], v[76:77]
  v_pk_mul_f32 v[66:67], v[66:67], v[70:71]
  v_pk_mul_f32 v[74:75], v[74:75], v[78:79]
  v_cvt_pk_bf16_f32 v16, v64, v65
  v_cvt_pk_bf16_f32 v17, v66, v67
  v_cvt_pk_bf16_f32 v18, v72, v73
  v_cvt_pk_bf16_f32 v19, v74, v75
  s_add_u32 s60, s59, 0
  s_lshr_b32 s61, s60, 1
  s_lshl_b32 s61, s61, 10
  s_and_b32 s60, s60, 1
  s_lshl_b32 s60, s60, 9
  s_add_u32 s61, s61, s60
  buffer_store_dwordx4 v[16:19], v9, s[40:43], s61 offen sc1
  ds_read_b128 v[160:163], v6 offset:512
  ds_read_b128 v[164:167], v6 offset:528
  ds_read_b128 v[168:171], v6 offset:576
  ds_read_b128 v[172:175], v6 offset:592
  ds_read_b128 v[176:179], v6 offset:640
  ds_read_b128 v[180:183], v6 offset:656
  ds_read_b128 v[184:187], v6 offset:704
  ds_read_b128 v[188:191], v6 offset:720
  s_waitcnt lgkmcnt(8)
  v_pk_fma_f32 v[196:197], v[192:193], v[228:229], v[196:197]
  v_pk_fma_f32 v[80:81], v[80:81], v[226:227], v[196:197]
  v_pk_fma_f32 v[198:199], v[194:195], v[228:229], v[198:199]
  v_pk_fma_f32 v[82:83], v[82:83], v[226:227], v[198:199]
  v_pk_fma_f32 v[204:205], v[200:201], v[228:229], v[204:205]
  v_pk_fma_f32 v[84:85], v[84:85], v[226:227], v[204:205]
  v_pk_fma_f32 v[206:207], v[202:203], v[228:229], v[206:207]
  v_pk_fma_f32 v[86:87], v[86:87], v[226:227], v[206:207]
  v_pk_fma_f32 v[212:213], v[208:209], v[228:229], v[212:213]
  v_pk_fma_f32 v[88:89], v[88:89], v[226:227], v[212:213]
  v_pk_fma_f32 v[214:215], v[210:211], v[228:229], v[214:215]
  v_pk_fma_f32 v[90:91], v[90:91], v[226:227], v[214:215]
  v_pk_fma_f32 v[220:221], v[216:217], v[228:229], v[220:221]
  v_pk_fma_f32 v[92:93], v[92:93], v[226:227], v[220:221]
  v_pk_fma_f32 v[222:223], v[218:219], v[228:229], v[222:223]
  v_pk_fma_f32 v[94:95], v[94:95], v[226:227], v[222:223]
  v_pk_mul_f32 v[80:81], v[80:81], v[84:85]
  v_pk_mul_f32 v[88:89], v[88:89], v[92:93]
  v_pk_mul_f32 v[82:83], v[82:83], v[86:87]
  v_pk_mul_f32 v[90:91], v[90:91], v[94:95]
  v_cvt_pk_bf16_f32 v20, v80, v81
  v_cvt_pk_bf16_f32 v21, v82, v83
  v_cvt_pk_bf16_f32 v22, v88, v89
  v_cvt_pk_bf16_f32 v23, v90, v91
  s_add_u32 s60, s59, 1
  s_lshr_b32 s61, s60, 1
  s_lshl_b32 s61, s61, 10
  s_and_b32 s60, s60, 1
  s_lshl_b32 s60, s60, 9
  s_add_u32 s61, s61, s60
  buffer_store_dwordx4 v[20:23], v9, s[40:43], s61 offen sc1
  ds_read_b128 v[192:195], v6 offset:768
  ds_read_b128 v[196:199], v6 offset:784
  ds_read_b128 v[200:203], v6 offset:832
  ds_read_b128 v[204:207], v6 offset:848
  ds_read_b128 v[208:211], v6 offset:896
  ds_read_b128 v[212:215], v6 offset:912
  ds_read_b128 v[216:219], v6 offset:960
  ds_read_b128 v[220:223], v6 offset:976
  s_waitcnt lgkmcnt(8)
  v_pk_fma_f32 v[164:165], v[160:161], v[228:229], v[164:165]
  v_pk_fma_f32 v[96:97], v[96:97], v[226:227], v[164:165]
  v_pk_fma_f32 v[166:167], v[162:163], v[228:229], v[166:167]
  v_pk_fma_f32 v[98:99], v[98:99], v[226:227], v[166:167]
  v_pk_fma_f32 v[172:173], v[168:169], v[228:229], v[172:173]
  v_pk_fma_f32 v[100:101], v[100:101], v[226:227], v[172:173]
  v_pk_fma_f32 v[174:175], v[170:171], v[228:229], v[174:175]
  v_pk_fma_f32 v[102:103], v[102:103], v[226:227], v[174:175]
  v_pk_fma_f32 v[180:181], v[176:177], v[228:229], v[180:181]
  v_pk_fma_f32 v[104:105], v[104:105], v[226:227], v[180:181]
  v_pk_fma_f32 v[182:183], v[178:179], v[228:229], v[182:183]
  v_pk_fma_f32 v[106:107], v[106:107], v[226:227], v[182:183]
  v_pk_fma_f32 v[188:189], v[184:185], v[228:229], v[188:189]
  v_pk_fma_f32 v[108:109], v[108:109], v[226:227], v[188:189]
  v_pk_fma_f32 v[190:191], v[186:187], v[228:229], v[190:191]
  v_pk_fma_f32 v[110:111], v[110:111], v[226:227], v[190:191]
  v_pk_mul_f32 v[96:97], v[96:97], v[100:101]
  v_pk_mul_f32 v[104:105], v[104:105], v[108:109]
  v_pk_mul_f32 v[98:99], v[98:99], v[102:103]
  v_pk_mul_f32 v[106:107], v[106:107], v[110:111]
  v_cvt_pk_bf16_f32 v24, v96, v97
  v_cvt_pk_bf16_f32 v25, v98, v99
  v_cvt_pk_bf16_f32 v26, v104, v105
  v_cvt_pk_bf16_f32 v27, v106, v107
  s_add_u32 s60, s59, 2
  s_lshr_b32 s61, s60, 1
  s_lshl_b32 s61, s61, 10
  s_and_b32 s60, s60, 1
  s_lshl_b32 s60, s60, 9
  s_add_u32 s61, s61, s60
  buffer_store_dwordx4 v[24:27], v9, s[40:43], s61 offen sc1
  ds_read_b128 v[160:163], v6 offset:1024
  ds_read_b128 v[164:167], v6 offset:1040
  ds_read_b128 v[168:171], v6 offset:1088
  ds_read_b128 v[172:175], v6 offset:1104
  ds_read_b128 v[176:179], v6 offset:1152
  ds_read_b128 v[180:183], v6 offset:1168
  ds_read_b128 v[184:187], v6 offset:1216
  ds_read_b128 v[188:191], v6 offset:1232
  s_waitcnt lgkmcnt(8)
  v_pk_fma_f32 v[196:197], v[192:193], v[228:229], v[196:197]
  v_pk_fma_f32 v[112:113], v[112:113], v[226:227], v[196:197]
  v_pk_fma_f32 v[198:199], v[194:195], v[228:229], v[198:199]
  v_pk_fma_f32 v[114:115], v[114:115], v[226:227], v[198:199]
  v_pk_fma_f32 v[204:205], v[200:201], v[228:229], v[204:205]
  v_pk_fma_f32 v[116:117], v[116:117], v[226:227], v[204:205]
  v_pk_fma_f32 v[206:207], v[202:203], v[228:229], v[206:207]
  v_pk_fma_f32 v[118:119], v[118:119], v[226:227], v[206:207]
  v_pk_fma_f32 v[212:213], v[208:209], v[228:229], v[212:213]
  v_pk_fma_f32 v[120:121], v[120:121], v[226:227], v[212:213]
  v_pk_fma_f32 v[214:215], v[210:211], v[228:229], v[214:215]
  v_pk_fma_f32 v[122:123], v[122:123], v[226:227], v[214:215]
  v_pk_fma_f32 v[220:221], v[216:217], v[228:229], v[220:221]
  v_pk_fma_f32 v[124:125], v[124:125], v[226:227], v[220:221]
  v_pk_fma_f32 v[222:223], v[218:219], v[228:229], v[222:223]
  v_pk_fma_f32 v[126:127], v[126:127], v[226:227], v[222:223]
  v_pk_mul_f32 v[112:113], v[112:113], v[116:117]
  v_pk_mul_f32 v[120:121], v[120:121], v[124:125]
  v_pk_mul_f32 v[114:115], v[114:115], v[118:119]
  v_pk_mul_f32 v[122:123], v[122:123], v[126:127]
  v_cvt_pk_bf16_f32 v28, v112, v113
  v_cvt_pk_bf16_f32 v29, v114, v115
  v_cvt_pk_bf16_f32 v30, v120, v121
  v_cvt_pk_bf16_f32 v31, v122, v123
  s_add_u32 s60, s59, 3
  s_lshr_b32 s61, s60, 1
  s_lshl_b32 s61, s61, 10
  s_and_b32 s60, s60, 1
  s_lshl_b32 s60, s60, 9
  s_add_u32 s61, s61, s60
  buffer_store_dwordx4 v[28:31], v9, s[40:43], s61 offen sc1
  ds_read_b128 v[192:195], v6 offset:1280
  ds_read_b128 v[196:199], v6 offset:1296
  ds_read_b128 v[200:203], v6 offset:1344
  ds_read_b128 v[204:207], v6 offset:1360
  ds_read_b128 v[208:211], v6 offset:1408
  ds_read_b128 v[212:215], v6 offset:1424
  ds_read_b128 v[216:219], v6 offset:1472
  ds_read_b128 v[220:223], v6 offset:1488
  s_waitcnt lgkmcnt(8)
  v_pk_fma_f32 v[164:165], v[160:161], v[228:229], v[164:165]
  v_pk_fma_f32 v[128:129], v[128:129], v[226:227], v[164:165]
  v_pk_fma_f32 v[166:167], v[162:163], v[228:229], v[166:167]
  v_pk_fma_f32 v[130:131], v[130:131], v[226:227], v[166:167]
  v_pk_fma_f32 v[172:173], v[168:169], v[228:229], v[172:173]
  v_pk_fma_f32 v[132:133], v[132:133], v[226:227], v[172:173]
  v_pk_fma_f32 v[174:175], v[170:171], v[228:229], v[174:175]
  v_pk_fma_f32 v[134:135], v[134:135], v[226:227], v[174:175]
  v_pk_fma_f32 v[180:181], v[176:177], v[228:229], v[180:181]
  v_pk_fma_f32 v[136:137], v[136:137], v[226:227], v[180:181]
  v_pk_fma_f32 v[182:183], v[178:179], v[228:229], v[182:183]
  v_pk_fma_f32 v[138:139], v[138:139], v[226:227], v[182:183]
  v_pk_fma_f32 v[188:189], v[184:185], v[228:229], v[188:189]
  v_pk_fma_f32 v[140:141], v[140:141], v[226:227], v[188:189]
  v_pk_fma_f32 v[190:191], v[186:187], v[228:229], v[190:191]
  v_pk_fma_f32 v[142:143], v[142:143], v[226:227], v[190:191]
  v_pk_mul_f32 v[128:129], v[128:129], v[132:133]
  v_pk_mul_f32 v[136:137], v[136:137], v[140:141]
  v_pk_mul_f32 v[130:131], v[130:131], v[134:135]
  v_pk_mul_f32 v[138:139], v[138:139], v[142:143]
  v_cvt_pk_bf16_f32 v32, v128, v129
  v_cvt_pk_bf16_f32 v33, v130, v131
  v_cvt_pk_bf16_f32 v34, v136, v137
  v_cvt_pk_bf16_f32 v35, v138, v139
  s_add_u32 s60, s59, 4
  s_lshr_b32 s61, s60, 1
  s_lshl_b32 s61, s61, 10
  s_and_b32 s60, s60, 1
  s_lshl_b32 s60, s60, 9
  s_add_u32 s61, s61, s60
  buffer_store_dwordx4 v[32:35], v9, s[40:43], s61 offen sc1
  s_waitcnt lgkmcnt(0)
  v_pk_fma_f32 v[196:197], v[192:193], v[228:229], v[196:197]
  v_pk_fma_f32 v[144:145], v[144:145], v[226:227], v[196:197]
  v_pk_fma_f32 v[198:199], v[194:195], v[228:229], v[198:199]
  v_pk_fma_f32 v[146:147], v[146:147], v[226:227], v[198:199]
  v_pk_fma_f32 v[204:205], v[200:201], v[228:229], v[204:205]
  v_pk_fma_f32 v[148:149], v[148:149], v[226:227], v[204:205]
  v_pk_fma_f32 v[206:207], v[202:203], v[228:229], v[206:207]
  v_pk_fma_f32 v[150:151], v[150:151], v[226:227], v[206:207]
  v_pk_fma_f32 v[212:213], v[208:209], v[228:229], v[212:213]
  v_pk_fma_f32 v[152:153], v[152:153], v[226:227], v[212:213]
  v_pk_fma_f32 v[214:215], v[210:211], v[228:229], v[214:215]
  v_pk_fma_f32 v[154:155], v[154:155], v[226:227], v[214:215]
  v_pk_fma_f32 v[220:221], v[216:217], v[228:229], v[220:221]
  v_pk_fma_f32 v[156:157], v[156:157], v[226:227], v[220:221]
  v_pk_fma_f32 v[222:223], v[218:219], v[228:229], v[222:223]
  v_pk_fma_f32 v[158:159], v[158:159], v[226:227], v[222:223]
  v_pk_mul_f32 v[144:145], v[144:145], v[148:149]
  v_pk_mul_f32 v[152:153], v[152:153], v[156:157]
  v_pk_mul_f32 v[146:147], v[146:147], v[150:151]
  v_pk_mul_f32 v[154:155], v[154:155], v[158:159]
  v_cvt_pk_bf16_f32 v36, v144, v145
  v_cvt_pk_bf16_f32 v37, v146, v147
  v_cvt_pk_bf16_f32 v38, v152, v153
  v_cvt_pk_bf16_f32 v39, v154, v155
  s_add_u32 s60, s59, 5
  s_lshr_b32 s61, s60, 1
  s_lshl_b32 s61, s61, 10
  s_and_b32 s60, s60, 1
  s_lshl_b32 s60, s60, 9
  s_add_u32 s61, s61, s60
  buffer_store_dwordx4 v[36:39], v9, s[40:43], s61 offen sc1
  s_waitcnt vmcnt(0)
  v_mov_b32 v12, 161816
  v_mov_b32 v13, 1
  s_mov_b64 exec, 1
  ds_add_u32 v12, v13
  s_mov_b64 exec, -1
  s_cmp_lg_u32 s3, 0
  s_cbranch_scc1 L_p_nosig_73
  v_mov_b32 v12, 161816
  s_mov_b32 s63, 320000
L_p_lw_75:
  ds_read_b32 v14, v12
  s_waitcnt lgkmcnt(0)
  v_readfirstlane_b32 s60, v14
  s_cmp_ge_u32 s60, 4
  s_cbranch_scc1 L_p_lwd_76
  s_sub_u32 s63, s63, 1
  s_cmp_lg_u32 s63, 0
  s_cbranch_scc1 L_p_lw_75
L_p_lwd_76:
  s_lshl_b32 s60, s30, 7
  s_add_u32 s60, s60, 36864
  v_mov_b32 v12, s60
  v_mov_b32 v13, 1
  s_mov_b64 exec, 1
  buffer_atomic_add v13, v12, s[16:19], 0 offen sc1
  s_mov_b64 exec, 1
  s_mov_b32 s63, 40000
L_p_poll_77:
  buffer_load_dword v14, v12, s[16:19], 0 offen sc1
  s_waitcnt vmcnt(0)
  v_cmp_le_u32 vcc, 16, v14
  s_nop 1
  s_cmp_eq_u64 vcc, exec
  s_cbranch_scc1 L_p_polled_78
  s_sub_u32 s63, s63, 1
  s_cmp_lg_u32 s63, 0
  s_cbranch_scc1 L_p_poll_77
L_p_polled_78:
  s_mov_b64 exec, -1
  v_mov_b32 v12, 161820
  v_mov_b32 v13, 1
  s_mov_b64 exec, 1
  ds_write_b32 v12, v13
  s_mov_b64 exec, -1
  s_branch L_p_hj_74
L_p_nosig_73:
  v_mov_b32 v12, 161820
  s_mov_b32 s63, 320000
L_p_lw_79:
  ds_read_b32 v14, v12
  s_waitcnt lgkmcnt(0)
  v_readfirstlane_b32 s60, v14
  s_cmp_ge_u32 s60, 1
  s_cbranch_scc1 L_p_lwd_80
  s_sub_u32 s63, s63, 1
  s_cmp_lg_u32 s63, 0
  s_cbranch_scc1 L_p_lw_79
L_p_lwd_80:
L_p_hj_74:
  s_add_u32 s8, s4, 0x1a94000
  s_addc_u32 s9, s5, 0
  s_and_b32 s9, s9, 0xffff
  s_mov_b32 s10, 0x600000
  s_mov_b32 s11, 0x20000
  s_mov_b32 s20, s96
  s_mov_b32 s21, s97
  s_and_b32 s21, s21, 0xffff
  s_mov_b32 s22, 0x280000
  s_mov_b32 s23, 0x20000
  s_and_b32 s52, s3, 1
  s_lshr_b32 s53, s3, 1
  s_lshl_b32 s54, s37, 2
  s_lshl_b32 s55, s52, 1
  s_add_u32 s54, s54, s55
  s_mul_i32 s55, s54, 48
  s_mul_i32 s56, s53, 24
  s_add_u32 s55, s55, s56
  s_lshl_b32 s33, s55, 10
  s_add_u32 s57, s54, s53
  s_mul_i32 s60, s3, 5120
  s_add_u32 s60, s60, 0
  v_add_u32 v254, s60, v3
  s_xor_b32 s61, s3, 2
  s_mul_i32 s61, s61, 5120
  s_add_u32 s61, s61, 0
  v_add_u32 v253, s61, v3
  s_lshr_b32 s60, s3, 1
  s_mul_i32 s60, s60, 10240
  v_add_u32 v6, s60, v3
  v_add_u32 v7, 0x10000, v6
  v_add_u32 v8, 0x20000, v6
  s_mov_b32 s39, s33
  s_mov_b32 s35, s39
  s_add_u32 s36, s39, 49152
  s_add_u32 s39, s39, 2048
  buffer_load_dwordx4 v[104:107], v3, s[8:11], s35 offen offset:0 sc1
  buffer_load_dwordx4 v[108:111], v3, s[8:11], s36 offen offset:0 sc1
  buffer_load_dwordx4 v[112:115], v3, s[8:11], s35 offen offset:1024 sc1
  buffer_load_dwordx4 v[116:119], v3, s[8:11], s36 offen offset:1024 sc1
  s_mov_b32 s35, s39
  s_add_u32 s36, s39, 49152
  s_add_u32 s39, s39, 2048
  buffer_load_dwordx4 v[120:123], v3, s[8:11], s35 offen offset:0 sc1
  buffer_load_dwordx4 v[124:127], v3, s[8:11], s36 offen offset:0 sc1
  buffer_load_dwordx4 v[128:131], v3, s[8:11], s35 offen offset:1024 sc1
  buffer_load_dwordx4 v[132:135], v3, s[8:11], s36 offen offset:1024 sc1
  s_mov_b32 s35, s39
  s_add_u32 s36, s39, 49152
  s_add_u32 s39, s39, 2048
  buffer_load_dwordx4 v[136:139], v3, s[8:11], s35 offen offset:0 sc1
  buffer_load_dwordx4 v[140:143], v3, s[8:11], s36 offen offset:0 sc1
  buffer_load_dwordx4 v[144:147], v3, s[8:11], s35 offen offset:1024 sc1
  buffer_load_dwordx4 v[148:151], v3, s[8:11], s36 offen offset:1024 sc1
  s_barrier
  ds_read_b128 v[16:19], v7 offset:32768
  ds_read_b128 v[20:23], v7 offset:33792
  ds_read_b128 v[24:27], v7 offset:34816
  ds_read_b128 v[28:31], v7 offset:35840
  ds_read_b128 v[32:35], v7 offset:36864
  s_waitcnt lgkmcnt(0)
  s_waitcnt vmcnt(10)
  v_mfma_f32_16x16x32_bf16 v[64:67], v[16:19], v[104:107], 0
  ds_read_b128 v[36:39], v7 offset:37888
  v_mfma_f32_16x16x32_bf16 v[68:71], v[20:23], v[104:107], 0
  ds_read_b128 v[40:43], v7 offset:38912
  v_mfma_f32_16x16x32_bf16 v[72:75], v[24:27], v[104:107], 0
  ds_read_b128 v[44:47], v7 offset:39936
  v_mfma_f32_16x16x32_bf16 v[76:79], v[28:31], v[104:107], 0
  ds_read_b128 v[48:51], v7 offset:40960
  v_mfma_f32_16x16x32_bf16 v[80:83], v[32:35], v[104:107], 0
  ds_read_b128 v[52:55], v7 offset:41984
  v_mfma_f32_16x16x32_bf16 v[84:87], v[16:19], v[108:111], 0
  s_mov_b32 s35, s39
  s_add_u32 s36, s39, 49152
  s_add_u32 s39, s39, 2048
  buffer_load_dwordx4 v[152:155], v3, s[8:11], s35 offen offset:0 sc1
  v_mfma_f32_16x16x32_bf16 v[88:91], v[20:23], v[108:111], 0
  v_mfma_f32_16x16x32_bf16 v[92:95], v[24:27], v[108:111], 0
  buffer_load_dwordx4 v[156:159], v3, s[8:11], s36 offen offset:0 sc1
  v_mfma_f32_16x16x32_bf16 v[96:99], v[28:31], v[108:111], 0
  v_mfma_f32_16x16x32_bf16 v[100:103], v[32:35], v[108:111], 0
  s_waitcnt lgkmcnt(0)
  s_waitcnt vmcnt(10)
  v_mfma_f32_16x16x32_bf16 v[64:67], v[36:39], v[112:115], v[64:67]
  ds_read_b128 v[16:19], v7 offset:57344
  v_mfma_f32_16x16x32_bf16 v[68:71], v[40:43], v[112:115], v[68:71]
  ds_read_b128 v[20:23], v7 offset:58368
  v_mfma_f32_16x16x32_bf16 v[72:75], v[44:47], v[112:115], v[72:75]
  ds_read_b128 v[24:27], v7 offset:59392
  v_mfma_f32_16x16x32_bf16 v[76:79], v[48:51], v[112:115], v[76:79]
  ds_read_b128 v[28:31], v7 offset:60416
  v_mfma_f32_16x16x32_bf16 v[80:83], v[52:55], v[112:115], v[80:83]
  ds_read_b128 v[32:35], v7 offset:61440
  v_mfma_f32_16x16x32_bf16 v[84:87], v[36:39], v[116:119], v[84:87]
  buffer_load_dwordx4 v[160:163], v3, s[8:11], s35 offen offset:1024 sc1
  v_mfma_f32_16x16x32_bf16 v[88:91], v[40:43], v[116:119], v[88:91]
  v_mfma_f32_16x16x32_bf16 v[92:95], v[44:47], v[116:119], v[92:95]
  buffer_load_dwordx4 v[164:167], v3, s[8:11], s36 offen offset:1024 sc1
  v_mfma_f32_16x16x32_bf16 v[96:99], v[48:51], v[116:119], v[96:99]
  v_mfma_f32_16x16x32_bf16 v[100:103], v[52:55], v[116:119], v[100:103]
  s_waitcnt lgkmcnt(0)
  s_waitcnt vmcnt(10)
  v_mfma_f32_16x16x32_bf16 v[64:67], v[16:19], v[120:123], v[64:67]
  ds_read_b128 v[36:39], v7 offset:62464
  v_mfma_f32_16x16x32_bf16 v[68:71], v[20:23], v[120:123], v[68:71]
  ds_read_b128 v[40:43], v7 offset:63488
  v_mfma_f32_16x16x32_bf16 v[72:75], v[24:27], v[120:123], v[72:75]
  ds_read_b128 v[44:47], v7 offset:64512
  v_mfma_f32_16x16x32_bf16 v[76:79], v[28:31], v[120:123], v[76:79]
  ds_read_b128 v[48:51], v8 offset:0
  v_mfma_f32_16x16x32_bf16 v[80:83], v[32:35], v[120:123], v[80:83]
  ds_read_b128 v[52:55], v8 offset:1024
  v_mfma_f32_16x16x32_bf16 v[84:87], v[16:19], v[124:127], v[84:87]
  s_mov_b32 s35, s39
  s_add_u32 s36, s39, 49152
  s_add_u32 s39, s39, 2048
  buffer_load_dwordx4 v[168:171], v3, s[8:11], s35 offen offset:0 sc1
  v_mfma_f32_16x16x32_bf16 v[88:91], v[20:23], v[124:127], v[88:91]
  v_mfma_f32_16x16x32_bf16 v[92:95], v[24:27], v[124:127], v[92:95]
  buffer_load_dwordx4 v[172:175], v3, s[8:11], s36 offen offset:0 sc1
  v_mfma_f32_16x16x32_bf16 v[96:99], v[28:31], v[124:127], v[96:99]
  v_mfma_f32_16x16x32_bf16 v[100:103], v[32:35], v[124:127], v[100:103]
  s_waitcnt lgkmcnt(0)
  s_barrier
  s_waitcnt vmcnt(10)
  v_mfma_f32_16x16x32_bf16 v[64:67], v[36:39], v[128:131], v[64:67]
  ds_read_b128 v[16:19], v6 offset:0
  v_mfma_f32_16x16x32_bf16 v[68:71], v[40:43], v[128:131], v[68:71]
  ds_read_b128 v[20:23], v6 offset:1024
  v_mfma_f32_16x16x32_bf16 v[72:75], v[44:47], v[128:131], v[72:75]
  ds_read_b128 v[24:27], v6 offset:2048
  v_mfma_f32_16x16x32_bf16 v[76:79], v[48:51], v[128:131], v[76:79]
  ds_read_b128 v[28:31], v6 offset:3072
  v_mfma_f32_16x16x32_bf16 v[80:83], v[52:55], v[128:131], v[80:83]
  ds_read_b128 v[32:35], v6 offset:4096
  v_mfma_f32_16x16x32_bf16 v[84:87], v[36:39], v[132:135], v[84:87]
  buffer_load_dwordx4 v[176:179], v3, s[8:11], s35 offen offset:1024 sc1
  v_mfma_f32_16x16x32_bf16 v[88:91], v[40:43], v[132:135], v[88:91]
  v_mfma_f32_16x16x32_bf16 v[92:95], v[44:47], v[132:135], v[92:95]
  buffer_load_dwordx4 v[180:183], v3, s[8:11], s36 offen offset:1024 sc1
  v_mfma_f32_16x16x32_bf16 v[96:99], v[48:51], v[132:135], v[96:99]
  v_mfma_f32_16x16x32_bf16 v[100:103], v[52:55], v[132:135], v[100:103]
  s_waitcnt lgkmcnt(0)
  s_waitcnt vmcnt(10)
  v_mfma_f32_16x16x32_bf16 v[64:67], v[16:19], v[136:139], v[64:67]
  ds_read_b128 v[36:39], v6 offset:5120
  v_mfma_f32_16x16x32_bf16 v[68:71], v[20:23], v[136:139], v[68:71]
  ds_read_b128 v[40:43], v6 offset:6144
  v_mfma_f32_16x16x32_bf16 v[72:75], v[24:27], v[136:139], v[72:75]
  ds_read_b128 v[44:47], v6 offset:7168
  v_mfma_f32_16x16x32_bf16 v[76:79], v[28:31], v[136:139], v[76:79]
  ds_read_b128 v[48:51], v6 offset:8192
  v_mfma_f32_16x16x32_bf16 v[80:83], v[32:35], v[136:139], v[80:83]
  ds_read_b128 v[52:55], v6 offset:9216
  v_mfma_f32_16x16x32_bf16 v[84:87], v[16:19], v[140:143], v[84:87]
  s_mov_b32 s35, s39
  s_add_u32 s36, s39, 49152
  s_add_u32 s39, s39, 2048
  buffer_load_dwordx4 v[184:187], v3, s[8:11], s35 offen offset:0 sc1
  v_mfma_f32_16x16x32_bf16 v[88:91], v[20:23], v[140:143], v[88:91]
  v_mfma_f32_16x16x32_bf16 v[92:95], v[24:27], v[140:143], v[92:95]
  buffer_load_dwordx4 v[188:191], v3, s[8:11], s36 offen offset:0 sc1
  v_mfma_f32_16x16x32_bf16 v[96:99], v[28:31], v[140:143], v[96:99]
  v_mfma_f32_16x16x32_bf16 v[100:103], v[32:35], v[140:143], v[100:103]
  s_waitcnt lgkmcnt(0)
  s_waitcnt vmcnt(10)
  v_mfma_f32_16x16x32_bf16 v[64:67], v[36:39], v[144:147], v[64:67]
  ds_read_b128 v[16:19], v6 offset:24576
  v_mfma_f32_16x16x32_bf16 v[68:71], v[40:43], v[144:147], v[68:71]
  ds_read_b128 v[20:23], v6 offset:25600
  v_mfma_f32_16x16x32_bf16 v[72:75], v[44:47], v[144:147], v[72:75]
  ds_read_b128 v[24:27], v6 offset:26624
  v_mfma_f32_16x16x32_bf16 v[76:79], v[48:51], v[144:147], v[76:79]
  ds_read_b128 v[28:31], v6 offset:27648
  v_mfma_f32_16x16x32_bf16 v[80:83], v[52:55], v[144:147], v[80:83]
  ds_read_b128 v[32:35], v6 offset:28672
  v_mfma_f32_16x16x32_bf16 v[84:87], v[36:39], v[148:151], v[84:87]
  buffer_load_dwordx4 v[192:195], v3, s[8:11], s35 offen offset:1024 sc1
  v_mfma_f32_16x16x32_bf16 v[88:91], v[40:43], v[148:151], v[88:91]
  v_mfma_f32_16x16x32_bf16 v[92:95], v[44:47], v[148:151], v[92:95]
  buffer_load_dwordx4 v[196:199], v3, s[8:11], s36 offen offset:1024 sc1
  v_mfma_f32_16x16x32_bf16 v[96:99], v[48:51], v[148:151], v[96:99]
  v_mfma_f32_16x16x32_bf16 v[100:103], v[52:55], v[148:151], v[100:103]
  s_waitcnt lgkmcnt(0)
  s_waitcnt vmcnt(10)
  v_mfma_f32_16x16x32_bf16 v[64:67], v[16:19], v[152:155], v[64:67]
  ds_read_b128 v[36:39], v6 offset:29696
  v_mfma_f32_16x16x32_bf16 v[68:71], v[20:23], v[152:155], v[68:71]
  ds_read_b128 v[40:43], v6 offset:30720
  v_mfma_f32_16x16x32_bf16 v[72:75], v[24:27], v[152:155], v[72:75]
  ds_read_b128 v[44:47], v6 offset:31744
  v_mfma_f32_16x16x32_bf16 v[76:79], v[28:31], v[152:155], v[76:79]
  ds_read_b128 v[48:51], v6 offset:32768
  v_mfma_f32_16x16x32_bf16 v[80:83], v[32:35], v[152:155], v[80:83]
  ds_read_b128 v[52:55], v6 offset:33792
  v_mfma_f32_16x16x32_bf16 v[84:87], v[16:19], v[156:159], v[84:87]
  s_mov_b32 s35, s39
  s_add_u32 s36, s39, 49152
  s_add_u32 s39, s39, 2048
  buffer_load_dwordx4 v[200:203], v3, s[8:11], s35 offen offset:0 sc1
  v_mfma_f32_16x16x32_bf16 v[88:91], v[20:23], v[156:159], v[88:91]
  v_mfma_f32_16x16x32_bf16 v[92:95], v[24:27], v[156:159], v[92:95]
  buffer_load_dwordx4 v[204:207], v3, s[8:11], s36 offen offset:0 sc1
  v_mfma_f32_16x16x32_bf16 v[96:99], v[28:31], v[156:159], v[96:99]
  v_mfma_f32_16x16x32_bf16 v[100:103], v[32:35], v[156:159], v[100:103]
  s_waitcnt lgkmcnt(0)
  s_barrier
  s_waitcnt vmcnt(10)
  v_mfma_f32_16x16x32_bf16 v[64:67], v[36:39], v[160:163], v[64:67]
  ds_read_b128 v[16:19], v6 offset:49152
  v_mfma_f32_16x16x32_bf16 v[68:71], v[40:43], v[160:163], v[68:71]
  ds_read_b128 v[20:23], v6 offset:50176
  v_mfma_f32_16x16x32_bf16 v[72:75], v[44:47], v[160:163], v[72:75]
  ds_read_b128 v[24:27], v6 offset:51200
  v_mfma_f32_16x16x32_bf16 v[76:79], v[48:51], v[160:163], v[76:79]
  ds_read_b128 v[28:31], v6 offset:52224
  v_mfma_f32_16x16x32_bf16 v[80:83], v[52:55], v[160:163], v[80:83]
  ds_read_b128 v[32:35], v6 offset:53248
  v_mfma_f32_16x16x32_bf16 v[84:87], v[36:39], v[164:167], v[84:87]
  buffer_load_dwordx4 v[208:211], v3, s[8:11], s35 offen offset:1024 sc1
  v_mfma_f32_16x16x32_bf16 v[88:91], v[40:43], v[164:167], v[88:91]
  v_mfma_f32_16x16x32_bf16 v[92:95], v[44:47], v[164:167], v[92:95]
  buffer_load_dwordx4 v[212:215], v3, s[8:11], s36 offen offset:1024 sc1
  v_mfma_f32_16x16x32_bf16 v[96:99], v[48:51], v[164:167], v[96:99]
  v_mfma_f32_16x16x32_bf16 v[100:103], v[52:55], v[164:167], v[100:103]
  s_waitcnt lgkmcnt(0)
  s_waitcnt vmcnt(10)
  v_mfma_f32_16x16x32_bf16 v[64:67], v[16:19], v[168:171], v[64:67]
  ds_read_b128 v[36:39], v6 offset:54272
  v_mfma_f32_16x16x32_bf16 v[68:71], v[20:23], v[168:171], v[68:71]
  ds_read_b128 v[40:43], v6 offset:55296
  v_mfma_f32_16x16x32_bf16 v[72:75], v[24:27], v[168:171], v[72:75]
  ds_read_b128 v[44:47], v6 offset:56320
  v_mfma_f32_16x16x32_bf16 v[76:79], v[28:31], v[168:171], v[76:79]
  ds_read_b128 v[48:51], v6 offset:57344
  v_mfma_f32_16x16x32_bf16 v[80:83], v[32:35], v[168:171], v[80:83]
  ds_read_b128 v[52:55], v6 offset:58368
  v_mfma_f32_16x16x32_bf16 v[84:87], v[16:19], v[172:175], v[84:87]
  s_mov_b32 s35, s39
  s_add_u32 s36, s39, 49152
  s_add_u32 s39, s39, 2048
  buffer_load_dwordx4 v[216:219], v3, s[8:11], s35 offen offset:0 sc1
  v_mfma_f32_16x16x32_bf16 v[88:91], v[20:23], v[172:175], v[88:91]
  v_mfma_f32_16x16x32_bf16 v[92:95], v[24:27], v[172:175], v[92:95]
  buffer_load_dwordx4 v[220:223], v3, s[8:11], s36 offen offset:0 sc1
  v_mfma_f32_16x16x32_bf16 v[96:99], v[28:31], v[172:175], v[96:99]
  v_mfma_f32_16x16x32_bf16 v[100:103], v[32:35], v[172:175], v[100:103]
  s_waitcnt lgkmcnt(0)
  s_waitcnt vmcnt(10)
  v_mfma_f32_16x16x32_bf16 v[64:67], v[36:39], v[176:179], v[64:67]
  ds_read_b128 v[16:19], v7 offset:8192
  v_mfma_f32_16x16x32_bf16 v[68:71], v[40:43], v[176:179], v[68:71]
  ds_read_b128 v[20:23], v7 offset:9216
  v_mfma_f32_16x16x32_bf16 v[72:75], v[44:47], v[176:179], v[72:75]
  ds_read_b128 v[24:27], v7 offset:10240
  v_mfma_f32_16x16x32_bf16 v[76:79], v[48:51], v[176:179], v[76:79]
  ds_read_b128 v[28:31], v7 offset:11264
  v_mfma_f32_16x16x32_bf16 v[80:83], v[52:55], v[176:179], v[80:83]
  ds_read_b128 v[32:35], v7 offset:12288
  v_mfma_f32_16x16x32_bf16 v[84:87], v[36:39], v[180:183], v[84:87]
  buffer_load_dwordx4 v[224:227], v3, s[8:11], s35 offen offset:1024 sc1
  v_mfma_f32_16x16x32_bf16 v[88:91], v[40:43], v[180:183], v[88:91]
  v_mfma_f32_16x16x32_bf16 v[92:95], v[44:47], v[180:183], v[92:95]
  buffer_load_dwordx4 v[228:231], v3, s[8:11], s36 offen offset:1024 sc1
  v_mfma_f32_16x16x32_bf16 v[96:99], v[48:51], v[180:183], v[96:99]
  v_mfma_f32_16x16x32_bf16 v[100:103], v[52:55], v[180:183], v[100:103]
  s_waitcnt lgkmcnt(0)
  s_waitcnt vmcnt(10)
  v_mfma_f32_16x16x32_bf16 v[64:67], v[16:19], v[184:187], v[64:67]
  ds_read_b128 v[36:39], v7 offset:13312
  v_mfma_f32_16x16x32_bf16 v[68:71], v[20:23], v[184:187], v[68:71]
  ds_read_b128 v[40:43], v7 offset:14336
  v_mfma_f32_16x16x32_bf16 v[72:75], v[24:27], v[184:187], v[72:75]
  ds_read_b128 v[44:47], v7 offset:15360
  v_mfma_f32_16x16x32_bf16 v[76:79], v[28:31], v[184:187], v[76:79]
  ds_read_b128 v[48:51], v7 offset:16384
  v_mfma_f32_16x16x32_bf16 v[80:83], v[32:35], v[184:187], v[80:83]
  ds_read_b128 v[52:55], v7 offset:17408
  v_mfma_f32_16x16x32_bf16 v[84:87], v[16:19], v[188:191], v[84:87]
  s_mov_b32 s35, s39
  s_add_u32 s36, s39, 49152
  s_add_u32 s39, s39, 2048
  buffer_load_dwordx4 v[104:107], v3, s[8:11], s35 offen offset:0 sc1
  v_mfma_f32_16x16x32_bf16 v[88:91], v[20:23], v[188:191], v[88:91]
  v_mfma_f32_16x16x32_bf16 v[92:95], v[24:27], v[188:191], v[92:95]
  buffer_load_dwordx4 v[108:111], v3, s[8:11], s36 offen offset:0 sc1
  v_mfma_f32_16x16x32_bf16 v[96:99], v[28:31], v[188:191], v[96:99]
  v_mfma_f32_16x16x32_bf16 v[100:103], v[32:35], v[188:191], v[100:103]
  s_waitcnt lgkmcnt(0)
  s_barrier
  s_waitcnt vmcnt(10)
  v_mfma_f32_16x16x32_bf16 v[64:67], v[36:39], v[192:195], v[64:67]
  ds_read_b128 v[16:19], v7 offset:32768
  v_mfma_f32_16x16x32_bf16 v[68:71], v[40:43], v[192:195], v[68:71]
  ds_read_b128 v[20:23], v7 offset:33792
  v_mfma_f32_16x16x32_bf16 v[72:75], v[44:47], v[192:195], v[72:75]
  ds_read_b128 v[24:27], v7 offset:34816
  v_mfma_f32_16x16x32_bf16 v[76:79], v[48:51], v[192:195], v[76:79]
  ds_read_b128 v[28:31], v7 offset:35840
  v_mfma_f32_16x16x32_bf16 v[80:83], v[52:55], v[192:195], v[80:83]
  ds_read_b128 v[32:35], v7 offset:36864
  v_mfma_f32_16x16x32_bf16 v[84:87], v[36:39], v[196:199], v[84:87]
  buffer_load_dwordx4 v[112:115], v3, s[8:11], s35 offen offset:1024 sc1
  v_mfma_f32_16x16x32_bf16 v[88:91], v[40:43], v[196:199], v[88:91]
  v_mfma_f32_16x16x32_bf16 v[92:95], v[44:47], v[196:199], v[92:95]
  buffer_load_dwordx4 v[116:119], v3, s[8:11], s36 offen offset:1024 sc1
  v_mfma_f32_16x16x32_bf16 v[96:99], v[48:51], v[196:199], v[96:99]
  v_mfma_f32_16x16x32_bf16 v[100:103], v[52:55], v[196:199], v[100:103]
  s_waitcnt lgkmcnt(0)
  s_waitcnt vmcnt(10)
  v_mfma_f32_16x16x32_bf16 v[64:67], v[16:19], v[200:203], v[64:67]
  ds_read_b128 v[36:39], v7 offset:37888
  v_mfma_f32_16x16x32_bf16 v[68:71], v[20:23], v[200:203], v[68:71]
  ds_read_b128 v[40:43], v7 offset:38912
  v_mfma_f32_16x16x32_bf16 v[72:75], v[24:27], v[200:203], v[72:75]
  ds_read_b128 v[44:47], v7 offset:39936
  v_mfma_f32_16x16x32_bf16 v[76:79], v[28:31], v[200:203], v[76:79]
  ds_read_b128 v[48:51], v7 offset:40960
  v_mfma_f32_16x16x32_bf16 v[80:83], v[32:35], v[200:203], v[80:83]
  ds_read_b128 v[52:55], v7 offset:41984
  v_mfma_f32_16x16x32_bf16 v[84:87], v[16:19], v[204:207], v[84:87]
  s_mov_b32 s35, s39
  s_add_u32 s36, s39, 49152
  s_add_u32 s39, s39, 2048
  buffer_load_dwordx4 v[120:123], v3, s[8:11], s35 offen offset:0 sc1
  v_mfma_f32_16x16x32_bf16 v[88:91], v[20:23], v[204:207], v[88:91]
  v_mfma_f32_16x16x32_bf16 v[92:95], v[24:27], v[204:207], v[92:95]
  buffer_load_dwordx4 v[124:127], v3, s[8:11], s36 offen offset:0 sc1
  v_mfma_f32_16x16x32_bf16 v[96:99], v[28:31], v[204:207], v[96:99]
  v_mfma_f32_16x16x32_bf16 v[100:103], v[32:35], v[204:207], v[100:103]
  s_waitcnt lgkmcnt(0)
  s_waitcnt vmcnt(10)
  v_mfma_f32_16x16x32_bf16 v[64:67], v[36:39], v[208:211], v[64:67]
  ds_read_b128 v[16:19], v7 offset:57344
  v_mfma_f32_16x16x32_bf16 v[68:71], v[40:43], v[208:211], v[68:71]
  ds_read_b128 v[20:23], v7 offset:58368
  v_mfma_f32_16x16x32_bf16 v[72:75], v[44:47], v[208:211], v[72:75]
  ds_read_b128 v[24:27], v7 offset:59392
  v_mfma_f32_16x16x32_bf16 v[76:79], v[48:51], v[208:211], v[76:79]
  ds_read_b128 v[28:31], v7 offset:60416
  v_mfma_f32_16x16x32_bf16 v[80:83], v[52:55], v[208:211], v[80:83]
  ds_read_b128 v[32:35], v7 offset:61440
  v_mfma_f32_16x16x32_bf16 v[84:87], v[36:39], v[212:215], v[84:87]
  buffer_load_dwordx4 v[128:131], v3, s[8:11], s35 offen offset:1024 sc1
  v_mfma_f32_16x16x32_bf16 v[88:91], v[40:43], v[212:215], v[88:91]
  v_mfma_f32_16x16x32_bf16 v[92:95], v[44:47], v[212:215], v[92:95]
  buffer_load_dwordx4 v[132:135], v3, s[8:11], s36 offen offset:1024 sc1
  v_mfma_f32_16x16x32_bf16 v[96:99], v[48:51], v[212:215], v[96:99]
  v_mfma_f32_16x16x32_bf16 v[100:103], v[52:55], v[212:215], v[100:103]
  s_waitcnt lgkmcnt(0)
  s_waitcnt vmcnt(10)
  v_mfma_f32_16x16x32_bf16 v[64:67], v[16:19], v[216:219], v[64:67]
  ds_read_b128 v[36:39], v7 offset:62464
  v_mfma_f32_16x16x32_bf16 v[68:71], v[20:23], v[216:219], v[68:71]
  ds_read_b128 v[40:43], v7 offset:63488
  v_mfma_f32_16x16x32_bf16 v[72:75], v[24:27], v[216:219], v[72:75]
  ds_read_b128 v[44:47], v7 offset:64512
  v_mfma_f32_16x16x32_bf16 v[76:79], v[28:31], v[216:219], v[76:79]
  ds_read_b128 v[48:51], v8 offset:0
  v_mfma_f32_16x16x32_bf16 v[80:83], v[32:35], v[216:219], v[80:83]
  ds_read_b128 v[52:55], v8 offset:1024
  v_mfma_f32_16x16x32_bf16 v[84:87], v[16:19], v[220:223], v[84:87]
  s_mov_b32 s35, s39
  s_add_u32 s36, s39, 49152
  s_add_u32 s39, s39, 2048
  buffer_load_dwordx4 v[136:139], v3, s[8:11], s35 offen offset:0 sc1
  v_mfma_f32_16x16x32_bf16 v[88:91], v[20:23], v[220:223], v[88:91]
  v_mfma_f32_16x16x32_bf16 v[92:95], v[24:27], v[220:223], v[92:95]
  buffer_load_dwordx4 v[140:143], v3, s[8:11], s36 offen offset:0 sc1
  v_mfma_f32_16x16x32_bf16 v[96:99], v[28:31], v[220:223], v[96:99]
  v_mfma_f32_16x16x32_bf16 v[100:103], v[32:35], v[220:223], v[100:103]
  s_waitcnt lgkmcnt(0)
  s_barrier
  s_waitcnt vmcnt(10)
  v_mfma_f32_16x16x32_bf16 v[64:67], v[36:39], v[224:227], v[64:67]
  ds_read_b128 v[16:19], v6 offset:0
  v_mfma_f32_16x16x32_bf16 v[68:71], v[40:43], v[224:227], v[68:71]
  ds_read_b128 v[20:23], v6 offset:1024
  v_mfma_f32_16x16x32_bf16 v[72:75], v[44:47], v[224:227], v[72:75]
  ds_read_b128 v[24:27], v6 offset:2048
  v_mfma_f32_16x16x32_bf16 v[76:79], v[48:51], v[224:227], v[76:79]
  ds_read_b128 v[28:31], v6 offset:3072
  v_mfma_f32_16x16x32_bf16 v[80:83], v[52:55], v[224:227], v[80:83]
  ds_read_b128 v[32:35], v6 offset:4096
  v_mfma_f32_16x16x32_bf16 v[84:87], v[36:39], v[228:231], v[84:87]
  buffer_load_dwordx4 v[144:147], v3, s[8:11], s35 offen offset:1024 sc1
  v_mfma_f32_16x16x32_bf16 v[88:91], v[40:43], v[228:231], v[88:91]
  v_mfma_f32_16x16x32_bf16 v[92:95], v[44:47], v[228:231], v[92:95]
  buffer_load_dwordx4 v[148:151], v3, s[8:11], s36 offen offset:1024 sc1
  v_mfma_f32_16x16x32_bf16 v[96:99], v[48:51], v[228:231], v[96:99]
  v_mfma_f32_16x16x32_bf16 v[100:103], v[52:55], v[228:231], v[100:103]
  s_waitcnt lgkmcnt(0)
  s_waitcnt vmcnt(10)
  v_mfma_f32_16x16x32_bf16 v[64:67], v[16:19], v[104:107], v[64:67]
  ds_read_b128 v[36:39], v6 offset:5120
  v_mfma_f32_16x16x32_bf16 v[68:71], v[20:23], v[104:107], v[68:71]
  ds_read_b128 v[40:43], v6 offset:6144
  v_mfma_f32_16x16x32_bf16 v[72:75], v[24:27], v[104:107], v[72:75]
  ds_read_b128 v[44:47], v6 offset:7168
  v_mfma_f32_16x16x32_bf16 v[76:79], v[28:31], v[104:107], v[76:79]
  ds_read_b128 v[48:51], v6 offset:8192
  v_mfma_f32_16x16x32_bf16 v[80:83], v[32:35], v[104:107], v[80:83]
  ds_read_b128 v[52:55], v6 offset:9216
  v_mfma_f32_16x16x32_bf16 v[84:87], v[16:19], v[108:111], v[84:87]
  s_mov_b32 s35, s39
  s_add_u32 s36, s39, 49152
  s_add_u32 s39, s39, 2048
  buffer_load_dwordx4 v[152:155], v3, s[8:11], s35 offen offset:0 sc1
  v_mfma_f32_16x16x32_bf16 v[88:91], v[20:23], v[108:111], v[88:91]
  v_mfma_f32_16x16x32_bf16 v[92:95], v[24:27], v[108:111], v[92:95]
  buffer_load_dwordx4 v[156:159], v3, s[8:11], s36 offen offset:0 sc1
  v_mfma_f32_16x16x32_bf16 v[96:99], v[28:31], v[108:111], v[96:99]
  v_mfma_f32_16x16x32_bf16 v[100:103], v[32:35], v[108:111], v[100:103]
  s_waitcnt lgkmcnt(0)
  s_waitcnt vmcnt(10)
  v_mfma_f32_16x16x32_bf16 v[64:67], v[36:39], v[112:115], v[64:67]
  ds_read_b128 v[16:19], v6 offset:24576
  v_mfma_f32_16x16x32_bf16 v[68:71], v[40:43], v[112:115], v[68:71]
  ds_read_b128 v[20:23], v6 offset:25600
  v_mfma_f32_16x16x32_bf16 v[72:75], v[44:47], v[112:115], v[72:75]
  ds_read_b128 v[24:27], v6 offset:26624
  v_mfma_f32_16x16x32_bf16 v[76:79], v[48:51], v[112:115], v[76:79]
  ds_read_b128 v[28:31], v6 offset:27648
  v_mfma_f32_16x16x32_bf16 v[80:83], v[52:55], v[112:115], v[80:83]
  ds_read_b128 v[32:35], v6 offset:28672
  v_mfma_f32_16x16x32_bf16 v[84:87], v[36:39], v[116:119], v[84:87]
  buffer_load_dwordx4 v[160:163], v3, s[8:11], s35 offen offset:1024 sc1
  v_mfma_f32_16x16x32_bf16 v[88:91], v[40:43], v[116:119], v[88:91]
  v_mfma_f32_16x16x32_bf16 v[92:95], v[44:47], v[116:119], v[92:95]
  buffer_load_dwordx4 v[164:167], v3, s[8:11], s36 offen offset:1024 sc1
  v_mfma_f32_16x16x32_bf16 v[96:99], v[48:51], v[116:119], v[96:99]
  v_mfma_f32_16x16x32_bf16 v[100:103], v[52:55], v[116:119], v[100:103]
  s_waitcnt lgkmcnt(0)
  s_waitcnt vmcnt(10)
  v_mfma_f32_16x16x32_bf16 v[64:67], v[16:19], v[120:123], v[64:67]
  ds_read_b128 v[36:39], v6 offset:29696
  v_mfma_f32_16x16x32_bf16 v[68:71], v[20:23], v[120:123], v[68:71]
  ds_read_b128 v[40:43], v6 offset:30720
  v_mfma_f32_16x16x32_bf16 v[72:75], v[24:27], v[120:123], v[72:75]
  ds_read_b128 v[44:47], v6 offset:31744
  v_mfma_f32_16x16x32_bf16 v[76:79], v[28:31], v[120:123], v[76:79]
  ds_read_b128 v[48:51], v6 offset:32768
  v_mfma_f32_16x16x32_bf16 v[80:83], v[32:35], v[120:123], v[80:83]
  ds_read_b128 v[52:55], v6 offset:33792
  v_mfma_f32_16x16x32_bf16 v[84:87], v[16:19], v[124:127], v[84:87]
  v_mfma_f32_16x16x32_bf16 v[88:91], v[20:23], v[124:127], v[88:91]
  v_mfma_f32_16x16x32_bf16 v[92:95], v[24:27], v[124:127], v[92:95]
  v_mfma_f32_16x16x32_bf16 v[96:99], v[28:31], v[124:127], v[96:99]
  v_mfma_f32_16x16x32_bf16 v[100:103], v[32:35], v[124:127], v[100:103]
  s_waitcnt lgkmcnt(0)
  s_barrier
  s_waitcnt vmcnt(8)
  v_mfma_f32_16x16x32_bf16 v[64:67], v[36:39], v[128:131], v[64:67]
  ds_read_b128 v[16:19], v6 offset:49152
  v_mfma_f32_16x16x32_bf16 v[68:71], v[40:43], v[128:131], v[68:71]
  ds_read_b128 v[20:23], v6 offset:50176
  v_mfma_f32_16x16x32_bf16 v[72:75], v[44:47], v[128:131], v[72:75]
  ds_read_b128 v[24:27], v6 offset:51200
  v_mfma_f32_16x16x32_bf16 v[76:79], v[48:51], v[128:131], v[76:79]
  ds_read_b128 v[28:31], v6 offset:52224
  v_mfma_f32_16x16x32_bf16 v[80:83], v[52:55], v[128:131], v[80:83]
  ds_read_b128 v[32:35], v6 offset:53248
  v_mfma_f32_16x16x32_bf16 v[84:87], v[36:39], v[132:135], v[84:87]
  v_mfma_f32_16x16x32_bf16 v[88:91], v[40:43], v[132:135], v[88:91]
  v_mfma_f32_16x16x32_bf16 v[92:95], v[44:47], v[132:135], v[92:95]
  v_mfma_f32_16x16x32_bf16 v[96:99], v[48:51], v[132:135], v[96:99]
  v_mfma_f32_16x16x32_bf16 v[100:103], v[52:55], v[132:135], v[100:103]
  s_waitcnt lgkmcnt(0)
  s_waitcnt vmcnt(6)
  v_mfma_f32_16x16x32_bf16 v[64:67], v[16:19], v[136:139], v[64:67]
  ds_read_b128 v[36:39], v6 offset:54272
  v_mfma_f32_16x16x32_bf16 v[68:71], v[20:23], v[136:139], v[68:71]
  ds_read_b128 v[40:43], v6 offset:55296
  v_mfma_f32_16x16x32_bf16 v[72:75], v[24:27], v[136:139], v[72:75]
  ds_read_b128 v[44:47], v6 offset:56320
  v_mfma_f32_16x16x32_bf16 v[76:79], v[28:31], v[136:139], v[76:79]
  ds_read_b128 v[48:51], v6 offset:57344
  v_mfma_f32_16x16x32_bf16 v[80:83], v[32:35], v[136:139], v[80:83]
  ds_read_b128 v[52:55], v6 offset:58368
  v_mfma_f32_16x16x32_bf16 v[84:87], v[16:19], v[140:143], v[84:87]
  v_mfma_f32_16x16x32_bf16 v[88:91], v[20:23], v[140:143], v[88:91]
  v_mfma_f32_16x16x32_bf16 v[92:95], v[24:27], v[140:143], v[92:95]
  v_mfma_f32_16x16x32_bf16 v[96:99], v[28:31], v[140:143], v[96:99]
  v_mfma_f32_16x16x32_bf16 v[100:103], v[32:35], v[140:143], v[100:103]
  s_waitcnt lgkmcnt(0)
  s_waitcnt vmcnt(4)
  v_mfma_f32_16x16x32_bf16 v[64:67], v[36:39], v[144:147], v[64:67]
  ds_read_b128 v[16:19], v7 offset:8192
  v_mfma_f32_16x16x32_bf16 v[68:71], v[40:43], v[144:147], v[68:71]
  ds_read_b128 v[20:23], v7 offset:9216
  v_mfma_f32_16x16x32_bf16 v[72:75], v[44:47], v[144:147], v[72:75]
  ds_read_b128 v[24:27], v7 offset:10240
  v_mfma_f32_16x16x32_bf16 v[76:79], v[48:51], v[144:147], v[76:79]
  ds_read_b128 v[28:31], v7 offset:11264
  v_mfma_f32_16x16x32_bf16 v[80:83], v[52:55], v[144:147], v[80:83]
  ds_read_b128 v[32:35], v7 offset:12288
  v_mfma_f32_16x16x32_bf16 v[84:87], v[36:39], v[148:151], v[84:87]
  v_mfma_f32_16x16x32_bf16 v[88:91], v[40:43], v[148:151], v[88:91]
  v_mfma_f32_16x16x32_bf16 v[92:95], v[44:47], v[148:151], v[92:95]
  v_mfma_f32_16x16x32_bf16 v[96:99], v[48:51], v[148:151], v[96:99]
  v_mfma_f32_16x16x32_bf16 v[100:103], v[52:55], v[148:151], v[100:103]
  s_waitcnt lgkmcnt(0)
  s_waitcnt vmcnt(2)
  v_mfma_f32_16x16x32_bf16 v[64:67], v[16:19], v[152:155], v[64:67]
  ds_read_b128 v[36:39], v7 offset:13312
  v_mfma_f32_16x16x32_bf16 v[68:71], v[20:23], v[152:155], v[68:71]
  ds_read_b128 v[40:43], v7 offset:14336
  v_mfma_f32_16x16x32_bf16 v[72:75], v[24:27], v[152:155], v[72:75]
  ds_read_b128 v[44:47], v7 offset:15360
  v_mfma_f32_16x16x32_bf16 v[76:79], v[28:31], v[152:155], v[76:79]
  ds_read_b128 v[48:51], v7 offset:16384
  v_mfma_f32_16x16x32_bf16 v[80:83], v[32:35], v[152:155], v[80:83]
  ds_read_b128 v[52:55], v7 offset:17408
  v_mfma_f32_16x16x32_bf16 v[84:87], v[16:19], v[156:159], v[84:87]
  v_mfma_f32_16x16x32_bf16 v[88:91], v[20:23], v[156:159], v[88:91]
  v_mfma_f32_16x16x32_bf16 v[92:95], v[24:27], v[156:159], v[92:95]
  v_mfma_f32_16x16x32_bf16 v[96:99], v[28:31], v[156:159], v[96:99]
  v_mfma_f32_16x16x32_bf16 v[100:103], v[32:35], v[156:159], v[100:103]
  s_waitcnt lgkmcnt(0)
  s_waitcnt vmcnt(0)
  v_mfma_f32_16x16x32_bf16 v[64:67], v[36:39], v[160:163], v[64:67]
  v_mfma_f32_16x16x32_bf16 v[68:71], v[40:43], v[160:163], v[68:71]
  v_mfma_f32_16x16x32_bf16 v[72:75], v[44:47], v[160:163], v[72:75]
  v_mfma_f32_16x16x32_bf16 v[76:79], v[48:51], v[160:163], v[76:79]
  v_mfma_f32_16x16x32_bf16 v[80:83], v[52:55], v[160:163], v[80:83]
  v_mfma_f32_16x16x32_bf16 v[84:87], v[36:39], v[164:167], v[84:87]
  v_mfma_f32_16x16x32_bf16 v[88:91], v[40:43], v[164:167], v[88:91]
  v_mfma_f32_16x16x32_bf16 v[92:95], v[44:47], v[164:167], v[92:95]
  v_mfma_f32_16x16x32_bf16 v[96:99], v[48:51], v[164:167], v[96:99]
  v_mfma_f32_16x16x32_bf16 v[100:103], v[52:55], v[164:167], v[100:103]
  s_nop 7
  ds_read_b128 v[116:119], v251 offset:320
  ds_read_b128 v[120:123], v251 offset:384
  ds_read_b128 v[124:127], v251 offset:448
  ds_read_b128 v[128:131], v251 offset:512
  ds_read_b128 v[132:135], v251 offset:576
  v_lshlrev_b32 v140, 16, v240
  v_and_b32 v141, 0xffff0000, v240
  v_lshlrev_b32 v142, 16, v241
  v_and_b32 v143, 0xffff0000, v241
  v_lshlrev_b32 v144, 16, v242
  v_and_b32 v145, 0xffff0000, v242
  v_lshlrev_b32 v146, 16, v243
  v_and_b32 v147, 0xffff0000, v243
  v_lshlrev_b32 v148, 16, v244
  v_and_b32 v149, 0xffff0000, v244
  v_lshlrev_b32 v150, 16, v245
  v_and_b32 v151, 0xffff0000, v245
  v_lshlrev_b32 v152, 16, v246
  v_and_b32 v153, 0xffff0000, v246
  v_lshlrev_b32 v154, 16, v247
  v_and_b32 v155, 0xffff0000, v247
  v_lshlrev_b32 v156, 16, v248
  v_and_b32 v157, 0xffff0000, v248
  v_lshlrev_b32 v158, 16, v249
  v_and_b32 v159, 0xffff0000, v249
  s_barrier
  s_lshr_b32 s61, s3, 1
  s_cmp_eq_u32 s61, 1
  s_cbranch_scc1 L_p_xk1_81
  ds_write_b128 v254, v[84:87] offset:0
  ds_write_b128 v254, v[88:91] offset:1024
  ds_write_b128 v254, v[92:95] offset:2048
  ds_write_b128 v254, v[96:99] offset:3072
  ds_write_b128 v254, v[100:103] offset:4096
  s_branch L_p_xdone_82
L_p_xk1_81:
  ds_write_b128 v254, v[64:67] offset:0
  ds_write_b128 v254, v[68:71] offset:1024
  ds_write_b128 v254, v[72:75] offset:2048
  ds_write_b128 v254, v[76:79] offset:3072
  ds_write_b128 v254, v[80:83] offset:4096
L_p_xdone_82:
  s_waitcnt lgkmcnt(0)
  s_barrier
  ds_read_b128 v[16:19], v253 offset:0
  ds_read_b128 v[20:23], v253 offset:1024
  ds_read_b128 v[24:27], v253 offset:2048
  ds_read_b128 v[28:31], v253 offset:3072
  ds_read_b128 v[32:35], v253 offset:4096
  s_cbranch_scc1 L_p_xk1b_83
  s_waitcnt lgkmcnt(4)
  v_pk_add_f32 v[64:65], v[64:65], v[16:17]
  v_pk_add_f32 v[66:67], v[66:67], v[18:19]
  s_waitcnt lgkmcnt(3)
  v_pk_add_f32 v[68:69], v[68:69], v[20:21]
  v_pk_add_f32 v[70:71], v[70:71], v[22:23]
  s_waitcnt lgkmcnt(2)
  v_pk_add_f32 v[72:73], v[72:73], v[24:25]
  v_pk_add_f32 v[74:75], v[74:75], v[26:27]
  s_waitcnt lgkmcnt(1)
  v_pk_add_f32 v[76:77], v[76:77], v[28:29]
  v_pk_add_f32 v[78:79], v[78:79], v[30:31]
  s_waitcnt lgkmcnt(0)
  v_pk_add_f32 v[80:81], v[80:81], v[32:33]
  v_pk_add_f32 v[82:83], v[82:83], v[34:35]
  s_branch L_p_xdoneb_84
L_p_xk1b_83:
  s_waitcnt lgkmcnt(4)
  v_pk_add_f32 v[64:65], v[84:85], v[16:17]
  v_pk_add_f32 v[66:67], v[86:87], v[18:19]
  s_waitcnt lgkmcnt(3)
  v_pk_add_f32 v[68:69], v[88:89], v[20:21]
  v_pk_add_f32 v[70:71], v[90:91], v[22:23]
  s_waitcnt lgkmcnt(2)
  v_pk_add_f32 v[72:73], v[92:93], v[24:25]
  v_pk_add_f32 v[74:75], v[94:95], v[26:27]
  s_waitcnt lgkmcnt(1)
  v_pk_add_f32 v[76:77], v[96:97], v[28:29]
  v_pk_add_f32 v[78:79], v[98:99], v[30:31]
  s_waitcnt lgkmcnt(0)
  v_pk_add_f32 v[80:81], v[100:101], v[32:33]
  v_pk_add_f32 v[82:83], v[102:103], v[34:35]
L_p_xdoneb_84:
  v_pk_fma_f32 v[64:65], v[64:65], v[116:117], v[140:141]
  v_pk_fma_f32 v[66:67], v[66:67], v[118:119], v[142:143]
  v_pk_fma_f32 v[68:69], v[68:69], v[120:121], v[144:145]
  v_pk_fma_f32 v[70:71], v[70:71], v[122:123], v[146:147]
  v_pk_fma_f32 v[72:73], v[72:73], v[124:125], v[148:149]
  v_pk_fma_f32 v[74:75], v[74:75], v[126:127], v[150:151]
  v_pk_fma_f32 v[76:77], v[76:77], v[128:129], v[152:153]
  v_pk_fma_f32 v[78:79], v[78:79], v[130:131], v[154:155]
  v_pk_fma_f32 v[80:81], v[80:81], v[132:133], v[156:157]
  v_pk_fma_f32 v[82:83], v[82:83], v[134:135], v[158:159]
  v_cvt_pk_bf16_f32 v20, v64, v65
  v_cvt_pk_bf16_f32 v21, v66, v67
  v_cvt_pk_bf16_f32 v22, v68, v69
  v_cvt_pk_bf16_f32 v23, v70, v71
  v_cvt_pk_bf16_f32 v24, v72, v73
  v_cvt_pk_bf16_f32 v25, v74, v75
  v_cvt_pk_bf16_f32 v26, v76, v77
  v_cvt_pk_bf16_f32 v27, v78, v79
  v_cvt_pk_bf16_f32 v28, v80, v81
  v_cvt_pk_bf16_f32 v29, v82, v83
  v_lshrrev_b32 v16, 4, v2
  v_and_b32 v16, 1, v16
  v_mul_u32_u24 v16, 24, v16
  v_add_u32 v16, v250, v16
  v_permlane16_swap_b32 v20, v22
  v_permlane16_swap_b32 v21, v23
  v_permlane16_swap_b32 v24, v26
  v_permlane16_swap_b32 v25, v27
  buffer_store_dwordx4 v[20:23], v16, s[20:23], 0 offen
  buffer_store_dwordx4 v[24:27], v16, s[20:23], 0 offen offset:64
  buffer_store_dwordx2 v[28:29], v250, s[20:23], 0 offen offset:128
  s_endpgm
L_H_wo:
  s_mul_i32 s62, s29, 5120
  s_add_u32 m0, s62, 0
  s_add_u32 s61, s28, s62
  s_add_u32 s28, s28, 20480
  buffer_load_dwordx4 v3, s[12:15], s61 offen offset:0  lds
  buffer_load_dwordx4 v3, s[12:15], s61 offen offset:1024  lds
  buffer_load_dwordx4 v3, s[12:15], s61 offen offset:2048  lds
  buffer_load_dwordx4 v3, s[12:15], s61 offen offset:3072  lds
  s_add_u32 s61, s61, 4096
  s_add_u32 m0, m0, 4096
  s_nop 0
  buffer_load_dwordx4 v3, s[12:15], s61 offen offset:0  lds
  s_waitcnt vmcnt(5)
  v_mov_b32 v12, 161800
  v_mov_b32 v13, 1
  s_mov_b64 exec, 1
  ds_add_u32 v12, v13
  s_mov_b64 exec, -1
  s_add_u32 m0, s62, 20480
  s_add_u32 s61, s28, s62
  s_add_u32 s28, s28, 20480
  buffer_load_dwordx4 v3, s[12:15], s61 offen offset:0  lds
  buffer_load_dwordx4 v3, s[12:15], s61 offen offset:1024  lds
  buffer_load_dwordx4 v3, s[12:15], s61 offen offset:2048  lds
  buffer_load_dwordx4 v3, s[12:15], s61 offen offset:3072  lds
  s_add_u32 s61, s61, 4096
  s_add_u32 m0, m0, 4096
  s_nop 0
  buffer_load_dwordx4 v3, s[12:15], s61 offen offset:0  lds
  s_mul_i32 s62, s29, 5120
  s_waitcnt lgkmcnt(0)
  s_waitcnt vmcnt(0)
  s_barrier
  s_add_u32 s24, s4, 0x504000
  s_addc_u32 s25, s5, 0
  s_and_b32 s25, s25, 0xffff
  s_mov_b32 s26, 0x3c0000
  s_mov_b32 s27, 0x20000
  s_mul_i32 s44, s30, 5
  s_lshr_b32 s45, s44, 1
  s_mul_i32 s47, s31, 240*1024
  s_mul_i32 s48, s45, 6144
  s_add_u32 s47, s47, s48
  s_lshl_b32 s48, s29, 10
  s_add_u32 s47, s47, s48
  v_lshrrev_b32 v8, 5, v2
  v_lshlrev_b32 v8, 6, v8
  v_add_u32 v8, 158720, v8
  s_add_u32 s59, s47, 0
  buffer_load_dwordx4 v[20:23], v3, s[24:27], s59 offen
  s_add_u32 s59, s59, 4096
  buffer_load_dwordx4 v[32:35], v3, s[24:27], s59 offen
  s_add_u32 s59, s47, 6144
  buffer_load_dwordx4 v[24:27], v3, s[24:27], s59 offen
  s_add_u32 s59, s59, 4096
  buffer_load_dwordx4 v[36:39], v3, s[24:27], s59 offen
  s_add_u32 s59, s47, 12288
  buffer_load_dwordx4 v[28:31], v3, s[24:27], s59 offen
  s_add_u32 s59, s59, 4096
  buffer_load_dwordx4 v[40:43], v3, s[24:27], s59 offen
  v_mov_b32 v56, 0
  v_mov_b32 v57, 0
  v_mov_b32 v58, 0
  v_mov_b32 v59, 0
  ds_read_b128 v[64:67], v8 offset:0
  ds_read_b128 v[68:71], v8 offset:16
  ds_read_b128 v[72:75], v8 offset:32
  ds_read_b128 v[76:79], v8 offset:48
  s_waitcnt vmcnt(0)
  s_waitcnt lgkmcnt(0)
  v_lshlrev_b32 v18, 16, v20
  v_and_b32 v19, 0xffff0000, v20
  v_fmac_f32 v56, v18, v64
  v_fmac_f32 v57, v18, v72
  v_fmac_f32 v56, v19, v65
  v_fmac_f32 v57, v19, v73
  v_lshlrev_b32 v18, 16, v21
  v_and_b32 v19, 0xffff0000, v21
  v_fmac_f32 v56, v18, v66
  v_fmac_f32 v57, v18, v74
  v_fmac_f32 v56, v19, v67
  v_fmac_f32 v57, v19, v75
  v_lshlrev_b32 v18, 16, v22
  v_and_b32 v19, 0xffff0000, v22
  v_fmac_f32 v56, v18, v68
  v_fmac_f32 v57, v18, v76
  v_fmac_f32 v56, v19, v69
  v_fmac_f32 v57, v19, v77
  v_lshlrev_b32 v18, 16, v23
  v_and_b32 v19, 0xffff0000, v23
  v_fmac_f32 v56, v18, v70
  v_fmac_f32 v57, v18, v78
  v_fmac_f32 v56, v19, v71
  v_fmac_f32 v57, v19, v79
  v_lshlrev_b32 v18, 16, v32
  v_and_b32 v19, 0xffff0000, v32
  v_fmac_f32 v58, v18, v64
  v_fmac_f32 v59, v18, v72
  v_fmac_f32 v58, v19, v65
  v_fmac_f32 v59, v19, v73
  v_lshlrev_b32 v18, 16, v33
  v_and_b32 v19, 0xffff0000, v33
  v_fmac_f32 v58, v18, v66
  v_fmac_f32 v59, v18, v74
  v_fmac_f32 v58, v19, v67
  v_fmac_f32 v59, v19, v75
  v_lshlrev_b32 v18, 16, v34
  v_and_b32 v19, 0xffff0000, v34
  v_fmac_f32 v58, v18, v68
  v_fmac_f32 v59, v18, v76
  v_fmac_f32 v58, v19, v69
  v_fmac_f32 v59, v19, v77
  v_lshlrev_b32 v18, 16, v35
  v_and_b32 v19, 0xffff0000, v35
  v_fmac_f32 v58, v18, v70
  v_fmac_f32 v59, v18, v78
  v_fmac_f32 v58, v19, v71
  v_fmac_f32 v59, v19, v79
  s_barrier
  s_barrier
  s_add_u32 s12, s4, 0x504000
  s_addc_u32 s13, s5, 0
  s_and_b32 s13, s13, 0xffff
  s_mov_b32 s14, 0x3c0000
  s_mov_b32 s15, 0x20000
  s_mul_i32 s34, s31, 240*1024
  s_mul_i32 s62, s29, 6144
  s_mov_b32 s28, s34
  s_add_u32 m0, s62, 0
  s_add_u32 s61, s28, s62
  s_add_u32 s28, s28, 24576
  buffer_load_dwordx4 v3, s[12:15], s61 offen offset:0  lds
  buffer_load_dwordx4 v3, s[12:15], s61 offen offset:1024  lds
  buffer_load_dwordx4 v3, s[12:15], s61 offen offset:2048  lds
  buffer_load_dwordx4 v3, s[12:15], s61 offen offset:3072  lds
  s_add_u32 s61, s61, 4096
  s_add_u32 m0, m0, 4096
  s_nop 0
  buffer_load_dwordx4 v3, s[12:15], s61 offen offset:0  lds
  buffer_load_dwordx4 v3, s[12:15], s61 offen offset:1024  lds
  s_add_u32 m0, s62, 24576
  s_add_u32 s61, s28, s62
  s_add_u32 s28, s28, 24576
  buffer_load_dwordx4 v3, s[12:15], s61 offen offset:0  lds
  buffer_load_dwordx4 v3, s[12:15], s61 offen offset:1024  lds
  buffer_load_dwordx4 v3, s[12:15], s61 offen offset:2048  lds
  buffer_load_dwordx4 v3, s[12:15], s61 offen offset:3072  lds
  s_add_u32 s61, s61, 4096
  s_add_u32 m0, m0, 4096
  s_nop 0
  buffer_load_dwordx4 v3, s[12:15], s61 offen offset:0  lds
  buffer_load_dwordx4 v3, s[12:15], s61 offen offset:1024  lds
  s_add_u32 m0, s62, 49152
  s_add_u32 s61, s28, s62
  s_add_u32 s28, s28, 24576
  buffer_load_dwordx4 v3, s[12:15], s61 offen offset:0  lds
  buffer_load_dwordx4 v3, s[12:15], s61 offen offset:1024  lds
  buffer_load_dwordx4 v3, s[12:15], s61 offen offset:2048  lds
  buffer_load_dwordx4 v3, s[12:15], s61 offen offset:3072  lds
  s_add_u32 s61, s61, 4096
  s_add_u32 m0, m0, 4096
  s_nop 0
  buffer_load_dwordx4 v3, s[12:15], s61 offen offset:0  lds
  buffer_load_dwordx4 v3, s[12:15], s61 offen offset:1024  lds
  s_add_u32 m0, s62, 73728
  s_add_u32 s61, s28, s62
  s_add_u32 s28, s28, 24576
  buffer_load_dwordx4 v3, s[12:15], s61 offen offset:0  lds
  buffer_load_dwordx4 v3, s[12:15], s61 offen offset:1024  lds
  buffer_load_dwordx4 v3, s[12:15], s61 offen offset:2048  lds
  buffer_load_dwordx4 v3, s[12:15], s61 offen offset:3072  lds
  s_add_u32 s61, s61, 4096
  s_add_u32 m0, m0, 4096
  s_nop 0
  buffer_load_dwordx4 v3, s[12:15], s61 offen offset:0  lds
  buffer_load_dwordx4 v3, s[12:15], s61 offen offset:1024  lds
  ds_read_b128 v[64:67], v8 offset:128
  ds_read_b128 v[68:71], v8 offset:144
  ds_read_b128 v[72:75], v8 offset:160
  ds_read_b128 v[76:79], v8 offset:176
  s_waitcnt lgkmcnt(0)
  v_lshlrev_b32 v18, 16, v24
  v_and_b32 v19, 0xffff0000, v24
  v_fmac_f32 v56, v18, v64
  v_fmac_f32 v57, v18, v72
  v_fmac_f32 v56, v19, v65
  v_fmac_f32 v57, v19, v73
  v_lshlrev_b32 v18, 16, v25
  v_and_b32 v19, 0xffff0000, v25
  v_fmac_f32 v56, v18, v66
  v_fmac_f32 v57, v18, v74
  v_fmac_f32 v56, v19, v67
  v_fmac_f32 v57, v19, v75
  v_lshlrev_b32 v18, 16, v26
  v_and_b32 v19, 0xffff0000, v26
  v_fmac_f32 v56, v18, v68
  v_fmac_f32 v57, v18, v76
  v_fmac_f32 v56, v19, v69
  v_fmac_f32 v57, v19, v77
  v_lshlrev_b32 v18, 16, v27
  v_and_b32 v19, 0xffff0000, v27
  v_fmac_f32 v56, v18, v70
  v_fmac_f32 v57, v18, v78
  v_fmac_f32 v56, v19, v71
  v_fmac_f32 v57, v19, v79
  v_lshlrev_b32 v18, 16, v36
  v_and_b32 v19, 0xffff0000, v36
  v_fmac_f32 v58, v18, v64
  v_fmac_f32 v59, v18, v72
  v_fmac_f32 v58, v19, v65
  v_fmac_f32 v59, v19, v73
  v_lshlrev_b32 v18, 16, v37
  v_and_b32 v19, 0xffff0000, v37
  v_fmac_f32 v58, v18, v66
  v_fmac_f32 v59, v18, v74
  v_fmac_f32 v58, v19, v67
  v_fmac_f32 v59, v19, v75
  v_lshlrev_b32 v18, 16, v38
  v_and_b32 v19, 0xffff0000, v38
  v_fmac_f32 v58, v18, v68
  v_fmac_f32 v59, v18, v76
  v_fmac_f32 v58, v19, v69
  v_fmac_f32 v59, v19, v77
  v_lshlrev_b32 v18, 16, v39
  v_and_b32 v19, 0xffff0000, v39
  v_fmac_f32 v58, v18, v70
  v_fmac_f32 v59, v18, v78
  v_fmac_f32 v58, v19, v71
  v_fmac_f32 v59, v19, v79
  ds_read_b128 v[64:67], v8 offset:256
  ds_read_b128 v[68:71], v8 offset:272
  ds_read_b128 v[72:75], v8 offset:288
  ds_read_b128 v[76:79], v8 offset:304
  s_waitcnt lgkmcnt(0)
  v_lshlrev_b32 v18, 16, v28
  v_and_b32 v19, 0xffff0000, v28
  v_fmac_f32 v56, v18, v64
  v_fmac_f32 v57, v18, v72
  v_fmac_f32 v56, v19, v65
  v_fmac_f32 v57, v19, v73
  v_lshlrev_b32 v18, 16, v29
  v_and_b32 v19, 0xffff0000, v29
  v_fmac_f32 v56, v18, v66
  v_fmac_f32 v57, v18, v74
  v_fmac_f32 v56, v19, v67
  v_fmac_f32 v57, v19, v75
  v_lshlrev_b32 v18, 16, v30
  v_and_b32 v19, 0xffff0000, v30
  v_fmac_f32 v56, v18, v68
  v_fmac_f32 v57, v18, v76
  v_fmac_f32 v56, v19, v69
  v_fmac_f32 v57, v19, v77
  v_lshlrev_b32 v18, 16, v31
  v_and_b32 v19, 0xffff0000, v31
  v_fmac_f32 v56, v18, v70
  v_fmac_f32 v57, v18, v78
  v_fmac_f32 v56, v19, v71
  v_fmac_f32 v57, v19, v79
  v_lshlrev_b32 v18, 16, v40
  v_and_b32 v19, 0xffff0000, v40
  v_fmac_f32 v58, v18, v64
  v_fmac_f32 v59, v18, v72
  v_fmac_f32 v58, v19, v65
  v_fmac_f32 v59, v19, v73
  v_lshlrev_b32 v18, 16, v41
  v_and_b32 v19, 0xffff0000, v41
  v_fmac_f32 v58, v18, v66
  v_fmac_f32 v59, v18, v74
  v_fmac_f32 v58, v19, v67
  v_fmac_f32 v59, v19, v75
  v_lshlrev_b32 v18, 16, v42
  v_and_b32 v19, 0xffff0000, v42
  v_fmac_f32 v58, v18, v68
  v_fmac_f32 v59, v18, v76
  v_fmac_f32 v58, v19, v69
  v_fmac_f32 v59, v19, v77
  v_lshlrev_b32 v18, 16, v43
  v_and_b32 v19, 0xffff0000, v43
  v_fmac_f32 v58, v18, v70
  v_fmac_f32 v59, v18, v78
  v_fmac_f32 v58, v19, v71
  v_fmac_f32 v59, v19, v79
  s_add_u32 s24, s4, 0x23d5000
  s_addc_u32 s25, s5, 0
  s_and_b32 s25, s25, 0xffff
  s_mov_b32 s26, 0x60000
  s_mov_b32 s27, 0x20000
  v_mov_b32 v60, v56
  v_mov_b32 v61, v57
  v_mov_b32 v62, v58
  v_mov_b32 v63, v59
  s_nop 1
  v_permlane32_swap_b32 v56, v60
  v_permlane32_swap_b32 v57, v61
  v_permlane32_swap_b32 v58, v62
  v_permlane32_swap_b32 v59, v63
  s_nop 1
  v_add_f32 v56, v56, v60
  v_add_f32 v57, v57, v61
  v_add_f32 v58, v58, v62
  v_add_f32 v59, v59, v63
  v_and_b32 v8, 31, v2
  v_lshrrev_b32 v9, 2, v8
  v_lshlrev_b32 v9, 5, v9
  v_and_b32 v8, 3, v8
  v_lshl_add_u32 v9, v8, 2, v9
  s_lshl_b32 s44, s30, 4
  s_add_u32 s44, s44, s31
  s_mul_i32 s44, s44, 1536
  s_lshl_b32 s45, s29, 8
  s_add_u32 s44, s44, s45
  s_cmp_ge_u32 s29, 2
  s_cselect_b32 s46, 0x40000000, s44
  s_mov_b64 exec, 0xffffffff
  buffer_store_dword v56, v9, s[24:27], s44 offen sc1
  buffer_store_dword v57, v9, s[24:27], s44 offen offset:16 sc1
  buffer_store_dword v58, v9, s[24:27], s46 offen offset:1024 sc1
  buffer_store_dword v59, v9, s[24:27], s46 offen offset:1040 sc1
  s_mov_b64 exec, -1
  s_mul_i32 s62, s29, 6144
  s_waitcnt lgkmcnt(0)
  s_waitcnt vmcnt(16)
  s_barrier
  s_add_u32 m0, s62, 98304
  s_add_u32 s61, s28, s62
  s_add_u32 s28, s28, 24576
  buffer_load_dwordx4 v3, s[12:15], s61 offen offset:0  lds
  buffer_load_dwordx4 v3, s[12:15], s61 offen offset:1024  lds
  buffer_load_dwordx4 v3, s[12:15], s61 offen offset:2048  lds
  buffer_load_dwordx4 v3, s[12:15], s61 offen offset:3072  lds
  s_add_u32 s61, s61, 4096
  s_add_u32 m0, m0, 4096
  s_nop 0
  buffer_load_dwordx4 v3, s[12:15], s61 offen offset:0  lds
  buffer_load_dwordx4 v3, s[12:15], s61 offen offset:1024  lds
  s_add_u32 m0, s62, 122880
  s_add_u32 s61, s28, s62
  s_add_u32 s28, s28, 24576
  buffer_load_dwordx4 v3, s[12:15], s61 offen offset:0  lds
  buffer_load_dwordx4 v3, s[12:15], s61 offen offset:1024  lds
  buffer_load_dwordx4 v3, s[12:15], s61 offen offset:2048  lds
  buffer_load_dwordx4 v3, s[12:15], s61 offen offset:3072  lds
  s_add_u32 s61, s61, 4096
  s_add_u32 m0, m0, 4096
  s_nop 0
  buffer_load_dwordx4 v3, s[12:15], s61 offen offset:0  lds
  buffer_load_dwordx4 v3, s[12:15], s61 offen offset:1024  lds
  s_waitcnt vmcnt(12)
  v_mov_b32 v12, 161832
  v_mov_b32 v13, 1
  s_mov_b64 exec, 1
  ds_add_rtn_u32 v14, v12, v13
  s_waitcnt lgkmcnt(0)
  v_readfirstlane_b32 s60, v14
  s_cmp_lg_u32 s60, 3
  s_cbranch_scc1 L_p_cs3_85
  s_lshl_b32 s60, s31, 7
  s_add_u32 s60, s60, 40960
  v_mov_b32 v12, s60
  buffer_atomic_add v13, v12, s[16:19], 0 offen sc1
L_p_cs3_85:
  s_mov_b64 exec, -1
  s_barrier
  s_add_u32 m0, s62, 0
  s_add_u32 s61, s28, s62
  s_add_u32 s28, s28, 24576
  buffer_load_dwordx4 v3, s[12:15], s61 offen offset:0  lds
  buffer_load_dwordx4 v3, s[12:15], s61 offen offset:1024  lds
  buffer_load_dwordx4 v3, s[12:15], s61 offen offset:2048  lds
  buffer_load_dwordx4 v3, s[12:15], s61 offen offset:3072  lds
  s_add_u32 s61, s61, 4096
  s_add_u32 m0, m0, 4096
  s_nop 0
  buffer_load_dwordx4 v3, s[12:15], s61 offen offset:0  lds
  buffer_load_dwordx4 v3, s[12:15], s61 offen offset:1024  lds
  s_add_u32 m0, s62, 24576
  s_add_u32 s61, s28, s62
  s_add_u32 s28, s28, 24576
  buffer_load_dwordx4 v3, s[12:15], s61 offen offset:0  lds
  buffer_load_dwordx4 v3, s[12:15], s61 offen offset:1024  lds
  buffer_load_dwordx4 v3, s[12:15], s61 offen offset:2048  lds
  buffer_load_dwordx4 v3, s[12:15], s61 offen offset:3072  lds
  s_add_u32 s61, s61, 4096
  s_add_u32 m0, m0, 4096
  s_nop 0
  buffer_load_dwordx4 v3, s[12:15], s61 offen offset:0  lds
  buffer_load_dwordx4 v3, s[12:15], s61 offen offset:1024  lds
  s_waitcnt vmcnt(12)
  s_barrier
  s_add_u32 m0, s62, 49152
  s_add_u32 s61, s28, s62
  s_add_u32 s28, s28, 24576
  buffer_load_dwordx4 v3, s[12:15], s61 offen offset:0  lds
  buffer_load_dwordx4 v3, s[12:15], s61 offen offset:1024  lds
  buffer_load_dwordx4 v3, s[12:15], s61 offen offset:2048  lds
  buffer_load_dwordx4 v3, s[12:15], s61 offen offset:3072  lds
  s_add_u32 s61, s61, 4096
  s_add_u32 m0, m0, 4096
  s_nop 0
  buffer_load_dwordx4 v3, s[12:15], s61 offen offset:0  lds
  buffer_load_dwordx4 v3, s[12:15], s61 offen offset:1024  lds
  s_add_u32 m0, s62, 73728
  s_add_u32 s61, s28, s62
  s_add_u32 s28, s28, 24576
  buffer_load_dwordx4 v3, s[12:15], s61 offen offset:0  lds
  buffer_load_dwordx4 v3, s[12:15], s61 offen offset:1024  lds
  buffer_load_dwordx4 v3, s[12:15], s61 offen offset:2048  lds
  buffer_load_dwordx4 v3, s[12:15], s61 offen offset:3072  lds
  s_add_u32 s61, s61, 4096
  s_add_u32 m0, m0, 4096
  s_nop 0
  buffer_load_dwordx4 v3, s[12:15], s61 offen offset:0  lds
  buffer_load_dwordx4 v3, s[12:15], s61 offen offset:1024  lds
  s_lshl_b32 s60, s31, 7
  s_add_u32 s60, s60, 40960
  v_mov_b32 v12, s60
  s_mov_b64 exec, 1
  buffer_load_dword v13, v12, s[16:19], 0 offen sc1
  s_mov_b64 exec, -1
  s_waitcnt vmcnt(13)
  s_barrier
  s_add_u32 s12, s4, 0x994000
  s_addc_u32 s13, s5, 0
  s_and_b32 s13, s13, 0xffff
  s_mov_b32 s14, 0x1e0000
  s_mov_b32 s15, 0x20000
  s_mul_i32 s34, s38, 240*1024
  s_mul_i32 s62, s29, 5120
  s_mov_b32 s28, s34
  s_add_u32 m0, s62, 98304
  s_add_u32 s61, s28, s62
  s_add_u32 s28, s28, 20480
  buffer_load_dwordx4 v3, s[12:15], s61 offen offset:0  lds
  buffer_load_dwordx4 v3, s[12:15], s61 offen offset:1024  lds
  buffer_load_dwordx4 v3, s[12:15], s61 offen offset:2048  lds
  buffer_load_dwordx4 v3, s[12:15], s61 offen offset:3072  lds
  s_add_u32 s61, s61, 4096
  s_add_u32 m0, m0, 4096
  s_nop 0
  buffer_load_dwordx4 v3, s[12:15], s61 offen offset:0  lds
  s_waitcnt vmcnt(5)
  v_readfirstlane_b32 s60, v13
  s_cmp_ge_u32 s60, 16
  s_cbranch_scc1 L_p_cl0_86
  s_lshl_b32 s60, s31, 7
  s_add_u32 s60, s60, 40960
  v_mov_b32 v12, s60
  s_mov_b64 exec, 1
  s_mov_b32 s63, 40000
L_p_poll_87:
  buffer_load_dword v14, v12, s[16:19], 0 offen sc1
  s_waitcnt vmcnt(0)
  v_cmp_le_u32 vcc, 16, v14
  s_nop 1
  s_cmp_eq_u64 vcc, exec
  s_cbranch_scc1 L_p_polled_88
  s_sub_u32 s63, s63, 1
  s_cmp_lg_u32 s63, 0
  s_cbranch_scc1 L_p_poll_87
L_p_polled_88:
  s_mov_b64 exec, -1
L_p_cl0_86:
  s_add_u32 s20, s4, 0x23d5000
  s_addc_u32 s21, s5, 0
  s_and_b32 s21, s21, 0xffff
  s_mov_b32 s22, 0x60000
  s_mov_b32 s23, 0x20000
  v_lshrrev_b32 v16, 5, v2
  v_mul_u32_u24 v16, 24576, v16
  v_and_b32 v17, 31, v2
  v_lshl_add_u32 v16, v17, 4, v16
  s_lshl_b32 s59, s29, 9
  v_add_u32 v16, s59, v16
  s_mul_i32 s59, s31, 1536
  buffer_load_dwordx4 v[20:23], v16, s[20:23], s59 offen sc1
  s_add_u32 s59, s59, 49152
  buffer_load_dwordx4 v[24:27], v16, s[20:23], s59 offen sc1
  s_add_u32 s59, s59, 49152
  buffer_load_dwordx4 v[28:31], v16, s[20:23], s59 offen sc1
  s_add_u32 s59, s59, 49152
  buffer_load_dwordx4 v[32:35], v16, s[20:23], s59 offen sc1
  s_add_u32 s59, s59, 49152
  buffer_load_dwordx4 v[36:39], v16, s[20:23], s59 offen sc1
  s_add_u32 s59, s59, 49152
  buffer_load_dwordx4 v[40:43], v16, s[20:23], s59 offen sc1
  s_add_u32 s59, s59, 49152
  buffer_load_dwordx4 v[44:47], v16, s[20:23], s59 offen sc1
  s_add_u32 s59, s59, 49152
  buffer_load_dwordx4 v[48:51], v16, s[20:23], s59 offen sc1
  s_add_u32 s59, s59, 49152
  s_add_u32 m0, s62, 122880
  s_add_u32 s61, s28, s62
  s_add_u32 s28, s28, 20480
  buffer_load_dwordx4 v3, s[12:15], s61 offen offset:0  lds
  buffer_load_dwordx4 v3, s[12:15], s61 offen offset:1024  lds
  buffer_load_dwordx4 v3, s[12:15], s61 offen offset:2048  lds
  buffer_load_dwordx4 v3, s[12:15], s61 offen offset:3072  lds
  s_add_u32 s61, s61, 4096
  s_add_u32 m0, m0, 4096
  s_nop 0
  buffer_load_dwordx4 v3, s[12:15], s61 offen offset:0  lds
  s_barrier
  s_add_u32 m0, s62, 0
  s_add_u32 s61, s28, s62
  s_add_u32 s28, s28, 20480
  buffer_load_dwordx4 v3, s[12:15], s61 offen offset:0  lds
  buffer_load_dwordx4 v3, s[12:15], s61 offen offset:1024  lds
  buffer_load_dwordx4 v3, s[12:15], s61 offen offset:2048  lds
  buffer_load_dwordx4 v3, s[12:15], s61 offen offset:3072  lds
  s_add_u32 s61, s61, 4096
  s_add_u32 m0, m0, 4096
  s_nop 0
  buffer_load_dwordx4 v3, s[12:15], s61 offen offset:0  lds
  s_add_u32 m0, s62, 24576
  s_add_u32 s61, s28, s62
  s_add_u32 s28, s28, 20480
  buffer_load_dwordx4 v3, s[12:15], s61 offen offset:0  lds
  buffer_load_dwordx4 v3, s[12:15], s61 offen offset:1024  lds
  buffer_load_dwordx4 v3, s[12:15], s61 offen offset:2048  lds
  buffer_load_dwordx4 v3, s[12:15], s61 offen offset:3072  lds
  s_add_u32 s61, s61, 4096
  s_add_u32 m0, m0, 4096
  s_nop 0
  buffer_load_dwordx4 v3, s[12:15], s61 offen offset:0  lds
  s_waitcnt vmcnt(15)
  v_add_f32 v20, v20, v24
  v_add_f32 v21, v21, v25
  v_add_f32 v22, v22, v26
  v_add_f32 v23, v23, v27
  v_add_f32 v20, v20, v28
  v_add_f32 v21, v21, v29
  v_add_f32 v22, v22, v30
  v_add_f32 v23, v23, v31
  v_add_f32 v20, v20, v32
  v_add_f32 v21, v21, v33
  v_add_f32 v22, v22, v34
  v_add_f32 v23, v23, v35
  v_add_f32 v20, v20, v36
  v_add_f32 v21, v21, v37
  v_add_f32 v22, v22, v38
  v_add_f32 v23, v23, v39
  v_add_f32 v20, v20, v40
  v_add_f32 v21, v21, v41
  v_add_f32 v22, v22, v42
  v_add_f32 v23, v23, v43
  v_add_f32 v20, v20, v44
  v_add_f32 v21, v21, v45
  v_add_f32 v22, v22, v46
  v_add_f32 v23, v23, v47
  v_add_f32 v20, v20, v48
  v_add_f32 v21, v21, v49
  v_add_f32 v22, v22, v50
  v_add_f32 v23, v23, v51
  v_mov_b32 v24, v20
  v_mov_b32 v25, v21
  v_mov_b32 v26, v22
  v_mov_b32 v27, v23
  s_nop 1
  v_permlane32_swap_b32 v20, v24
  v_permlane32_swap_b32 v21, v25
  v_permlane32_swap_b32 v22, v26
  v_permlane32_swap_b32 v23, v27
  s_nop 1
  v_add_f32 v20, v20, v24
  v_add_f32 v21, v21, v25
  v_add_f32 v22, v22, v26
  v_add_f32 v23, v23, v27
  v_and_b32 v16, 31, v2
  v_lshlrev_b32 v16, 4, v16
  s_lshl_b32 s59, s29, 9
  s_add_u32 s59, s59, 160256
  v_add_u32 v16, s59, v16
  s_cmp_eq_u32 s29, 3
  s_cbranch_scc1 L_p_cf_89
  s_mov_b64 exec, 0xffffffff
  ds_write_b128 v16, v[20:23]
  s_mov_b64 exec, -1
L_p_cf_89:
  s_waitcnt lgkmcnt(0)
  s_barrier
  s_add_u32 m0, s62, 49152
  s_add_u32 s61, s28, s62
  s_add_u32 s28, s28, 20480
  buffer_load_dwordx4 v3, s[12:15], s61 offen offset:0  lds
  buffer_load_dwordx4 v3, s[12:15], s61 offen offset:1024  lds
  buffer_load_dwordx4 v3, s[12:15], s61 offen offset:2048  lds
  buffer_load_dwordx4 v3, s[12:15], s61 offen offset:3072  lds
  s_add_u32 s61, s61, 4096
  s_add_u32 m0, m0, 4096
  s_nop 0
  buffer_load_dwordx4 v3, s[12:15], s61 offen offset:0  lds
  s_add_u32 m0, s62, 73728
  s_add_u32 s61, s28, s62
  s_add_u32 s28, s28, 20480
  buffer_load_dwordx4 v3, s[12:15], s61 offen offset:0  lds
  buffer_load_dwordx4 v3, s[12:15], s61 offen offset:1024  lds
  buffer_load_dwordx4 v3, s[12:15], s61 offen offset:2048  lds
  buffer_load_dwordx4 v3, s[12:15], s61 offen offset:3072  lds
  s_add_u32 s61, s61, 4096
  s_add_u32 m0, m0, 4096
  s_nop 0
  buffer_load_dwordx4 v3, s[12:15], s61 offen offset:0  lds
  s_mul_i32 s62, s29, 5120
  s_waitcnt lgkmcnt(0)
  s_waitcnt vmcnt(20)
  s_barrier
  s_waitcnt vmcnt(10)
  s_barrier
  s_add_u32 m0, s62, 98304
  s_add_u32 s61, s28, s62
  s_add_u32 s28, s28, 20480
  buffer_load_dwordx4 v3, s[12:15], s61 offen offset:0  lds
  buffer_load_dwordx4 v3, s[12:15], s61 offen offset:1024  lds
  buffer_load_dwordx4 v3, s[12:15], s61 offen offset:2048  lds
  buffer_load_dwordx4 v3, s[12:15], s61 offen offset:3072  lds
  s_add_u32 s61, s61, 4096
  s_add_u32 m0, m0, 4096
  s_nop 0
  buffer_load_dwordx4 v3, s[12:15], s61 offen offset:0  lds
  s_add_u32 m0, s62, 122880
  s_add_u32 s61, s28, s62
  s_add_u32 s28, s28, 20480
  buffer_load_dwordx4 v3, s[12:15], s61 offen offset:0  lds
  buffer_load_dwordx4 v3, s[12:15], s61 offen offset:1024  lds
  buffer_load_dwordx4 v3, s[12:15], s61 offen offset:2048  lds
  buffer_load_dwordx4 v3, s[12:15], s61 offen offset:3072  lds
  s_add_u32 s61, s61, 4096
  s_add_u32 m0, m0, 4096
  s_nop 0
  buffer_load_dwordx4 v3, s[12:15], s61 offen offset:0  lds
  s_waitcnt vmcnt(10)
  s_barrier
  s_add_u32 m0, s62, 0
  s_add_u32 s61, s28, s62
  s_add_u32 s28, s28, 20480
  buffer_load_dwordx4 v3, s[12:15], s61 offen offset:0  lds
  buffer_load_dwordx4 v3, s[12:15], s61 offen offset:1024  lds
  buffer_load_dwordx4 v3, s[12:15], s61 offen offset:2048  lds
  buffer_load_dwordx4 v3, s[12:15], s61 offen offset:3072  lds
  s_add_u32 s61, s61, 4096
  s_add_u32 m0, m0, 4096
  s_nop 0
  buffer_load_dwordx4 v3, s[12:15], s61 offen offset:0  lds
  s_add_u32 m0, s62, 24576
  s_add_u32 s61, s28, s62
  s_add_u32 s28, s28, 20480
  buffer_load_dwordx4 v3, s[12:15], s61 offen offset:0  lds
  buffer_load_dwordx4 v3, s[12:15], s61 offen offset:1024  lds
  buffer_load_dwordx4 v3, s[12:15], s61 offen offset:2048  lds
  buffer_load_dwordx4 v3, s[12:15], s61 offen offset:3072  lds
  s_add_u32 s61, s61, 4096
  s_add_u32 m0, m0, 4096
  s_nop 0
  buffer_load_dwordx4 v3, s[12:15], s61 offen offset:0  lds
  s_waitcnt vmcnt(10)
  s_barrier
  s_add_u32 m0, s62, 49152
  s_add_u32 s61, s28, s62
  s_add_u32 s28, s28, 20480
  buffer_load_dwordx4 v3, s[12:15], s61 offen offset:0  lds
  buffer_load_dwordx4 v3, s[12:15], s61 offen offset:1024  lds
  buffer_load_dwordx4 v3, s[12:15], s61 offen offset:2048  lds
  buffer_load_dwordx4 v3, s[12:15], s61 offen offset:3072  lds
  s_add_u32 s61, s61, 4096
  s_add_u32 m0, m0, 4096
  s_nop 0
  buffer_load_dwordx4 v3, s[12:15], s61 offen offset:0  lds
  s_add_u32 m0, s62, 73728
  s_add_u32 s61, s28, s62
  s_add_u32 s28, s28, 20480
  buffer_load_dwordx4 v3, s[12:15], s61 offen offset:0  lds
  buffer_load_dwordx4 v3, s[12:15], s61 offen offset:1024  lds
  buffer_load_dwordx4 v3, s[12:15], s61 offen offset:2048  lds
  buffer_load_dwordx4 v3, s[12:15], s61 offen offset:3072  lds
  s_add_u32 s61, s61, 4096
  s_add_u32 m0, m0, 4096
  s_nop 0
  buffer_load_dwordx4 v3, s[12:15], s61 offen offset:0  lds
  s_waitcnt vmcnt(10)
  s_barrier
  s_waitcnt vmcnt(0)
  s_barrier
  s_barrier
  s_barrier
L_p_end:
  s_endpgm
L_p_codeend:
.section .rodata,"a"
.p2align 6
.amdhsa_kernel k0_kernel
  .amdhsa_next_free_vgpr 128
  .amdhsa_next_free_sgpr 102
  .amdhsa_accum_offset 128
  .amdhsa_group_segment_fixed_size 0
  .amdhsa_kernarg_size 96
  .amdhsa_user_sgpr_count 2
  .amdhsa_user_sgpr_kernarg_segment_ptr 1
  .amdhsa_system_sgpr_workgroup_id_x 1
  .amdhsa_float_denorm_mode_32 3
.end_amdhsa_kernel
.p2align 6
.amdhsa_kernel p_kernel
  .amdhsa_next_free_vgpr 256
  .amdhsa_next_free_sgpr 102
  .amdhsa_accum_offset 256
  .amdhsa_group_segment_fixed_size 0
  .amdhsa_kernarg_size 96
  .amdhsa_user_sgpr_count 2
  .amdhsa_user_sgpr_kernarg_segment_ptr 1
  .amdhsa_system_sgpr_workgroup_id_x 1
  .amdhsa_float_denorm_mode_32 3
.end_amdhsa_kernel
```
